```python
import torch

def _softmax(x, axis=-1):
    return torch.softmax(x, dim=axis)

def _gelu(x):
    return torch.nn.functional.gelu(x, approximate='tanh')

def _silu(x):
    return torch.nn.functional.silu(x)

def _sigmoid(x):
    return torch.sigmoid(x)

def _layernorm(x, axis=-1, eps=1e-05):
    m = x.mean(dim=axis, keepdim=True)
    v = x.var(dim=axis, keepdim=True, unbiased=False)
    return (x - m) / torch.sqrt(v + eps)

def _scatter_add(tgt, idx, src, axis=0):
    return tgt.clone().index_add_(axis, idx, src)

def _segment_sum(src, seg, n):
    out = torch.zeros((n,) + src.shape[1:], dtype=src.dtype)
    return out.index_add_(0, seg, src)

def _pad(x, pw):
    flat = tuple((v for pair in reversed(pw) for v in pair))
    return torch.nn.functional.pad(x, flat)
kernel_name = 'concat_heads__memory_aug_recurrent_mem_tr__mha_block__prompt'

def setup_inputs():

    _w = lambda a: (lambda t: t.to(torch.bfloat16) if t.is_floating_point() else t)(torch.as_tensor(a))

    def _A_setup():
        B, S, Dm = (1, 2048, 512)
        H, Dh = (32, 128)
        M, seg = (8, 32)
        seg = min(seg, S)
        S = S // seg * seg
        return {'x': _w((lambda *s: torch.randn(*s, dtype=torch.bfloat16) * 0.05)(B, S, Dm)), 'mem0': _w((lambda *s: torch.randn(*s, dtype=torch.bfloat16) * 0.8)(B, M, Dm)), 'Wq': _w((lambda *s: torch.randn(*s, dtype=torch.bfloat16) * 1.6)(Dm, H, Dh) * Dm ** (-0.5)), 'Wk': _w((lambda *s: torch.randn(*s, dtype=torch.bfloat16) * 1.6)(Dm, H, Dh) * Dm ** (-0.5)), 'Wv': _w((lambda *s: torch.randn(*s, dtype=torch.bfloat16) * 0.8)(Dm, H, Dh) * Dm ** (-0.5)), 'Wo': _w((lambda *s: torch.randn(*s, dtype=torch.bfloat16) * 0.8)(H, Dh, Dm) * (H * Dh) ** (-0.5)), 'seg_len': seg}
    _A_in = _A_setup()

    def _B_setup():
        B, S, D, H = (1, 2048, 512, 32)
        return {'x': _w((lambda *s: torch.randn(*s, dtype=torch.bfloat16) * 0.2)(B, S, D)), 'wqkv': _w((lambda *s: torch.randn(*s, dtype=torch.bfloat16) * 0.2)(D, 3 * D)), 'wo': _w((lambda *s: torch.randn(*s, dtype=torch.bfloat16) * 0.05)(D, D))}
    _B_in = _B_setup()
    return {'A_x': _A_in['x'], 'A_mem0': _A_in['mem0'], 'A_Wq': _A_in['Wq'], 'A_Wk': _A_in['Wk'], 'A_Wv': _A_in['Wv'], 'A_Wo': _A_in['Wo'], 'A_seg_len': _A_in['seg_len'], 'B_x': _B_in['x'], 'B_wqkv': _B_in['wqkv'], 'B_wo': _B_in['wo']}

def reference(A_x, A_mem0, A_Wq, A_Wk, A_Wv, A_Wo, A_seg_len, B_x, B_wqkv, B_wo):

    def _A_ref(x, mem0, Wq, Wk, Wv, Wo, seg_len):
        B, S, Dm = x.shape
        H, Dh = (Wq.shape[1], Wq.shape[2])
        M = mem0.shape[1]
        scale = Dh ** (-0.5)
        n_seg = S // seg_len
        L = M + seg_len
        idx = torch.arange(L)
        mask = (idx[:, None] < M) | (idx[:, None] >= idx[None, :])
        mem = mem0
        outs = []
        for s in range(n_seg):
            xs = x[:, s * seg_len:(s + 1) * seg_len, :].clone()
            h = torch.concatenate([mem, xs], axis=1)
            q = torch.einsum('btd,dhe->bhte', h, Wq)
            k = torch.einsum('btd,dhe->bhte', h, Wk)
            v = torch.einsum('btd,dhe->bhte', h, Wv)
            scores = torch.einsum('bhqe,bhke->bhqk', q, k) * scale
            scores = torch.where(mask[None, None], scores, -1000000000.0)
            p = _softmax(scores, axis=-1)
            o = torch.einsum('bhqk,bhke->bhqe', p, v)
            o = torch.einsum('bhte,hed->btd', o, Wo)
            mem = o[:, :M, :].clone()
            outs.append(o[:, M:, :])
        return torch.concatenate(outs, axis=1)

    def _B_ref(x, wqkv, wo):
        B, S, D = x.shape
        H = 32
        Dh = D // H
        qkv = (lambda x, *d: x.permute(*d))((x @ wqkv).reshape(B, S, 3, H, Dh), 2, 0, 3, 1, 4)
        q, k, v = (qkv[0], qkv[1], qkv[2])
        scores = torch.einsum('bhqd,bhkd->bhqk', q, k) * Dh ** (-0.5)
        p = _softmax(scores, axis=-1)
        o = torch.einsum('bhqk,bhkd->bhqd', p, v)
        return (lambda x, *d: x.permute(*d))(o, 0, 2, 1, 3).reshape(B, S, D) @ wo
    a = _A_ref(A_x, A_mem0, A_Wq, A_Wk, A_Wv, A_Wo, A_seg_len)
    b = _B_ref(B_x, B_wqkv, B_wo)
    return torch.concatenate([a, b], axis=-1)
```

```asm
; @launch grid=(256,1,1) block=(256,1,1) lds=163840
.amdgcn_target "amdgcn-amd-amdhsa--gfx950"
.text
.globl concat_heads__memory_aug_recurrent_mem_tr__mha_block__prompt_kernel
.p2align 8
.type concat_heads__memory_aug_recurrent_mem_tr__mha_block__prompt_kernel,@function
concat_heads__memory_aug_recurrent_mem_tr__mha_block__prompt_kernel:
  s_cmp_ge_u32 s2, 256
  s_cbranch_scc1 L_exit
  s_load_dwordx16 s[64:79], s[0:1], 0
  s_load_dwordx8 s[80:87], s[0:1], 64
  s_load_dwordx2 s[88:89], s[0:1], 96
  s_getreg_b32 s3, hwreg(HW_REG_XCC_ID)
  s_and_b32 s3, s3, 0xf
  v_lshrrev_b32 v1, 6, v0
  v_and_b32 v0, 63, v0
  v_readfirstlane_b32 s4, v1
  s_mov_b32 s56, 0x400000
  s_and_b32 s57, s3, 3
  s_lshl_b32 s57, s57, 6
  s_and_b32 s58, s3, 12
  s_add_u32 s57, s57, s58
  v_mov_b32 v2, s57
  v_mov_b32 v3, 1
  s_waitcnt lgkmcnt(0)
  s_mov_b32 s48, s86
  s_and_b32 s49, s87, 0xffff
  s_mov_b32 s50, 0x100
  s_mov_b32 s51, 0x20000
  s_cmp_lg_u32 s4, 0
  s_cbranch_scc1 L_notick
  s_mov_b64 exec, 1
  buffer_atomic_add v3, v2, s[48:51], 0 offen sc0
L_notick:
  s_mov_b32 s52, s88
  s_and_b32 s53, s89, 0xffff
  s_mov_b32 s54, 0x10000000
  s_mov_b32 s55, 0x20000
  s_mov_b32 s8, s64
  s_and_b32 s9, s65, 0xffff
  s_mov_b32 s10, 0x200000
  s_mov_b32 s11, 0x20000
  s_mov_b32 s12, s66
  s_and_b32 s13, s67, 0xffff
  s_mov_b32 s14, 0x2000
  s_mov_b32 s15, 0x20000
  s_mov_b32 s16, s68
  s_and_b32 s17, s69, 0xffff
  s_mov_b32 s18, 0x400000
  s_mov_b32 s19, 0x20000
  s_mov_b32 s20, s70
  s_and_b32 s21, s71, 0xffff
  s_mov_b32 s22, 0x400000
  s_mov_b32 s23, 0x20000
  s_mov_b32 s24, s72
  s_and_b32 s25, s73, 0xffff
  s_mov_b32 s26, 0x400000
  s_mov_b32 s27, 0x20000
  s_mov_b32 s28, s74
  s_and_b32 s29, s75, 0xffff
  s_mov_b32 s30, 0x400000
  s_mov_b32 s31, 0x20000
  s_mov_b32 s32, s78
  s_and_b32 s33, s79, 0xffff
  s_mov_b32 s34, 0x200000
  s_mov_b32 s35, 0x20000
  s_mov_b32 s36, s80
  s_and_b32 s37, s81, 0xffff
  s_mov_b32 s38, 0x180000
  s_mov_b32 s39, 0x20000
  s_mov_b32 s40, s82
  s_and_b32 s41, s83, 0xffff
  s_mov_b32 s42, 0x80000
  s_mov_b32 s43, 0x20000
  s_mov_b32 s44, s84
  s_and_b32 s45, s85, 0xffff
  s_mov_b32 s46, 0x400000
  s_mov_b32 s47, 0x20000
  s_cmp_lg_u32 s4, 0
  s_cbranch_scc1 L_warm
  s_waitcnt vmcnt(0)
  s_mov_b64 exec, -1
  v_readfirstlane_b32 s58, v3
  s_lshl_b32 s59, s3, 5
  s_add_u32 s59, s59, s58
  s_cmp_ge_u32 s58, 32
  s_cbranch_scc1 L_ovf
  s_cmp_ge_u32 s3, 8
  s_cbranch_scc0 L_role_done
L_ovf:
  v_mov_b32 v2, 236
  v_mov_b32 v3, 1
  s_mov_b64 exec, 1
  buffer_atomic_add v3, v2, s[48:51], 0 offen sc0
  s_waitcnt vmcnt(0)
  s_mov_b64 exec, -1
  v_readfirstlane_b32 s58, v3
  v_and_b32 v2, 3, v0
  v_lshlrev_b32 v2, 6, v2
  v_and_b32 v3, 12, v0
  v_add_u32 v2, v2, v3
L_ovf_wait:
  s_sub_u32 s56, s56, 1
  s_cbranch_scc1 L_timeout
  s_sleep 8
  buffer_load_dword v3, v2, s[48:51], 0 offen sc1
  s_waitcnt vmcnt(0)
  s_mov_b32 s60, 0
  v_readlane_b32 s61, v3, 0
  s_nop 0
  s_add_u32 s60, s60, s61
  v_readlane_b32 s61, v3, 1
  s_nop 0
  s_add_u32 s60, s60, s61
  v_readlane_b32 s61, v3, 2
  s_nop 0
  s_add_u32 s60, s60, s61
  v_readlane_b32 s61, v3, 3
  s_nop 0
  s_add_u32 s60, s60, s61
  v_readlane_b32 s61, v3, 4
  s_nop 0
  s_add_u32 s60, s60, s61
  v_readlane_b32 s61, v3, 5
  s_nop 0
  s_add_u32 s60, s60, s61
  v_readlane_b32 s61, v3, 6
  s_nop 0
  s_add_u32 s60, s60, s61
  v_readlane_b32 s61, v3, 7
  s_nop 0
  s_add_u32 s60, s60, s61
  v_readlane_b32 s61, v3, 8
  s_nop 0
  s_add_u32 s60, s60, s61
  v_readlane_b32 s61, v3, 9
  s_nop 0
  s_add_u32 s60, s60, s61
  v_readlane_b32 s61, v3, 10
  s_nop 0
  s_add_u32 s60, s60, s61
  v_readlane_b32 s61, v3, 11
  s_nop 0
  s_add_u32 s60, s60, s61
  v_readlane_b32 s61, v3, 12
  s_nop 0
  s_add_u32 s60, s60, s61
  v_readlane_b32 s61, v3, 13
  s_nop 0
  s_add_u32 s60, s60, s61
  v_readlane_b32 s61, v3, 14
  s_nop 0
  s_add_u32 s60, s60, s61
  v_readlane_b32 s61, v3, 15
  s_nop 0
  s_add_u32 s60, s60, s61
  s_cmp_lt_u32 s60, 256
  s_cbranch_scc1 L_ovf_wait
  s_mov_b32 s59, 0x1000
  v_readlane_b32 s61, v3, 0
  s_nop 0
  s_min_u32 s61, s61, 32
  s_sub_u32 s60, 32, s61
  s_cmp_lt_u32 s58, s60
  s_cbranch_scc0 L_ovf_n_1
  s_add_u32 s59, s61, s58
  s_add_u32 s59, s59, 65536
  s_branch L_role_done
L_ovf_n_1:
  s_sub_u32 s58, s58, s60
  v_readlane_b32 s61, v3, 1
  s_nop 0
  s_min_u32 s61, s61, 32
  s_sub_u32 s60, 32, s61
  s_cmp_lt_u32 s58, s60
  s_cbranch_scc0 L_ovf_n_2
  s_add_u32 s59, s61, s58
  s_add_u32 s59, s59, 65568
  s_branch L_role_done
L_ovf_n_2:
  s_sub_u32 s58, s58, s60
  v_readlane_b32 s61, v3, 2
  s_nop 0
  s_min_u32 s61, s61, 32
  s_sub_u32 s60, 32, s61
  s_cmp_lt_u32 s58, s60
  s_cbranch_scc0 L_ovf_n_3
  s_add_u32 s59, s61, s58
  s_add_u32 s59, s59, 65600
  s_branch L_role_done
L_ovf_n_3:
  s_sub_u32 s58, s58, s60
  v_readlane_b32 s61, v3, 3
  s_nop 0
  s_min_u32 s61, s61, 32
  s_sub_u32 s60, 32, s61
  s_cmp_lt_u32 s58, s60
  s_cbranch_scc0 L_ovf_n_4
  s_add_u32 s59, s61, s58
  s_add_u32 s59, s59, 65632
  s_branch L_role_done
L_ovf_n_4:
  s_sub_u32 s58, s58, s60
  v_readlane_b32 s61, v3, 4
  s_nop 0
  s_min_u32 s61, s61, 32
  s_sub_u32 s60, 32, s61
  s_cmp_lt_u32 s58, s60
  s_cbranch_scc0 L_ovf_n_5
  s_add_u32 s59, s61, s58
  s_add_u32 s59, s59, 65664
  s_branch L_role_done
L_ovf_n_5:
  s_sub_u32 s58, s58, s60
  v_readlane_b32 s61, v3, 5
  s_nop 0
  s_min_u32 s61, s61, 32
  s_sub_u32 s60, 32, s61
  s_cmp_lt_u32 s58, s60
  s_cbranch_scc0 L_ovf_n_6
  s_add_u32 s59, s61, s58
  s_add_u32 s59, s59, 65696
  s_branch L_role_done
L_ovf_n_6:
  s_sub_u32 s58, s58, s60
  v_readlane_b32 s61, v3, 6
  s_nop 0
  s_min_u32 s61, s61, 32
  s_sub_u32 s60, 32, s61
  s_cmp_lt_u32 s58, s60
  s_cbranch_scc0 L_ovf_n_7
  s_add_u32 s59, s61, s58
  s_add_u32 s59, s59, 65728
  s_branch L_role_done
L_ovf_n_7:
  s_sub_u32 s58, s58, s60
  v_readlane_b32 s61, v3, 7
  s_nop 0
  s_min_u32 s61, s61, 32
  s_sub_u32 s60, 32, s61
  s_cmp_lt_u32 s58, s60
  s_cbranch_scc0 L_ovf_n_8
  s_add_u32 s59, s61, s58
  s_add_u32 s59, s59, 65760
  s_branch L_role_done
L_ovf_n_8:
  s_sub_u32 s58, s58, s60
L_role_done:
  v_mov_b32 v2, 0
  v_mov_b32 v3, s59
  ds_write_b32 v2, v3
  s_waitcnt lgkmcnt(0)
  s_branch L_role_wait
L_warm:
  s_cmp_lg_u32 s3, 0
  s_cbranch_scc1 L_warm2
  s_bfe_u32 s60, s2, 0x50003
  s_mul_i32 s60, s60, 24576
  s_sub_u32 s61, s4, 1
  s_mul_i32 s61, s61, 8192
  s_add_u32 s60, s60, s61
  v_lshlrev_b32 v1, 4, v0
  buffer_load_dwordx4 v[252:255], v1, s[16:19], s60 offen offset:0
  buffer_load_dwordx4 v[252:255], v1, s[16:19], s60 offen offset:1024
  buffer_load_dwordx4 v[252:255], v1, s[16:19], s60 offen offset:2048
  buffer_load_dwordx4 v[252:255], v1, s[16:19], s60 offen offset:3072
  s_add_u32 s60, s60, 4096
  buffer_load_dwordx4 v[252:255], v1, s[16:19], s60 offen offset:0
  buffer_load_dwordx4 v[252:255], v1, s[16:19], s60 offen offset:1024
  buffer_load_dwordx4 v[252:255], v1, s[16:19], s60 offen offset:2048
  buffer_load_dwordx4 v[252:255], v1, s[16:19], s60 offen offset:3072
  s_add_u32 s60, s60, 4096
L_warm2:
L_role_wait:
  s_barrier
  v_mov_b32 v2, 0
  ds_read_b32 v3, v2
  s_waitcnt lgkmcnt(0)
  v_readfirstlane_b32 s59, v3
  s_barrier
  s_lshr_b32 s7, s59, 16
  s_bfe_u32 s5, s59, 0x80005
  s_and_b32 s6, s59, 31
  s_cmp_ge_u32 s5, 8
  s_cbranch_scc1 L_exit
  s_cmp_lg_u32 s5, 5
  s_cbranch_scc1 L_noclr_9
  s_cmp_lg_u32 s6, 0
  s_cbranch_scc1 L_noclr_9
  s_cmp_lg_u32 s4, 3
  s_cbranch_scc1 L_noclr_9
  v_lshlrev_b32 v1, 7, v0
  v_mov_b32 v2, 0
  s_mov_b32 s57, 0
  buffer_store_dword v2, v1, s[52:55], s57 offen sc1
  s_mov_b32 s57, 8192
  buffer_store_dword v2, v1, s[52:55], s57 offen sc1
  s_mov_b32 s57, 16384
  buffer_store_dword v2, v1, s[52:55], s57 offen sc1
  s_mov_b32 s57, 24576
  buffer_store_dword v2, v1, s[52:55], s57 offen sc1
  s_mov_b32 s57, 32768
  buffer_store_dword v2, v1, s[52:55], s57 offen sc1
  s_mov_b32 s57, 40960
  buffer_store_dword v2, v1, s[52:55], s57 offen sc1
  s_mov_b32 s57, 49152
  buffer_store_dword v2, v1, s[52:55], s57 offen sc1
  s_mov_b32 s57, 57344
  buffer_store_dword v2, v1, s[52:55], s57 offen sc1
  s_mov_b32 s57, 65536
  buffer_store_dword v2, v1, s[52:55], s57 offen sc1
  s_mov_b32 s57, 73728
  buffer_store_dword v2, v1, s[52:55], s57 offen sc1
  s_mov_b32 s57, 81920
  buffer_store_dword v2, v1, s[52:55], s57 offen sc1
  s_mov_b32 s57, 90112
  buffer_store_dword v2, v1, s[52:55], s57 offen sc1
  s_mov_b32 s57, 98304
  buffer_store_dword v2, v1, s[52:55], s57 offen sc1
  s_mov_b32 s57, 106496
  buffer_store_dword v2, v1, s[52:55], s57 offen sc1
  s_mov_b32 s57, 114688
  buffer_store_dword v2, v1, s[52:55], s57 offen sc1
  s_mov_b32 s57, 122880
  buffer_store_dword v2, v1, s[52:55], s57 offen sc1
  s_waitcnt vmcnt(0)
  v_mov_b32 v1, 228
  v_mov_b32 v2, 1
  s_mov_b64 exec, 1
  buffer_store_dword v2, v1, s[48:51], 0 offen sc1
  s_mov_b64 exec, -1
L_noclr_9:
  s_cmp_lt_u32 s5, 5
  s_cbranch_scc1 L_nowarm
  s_sub_u32 s60, s5, 5
  s_lshl_b32 s60, s60, 5
  s_add_u32 s60, s60, s6
  s_lshl_b32 s60, s60, 2
  s_add_u32 s60, s60, s4
  s_mul_i32 s60, s60, 11264
  v_lshlrev_b32 v1, 4, v0
  s_sub_u32 s61, s5, 5
  s_lshl_b32 s61, s61, 2
  s_add_u32 s61, s61, s4
  s_lshl_b32 s61, s61, 15
  s_lshl_b32 s62, s6, 10
  s_add_u32 s61, s61, s62
  buffer_load_dwordx4 v[252:255], v1, s[32:35], s61 offen
  s_add_u32 s61, s61, 393216
  buffer_load_dwordx4 v[252:255], v1, s[32:35], s61 offen
  s_add_u32 s61, s61, 393216
  buffer_load_dwordx4 v[252:255], v1, s[32:35], s61 offen
  s_add_u32 s61, s61, 393216
  buffer_load_dwordx4 v[252:255], v1, s[32:35], s61 offen
  s_add_u32 s61, s61, 393216
  buffer_load_dwordx4 v[252:255], v1, s[32:35], s61 offen
  s_add_u32 s61, s61, 393216
  buffer_load_dwordx4 v[252:255], v1, s[32:35], s61 offen
  s_add_u32 s61, s61, 393216
  s_mov_b32 s61, s60
  buffer_load_dwordx4 v[252:255], v1, s[16:19], s61 offen
  s_add_u32 s61, s61, 1024
  buffer_load_dwordx4 v[252:255], v1, s[16:19], s61 offen
  s_add_u32 s61, s61, 1024
  buffer_load_dwordx4 v[252:255], v1, s[16:19], s61 offen
  s_add_u32 s61, s61, 1024
  buffer_load_dwordx4 v[252:255], v1, s[16:19], s61 offen
  s_add_u32 s61, s61, 1024
  buffer_load_dwordx4 v[252:255], v1, s[16:19], s61 offen
  s_add_u32 s61, s61, 1024
  buffer_load_dwordx4 v[252:255], v1, s[16:19], s61 offen
  s_add_u32 s61, s61, 1024
  buffer_load_dwordx4 v[252:255], v1, s[16:19], s61 offen
  s_add_u32 s61, s61, 1024
  buffer_load_dwordx4 v[252:255], v1, s[16:19], s61 offen
  s_add_u32 s61, s61, 1024
  buffer_load_dwordx4 v[252:255], v1, s[16:19], s61 offen
  s_add_u32 s61, s61, 1024
  buffer_load_dwordx4 v[252:255], v1, s[16:19], s61 offen
  s_add_u32 s61, s61, 1024
  buffer_load_dwordx4 v[252:255], v1, s[16:19], s61 offen
  s_add_u32 s61, s61, 1024
  s_mov_b32 s61, s60
  buffer_load_dwordx4 v[252:255], v1, s[20:23], s61 offen
  s_add_u32 s61, s61, 1024
  buffer_load_dwordx4 v[252:255], v1, s[20:23], s61 offen
  s_add_u32 s61, s61, 1024
  buffer_load_dwordx4 v[252:255], v1, s[20:23], s61 offen
  s_add_u32 s61, s61, 1024
  buffer_load_dwordx4 v[252:255], v1, s[20:23], s61 offen
  s_add_u32 s61, s61, 1024
  buffer_load_dwordx4 v[252:255], v1, s[20:23], s61 offen
  s_add_u32 s61, s61, 1024
  buffer_load_dwordx4 v[252:255], v1, s[20:23], s61 offen
  s_add_u32 s61, s61, 1024
  buffer_load_dwordx4 v[252:255], v1, s[20:23], s61 offen
  s_add_u32 s61, s61, 1024
  buffer_load_dwordx4 v[252:255], v1, s[20:23], s61 offen
  s_add_u32 s61, s61, 1024
  buffer_load_dwordx4 v[252:255], v1, s[20:23], s61 offen
  s_add_u32 s61, s61, 1024
  buffer_load_dwordx4 v[252:255], v1, s[20:23], s61 offen
  s_add_u32 s61, s61, 1024
  buffer_load_dwordx4 v[252:255], v1, s[20:23], s61 offen
  s_add_u32 s61, s61, 1024
  s_mov_b32 s61, s60
  buffer_load_dwordx4 v[252:255], v1, s[24:27], s61 offen
  s_add_u32 s61, s61, 1024
  buffer_load_dwordx4 v[252:255], v1, s[24:27], s61 offen
  s_add_u32 s61, s61, 1024
  buffer_load_dwordx4 v[252:255], v1, s[24:27], s61 offen
  s_add_u32 s61, s61, 1024
  buffer_load_dwordx4 v[252:255], v1, s[24:27], s61 offen
  s_add_u32 s61, s61, 1024
  buffer_load_dwordx4 v[252:255], v1, s[24:27], s61 offen
  s_add_u32 s61, s61, 1024
  buffer_load_dwordx4 v[252:255], v1, s[24:27], s61 offen
  s_add_u32 s61, s61, 1024
  buffer_load_dwordx4 v[252:255], v1, s[24:27], s61 offen
  s_add_u32 s61, s61, 1024
  buffer_load_dwordx4 v[252:255], v1, s[24:27], s61 offen
  s_add_u32 s61, s61, 1024
  buffer_load_dwordx4 v[252:255], v1, s[24:27], s61 offen
  s_add_u32 s61, s61, 1024
  buffer_load_dwordx4 v[252:255], v1, s[24:27], s61 offen
  s_add_u32 s61, s61, 1024
  buffer_load_dwordx4 v[252:255], v1, s[24:27], s61 offen
  s_add_u32 s61, s61, 1024
  s_mov_b32 s61, s60
  buffer_load_dwordx4 v[252:255], v1, s[28:31], s61 offen
  s_add_u32 s61, s61, 1024
  buffer_load_dwordx4 v[252:255], v1, s[28:31], s61 offen
  s_add_u32 s61, s61, 1024
  buffer_load_dwordx4 v[252:255], v1, s[28:31], s61 offen
  s_add_u32 s61, s61, 1024
  buffer_load_dwordx4 v[252:255], v1, s[28:31], s61 offen
  s_add_u32 s61, s61, 1024
  buffer_load_dwordx4 v[252:255], v1, s[28:31], s61 offen
  s_add_u32 s61, s61, 1024
  buffer_load_dwordx4 v[252:255], v1, s[28:31], s61 offen
  s_add_u32 s61, s61, 1024
  buffer_load_dwordx4 v[252:255], v1, s[28:31], s61 offen
  s_add_u32 s61, s61, 1024
  buffer_load_dwordx4 v[252:255], v1, s[28:31], s61 offen
  s_add_u32 s61, s61, 1024
  buffer_load_dwordx4 v[252:255], v1, s[28:31], s61 offen
  s_add_u32 s61, s61, 1024
  buffer_load_dwordx4 v[252:255], v1, s[28:31], s61 offen
  s_add_u32 s61, s61, 1024
  buffer_load_dwordx4 v[252:255], v1, s[28:31], s61 offen
  s_add_u32 s61, s61, 1024
L_nowarm:
  s_cmp_eq_u32 s5, 0
  s_cbranch_scc1 L_chain
  s_cmp_ge_u32 s5, 5
  s_cbranch_scc1 L_bworker
L_aworker:
  s_and_b32 s60, s6, 1
  s_bfe_u32 s63, s6, 0x10001
  s_and_b32 s59, s6, 3
  s_lshr_b32 s61, s6, 2
  s_sub_u32 s62, s5, 1
  s_lshl_b32 s62, s62, 3
  s_add_u32 s6, s61, s62
  s_add_u32 s5, s59, 1
  v_lshrrev_b32 v1, 4, v0
  v_and_b32 v2, 15, v0
  v_lshlrev_b32 v3, 1, v1
  v_xor_b32 v2, v2, v3
  v_lshlrev_b32 v2, 4, v2
  v_lshl_add_u32 v2, v1, 13, v2
  s_lshl_b32 s64, s6, 8
  s_lshl_b32 s65, s4, 17
  s_add_u32 s64, s64, s65
  v_add_u32 v104, s64, v2
  v_xor_b32 v105, 0x80, v104
  s_lshl_b32 s64, s4, 12
  s_add_u32 s64, s64, 32768
  s_add_u32 m0, s64, 0
  s_mov_b32 s65, 0
  buffer_load_dwordx4 v104, s[20:23], s65 offen lds
  s_add_u32 m0, s64, 1024
  s_mov_b32 s65, 32768
  buffer_load_dwordx4 v104, s[20:23], s65 offen lds
  s_add_u32 m0, s64, 2048
  s_mov_b32 s65, 65536
  buffer_load_dwordx4 v105, s[20:23], s65 offen lds
  s_add_u32 m0, s64, 3072
  s_mov_b32 s65, 98304
  buffer_load_dwordx4 v105, s[20:23], s65 offen lds
  s_add_u32 m0, s64, 16384
  s_mov_b32 s65, 524288
  buffer_load_dwordx4 v104, s[20:23], s65 offen lds
  s_add_u32 m0, s64, 17408
  s_mov_b32 s65, 557056
  buffer_load_dwordx4 v104, s[20:23], s65 offen lds
  s_add_u32 m0, s64, 18432
  s_mov_b32 s65, 589824
  buffer_load_dwordx4 v105, s[20:23], s65 offen lds
  s_add_u32 m0, s64, 19456
  s_mov_b32 s65, 622592
  buffer_load_dwordx4 v105, s[20:23], s65 offen lds
  s_add_u32 m0, s64, 32768
  s_mov_b32 s65, 1048576
  buffer_load_dwordx4 v104, s[20:23], s65 offen lds
  s_add_u32 m0, s64, 33792
  s_mov_b32 s65, 1081344
  buffer_load_dwordx4 v104, s[20:23], s65 offen lds
  s_add_u32 m0, s64, 34816
  s_mov_b32 s65, 1114112
  buffer_load_dwordx4 v105, s[20:23], s65 offen lds
  s_add_u32 m0, s64, 35840
  s_mov_b32 s65, 1146880
  buffer_load_dwordx4 v105, s[20:23], s65 offen lds
  s_add_u32 m0, s64, 49152
  s_mov_b32 s65, 1572864
  buffer_load_dwordx4 v104, s[20:23], s65 offen lds
  s_add_u32 m0, s64, 50176
  s_mov_b32 s65, 1605632
  buffer_load_dwordx4 v104, s[20:23], s65 offen lds
  s_add_u32 m0, s64, 51200
  s_mov_b32 s65, 1638400
  buffer_load_dwordx4 v105, s[20:23], s65 offen lds
  s_add_u32 m0, s64, 52224
  s_mov_b32 s65, 1671168
  buffer_load_dwordx4 v105, s[20:23], s65 offen lds
  s_add_u32 m0, s64, 65536
  s_mov_b32 s65, 2097152
  buffer_load_dwordx4 v104, s[20:23], s65 offen lds
  s_add_u32 m0, s64, 66560
  s_mov_b32 s65, 2129920
  buffer_load_dwordx4 v104, s[20:23], s65 offen lds
  s_add_u32 m0, s64, 67584
  s_mov_b32 s65, 2162688
  buffer_load_dwordx4 v105, s[20:23], s65 offen lds
  s_add_u32 m0, s64, 68608
  s_mov_b32 s65, 2195456
  buffer_load_dwordx4 v105, s[20:23], s65 offen lds
  s_add_u32 m0, s64, 81920
  s_mov_b32 s65, 2621440
  buffer_load_dwordx4 v104, s[20:23], s65 offen lds
  s_add_u32 m0, s64, 82944
  s_mov_b32 s65, 2654208
  buffer_load_dwordx4 v104, s[20:23], s65 offen lds
  s_add_u32 m0, s64, 83968
  s_mov_b32 s65, 2686976
  buffer_load_dwordx4 v105, s[20:23], s65 offen lds
  s_add_u32 m0, s64, 84992
  s_mov_b32 s65, 2719744
  buffer_load_dwordx4 v105, s[20:23], s65 offen lds
  s_add_u32 m0, s64, 98304
  s_mov_b32 s65, 3145728
  buffer_load_dwordx4 v104, s[20:23], s65 offen lds
  s_add_u32 m0, s64, 99328
  s_mov_b32 s65, 3178496
  buffer_load_dwordx4 v104, s[20:23], s65 offen lds
  s_add_u32 m0, s64, 100352
  s_mov_b32 s65, 3211264
  buffer_load_dwordx4 v105, s[20:23], s65 offen lds
  s_add_u32 m0, s64, 101376
  s_mov_b32 s65, 3244032
  buffer_load_dwordx4 v105, s[20:23], s65 offen lds
  s_add_u32 m0, s64, 114688
  s_mov_b32 s65, 3670016
  buffer_load_dwordx4 v104, s[20:23], s65 offen lds
  s_add_u32 m0, s64, 115712
  s_mov_b32 s65, 3702784
  buffer_load_dwordx4 v104, s[20:23], s65 offen lds
  s_add_u32 m0, s64, 116736
  s_mov_b32 s65, 3735552
  buffer_load_dwordx4 v105, s[20:23], s65 offen lds
  s_add_u32 m0, s64, 117760
  s_mov_b32 s65, 3768320
  buffer_load_dwordx4 v105, s[20:23], s65 offen lds
  v_lshrrev_b32 v1, 4, v0
  v_bfe_u32 v2, v0, 2, 2
  v_lshl_add_u32 v3, v1, 3, v2
  v_lshlrev_b32 v106, 8, v3
  v_and_b32 v1, 1, v1
  v_lshlrev_b32 v1, 3, v1
  v_lshl_add_u32 v1, v2, 1, v1
  v_bfe_u32 v2, v0, 1, 1
  s_lshl_b32 s65, s4, 2
  v_add_u32 v2, s65, v2
  v_xor_b32 v1, v1, v2
  v_lshl_add_u32 v106, v1, 4, v106
  v_and_b32 v1, 1, v0
  v_lshl_add_u32 v106, v1, 3, v106
  v_add_u32 v106, 32768, v106
  v_xor_b32 v107, 32, v106
  v_add_u32 v108, 0x10000, v106
  v_add_u32 v109, 0x10000, v107
  s_cmp_eq_u32 s63, 0
  s_cbranch_scc1 L_p_start
  s_waitcnt vmcnt(28) lgkmcnt(0)
  s_barrier
  ds_read_b64_tr_b16 a[0:1], v106 offset:0
  ds_read_b64_tr_b16 a[2:3], v106 offset:1024
  ds_read_b64_tr_b16 a[4:5], v106 offset:8192
  ds_read_b64_tr_b16 a[6:7], v106 offset:9216
  ds_read_b64_tr_b16 a[64:65], v107 offset:0
  ds_read_b64_tr_b16 a[66:67], v107 offset:1024
  ds_read_b64_tr_b16 a[68:69], v107 offset:8192
  ds_read_b64_tr_b16 a[70:71], v107 offset:9216
  s_waitcnt vmcnt(24) lgkmcnt(0)
  s_barrier
  s_add_u32 m0, s64, 0
  s_mov_b32 s65, 0
  buffer_load_dwordx4 v104, s[24:27], s65 offen lds
  s_add_u32 m0, s64, 1024
  s_mov_b32 s65, 32768
  buffer_load_dwordx4 v104, s[24:27], s65 offen lds
  s_add_u32 m0, s64, 2048
  s_mov_b32 s65, 65536
  buffer_load_dwordx4 v105, s[24:27], s65 offen lds
  s_add_u32 m0, s64, 3072
  s_mov_b32 s65, 98304
  buffer_load_dwordx4 v105, s[24:27], s65 offen lds
  ds_read_b64_tr_b16 a[8:9], v106 offset:16384
  ds_read_b64_tr_b16 a[10:11], v106 offset:17408
  ds_read_b64_tr_b16 a[12:13], v106 offset:24576
  ds_read_b64_tr_b16 a[14:15], v106 offset:25600
  ds_read_b64_tr_b16 a[72:73], v107 offset:16384
  ds_read_b64_tr_b16 a[74:75], v107 offset:17408
  ds_read_b64_tr_b16 a[76:77], v107 offset:24576
  ds_read_b64_tr_b16 a[78:79], v107 offset:25600
  s_waitcnt vmcnt(24) lgkmcnt(0)
  s_barrier
  s_add_u32 m0, s64, 16384
  s_mov_b32 s65, 524288
  buffer_load_dwordx4 v104, s[24:27], s65 offen lds
  s_add_u32 m0, s64, 17408
  s_mov_b32 s65, 557056
  buffer_load_dwordx4 v104, s[24:27], s65 offen lds
  s_add_u32 m0, s64, 18432
  s_mov_b32 s65, 589824
  buffer_load_dwordx4 v105, s[24:27], s65 offen lds
  s_add_u32 m0, s64, 19456
  s_mov_b32 s65, 622592
  buffer_load_dwordx4 v105, s[24:27], s65 offen lds
  ds_read_b64_tr_b16 a[16:17], v106 offset:32768
  ds_read_b64_tr_b16 a[18:19], v106 offset:33792
  ds_read_b64_tr_b16 a[20:21], v106 offset:40960
  ds_read_b64_tr_b16 a[22:23], v106 offset:41984
  ds_read_b64_tr_b16 a[80:81], v107 offset:32768
  ds_read_b64_tr_b16 a[82:83], v107 offset:33792
  ds_read_b64_tr_b16 a[84:85], v107 offset:40960
  ds_read_b64_tr_b16 a[86:87], v107 offset:41984
  s_waitcnt vmcnt(24) lgkmcnt(0)
  s_barrier
  s_add_u32 m0, s64, 32768
  s_mov_b32 s65, 1048576
  buffer_load_dwordx4 v104, s[24:27], s65 offen lds
  s_add_u32 m0, s64, 33792
  s_mov_b32 s65, 1081344
  buffer_load_dwordx4 v104, s[24:27], s65 offen lds
  s_add_u32 m0, s64, 34816
  s_mov_b32 s65, 1114112
  buffer_load_dwordx4 v105, s[24:27], s65 offen lds
  s_add_u32 m0, s64, 35840
  s_mov_b32 s65, 1146880
  buffer_load_dwordx4 v105, s[24:27], s65 offen lds
  ds_read_b64_tr_b16 a[24:25], v106 offset:49152
  ds_read_b64_tr_b16 a[26:27], v106 offset:50176
  ds_read_b64_tr_b16 a[28:29], v106 offset:57344
  ds_read_b64_tr_b16 a[30:31], v106 offset:58368
  ds_read_b64_tr_b16 a[88:89], v107 offset:49152
  ds_read_b64_tr_b16 a[90:91], v107 offset:50176
  ds_read_b64_tr_b16 a[92:93], v107 offset:57344
  ds_read_b64_tr_b16 a[94:95], v107 offset:58368
  s_waitcnt vmcnt(24) lgkmcnt(0)
  s_barrier
  s_add_u32 m0, s64, 49152
  s_mov_b32 s65, 1572864
  buffer_load_dwordx4 v104, s[24:27], s65 offen lds
  s_add_u32 m0, s64, 50176
  s_mov_b32 s65, 1605632
  buffer_load_dwordx4 v104, s[24:27], s65 offen lds
  s_add_u32 m0, s64, 51200
  s_mov_b32 s65, 1638400
  buffer_load_dwordx4 v105, s[24:27], s65 offen lds
  s_add_u32 m0, s64, 52224
  s_mov_b32 s65, 1671168
  buffer_load_dwordx4 v105, s[24:27], s65 offen lds
  ds_read_b64_tr_b16 a[32:33], v108 offset:0
  ds_read_b64_tr_b16 a[34:35], v108 offset:1024
  ds_read_b64_tr_b16 a[36:37], v108 offset:8192
  ds_read_b64_tr_b16 a[38:39], v108 offset:9216
  ds_read_b64_tr_b16 a[96:97], v109 offset:0
  ds_read_b64_tr_b16 a[98:99], v109 offset:1024
  ds_read_b64_tr_b16 a[100:101], v109 offset:8192
  ds_read_b64_tr_b16 a[102:103], v109 offset:9216
  s_waitcnt vmcnt(24) lgkmcnt(0)
  s_barrier
  s_add_u32 m0, s64, 65536
  s_mov_b32 s65, 2097152
  buffer_load_dwordx4 v104, s[24:27], s65 offen lds
  s_add_u32 m0, s64, 66560
  s_mov_b32 s65, 2129920
  buffer_load_dwordx4 v104, s[24:27], s65 offen lds
  s_add_u32 m0, s64, 67584
  s_mov_b32 s65, 2162688
  buffer_load_dwordx4 v105, s[24:27], s65 offen lds
  s_add_u32 m0, s64, 68608
  s_mov_b32 s65, 2195456
  buffer_load_dwordx4 v105, s[24:27], s65 offen lds
  ds_read_b64_tr_b16 a[40:41], v108 offset:16384
  ds_read_b64_tr_b16 a[42:43], v108 offset:17408
  ds_read_b64_tr_b16 a[44:45], v108 offset:24576
  ds_read_b64_tr_b16 a[46:47], v108 offset:25600
  ds_read_b64_tr_b16 a[104:105], v109 offset:16384
  ds_read_b64_tr_b16 a[106:107], v109 offset:17408
  ds_read_b64_tr_b16 a[108:109], v109 offset:24576
  ds_read_b64_tr_b16 a[110:111], v109 offset:25600
  s_waitcnt vmcnt(24) lgkmcnt(0)
  s_barrier
  s_add_u32 m0, s64, 81920
  s_mov_b32 s65, 2621440
  buffer_load_dwordx4 v104, s[24:27], s65 offen lds
  s_add_u32 m0, s64, 82944
  s_mov_b32 s65, 2654208
  buffer_load_dwordx4 v104, s[24:27], s65 offen lds
  s_add_u32 m0, s64, 83968
  s_mov_b32 s65, 2686976
  buffer_load_dwordx4 v105, s[24:27], s65 offen lds
  s_add_u32 m0, s64, 84992
  s_mov_b32 s65, 2719744
  buffer_load_dwordx4 v105, s[24:27], s65 offen lds
  ds_read_b64_tr_b16 a[48:49], v108 offset:32768
  ds_read_b64_tr_b16 a[50:51], v108 offset:33792
  ds_read_b64_tr_b16 a[52:53], v108 offset:40960
  ds_read_b64_tr_b16 a[54:55], v108 offset:41984
  ds_read_b64_tr_b16 a[112:113], v109 offset:32768
  ds_read_b64_tr_b16 a[114:115], v109 offset:33792
  ds_read_b64_tr_b16 a[116:117], v109 offset:40960
  ds_read_b64_tr_b16 a[118:119], v109 offset:41984
  s_waitcnt vmcnt(24) lgkmcnt(0)
  s_barrier
  s_add_u32 m0, s64, 98304
  s_mov_b32 s65, 3145728
  buffer_load_dwordx4 v104, s[24:27], s65 offen lds
  s_add_u32 m0, s64, 99328
  s_mov_b32 s65, 3178496
  buffer_load_dwordx4 v104, s[24:27], s65 offen lds
  s_add_u32 m0, s64, 100352
  s_mov_b32 s65, 3211264
  buffer_load_dwordx4 v105, s[24:27], s65 offen lds
  s_add_u32 m0, s64, 101376
  s_mov_b32 s65, 3244032
  buffer_load_dwordx4 v105, s[24:27], s65 offen lds
  ds_read_b64_tr_b16 a[56:57], v108 offset:49152
  ds_read_b64_tr_b16 a[58:59], v108 offset:50176
  ds_read_b64_tr_b16 a[60:61], v108 offset:57344
  ds_read_b64_tr_b16 a[62:63], v108 offset:58368
  ds_read_b64_tr_b16 a[120:121], v109 offset:49152
  ds_read_b64_tr_b16 a[122:123], v109 offset:50176
  ds_read_b64_tr_b16 a[124:125], v109 offset:57344
  ds_read_b64_tr_b16 a[126:127], v109 offset:58368
  s_waitcnt vmcnt(24) lgkmcnt(0)
  s_barrier
  s_add_u32 m0, s64, 114688
  s_mov_b32 s65, 3670016
  buffer_load_dwordx4 v104, s[24:27], s65 offen lds
  s_add_u32 m0, s64, 115712
  s_mov_b32 s65, 3702784
  buffer_load_dwordx4 v104, s[24:27], s65 offen lds
  s_add_u32 m0, s64, 116736
  s_mov_b32 s65, 3735552
  buffer_load_dwordx4 v105, s[24:27], s65 offen lds
  s_add_u32 m0, s64, 117760
  s_mov_b32 s65, 3768320
  buffer_load_dwordx4 v105, s[24:27], s65 offen lds
  ds_read_b64_tr_b16 a[128:129], v106 offset:0
  ds_read_b64_tr_b16 a[130:131], v106 offset:1024
  ds_read_b64_tr_b16 a[132:133], v106 offset:8192
  ds_read_b64_tr_b16 a[134:135], v106 offset:9216
  ds_read_b64_tr_b16 a[192:193], v107 offset:0
  ds_read_b64_tr_b16 a[194:195], v107 offset:1024
  ds_read_b64_tr_b16 a[196:197], v107 offset:8192
  ds_read_b64_tr_b16 a[198:199], v107 offset:9216
  s_waitcnt vmcnt(24) lgkmcnt(0)
  s_barrier
  ds_read_b64_tr_b16 a[136:137], v106 offset:16384
  ds_read_b64_tr_b16 a[138:139], v106 offset:17408
  ds_read_b64_tr_b16 a[140:141], v106 offset:24576
  ds_read_b64_tr_b16 a[142:143], v106 offset:25600
  ds_read_b64_tr_b16 a[200:201], v107 offset:16384
  ds_read_b64_tr_b16 a[202:203], v107 offset:17408
  ds_read_b64_tr_b16 a[204:205], v107 offset:24576
  ds_read_b64_tr_b16 a[206:207], v107 offset:25600
  s_waitcnt vmcnt(20) lgkmcnt(0)
  s_barrier
  ds_read_b64_tr_b16 a[144:145], v106 offset:32768
  ds_read_b64_tr_b16 a[146:147], v106 offset:33792
  ds_read_b64_tr_b16 a[148:149], v106 offset:40960
  ds_read_b64_tr_b16 a[150:151], v106 offset:41984
  ds_read_b64_tr_b16 a[208:209], v107 offset:32768
  ds_read_b64_tr_b16 a[210:211], v107 offset:33792
  ds_read_b64_tr_b16 a[212:213], v107 offset:40960
  ds_read_b64_tr_b16 a[214:215], v107 offset:41984
  s_waitcnt vmcnt(16) lgkmcnt(0)
  s_barrier
  ds_read_b64_tr_b16 a[152:153], v106 offset:49152
  ds_read_b64_tr_b16 a[154:155], v106 offset:50176
  ds_read_b64_tr_b16 a[156:157], v106 offset:57344
  ds_read_b64_tr_b16 a[158:159], v106 offset:58368
  ds_read_b64_tr_b16 a[216:217], v107 offset:49152
  ds_read_b64_tr_b16 a[218:219], v107 offset:50176
  ds_read_b64_tr_b16 a[220:221], v107 offset:57344
  ds_read_b64_tr_b16 a[222:223], v107 offset:58368
  s_waitcnt vmcnt(12) lgkmcnt(0)
  s_barrier
  ds_read_b64_tr_b16 a[160:161], v108 offset:0
  ds_read_b64_tr_b16 a[162:163], v108 offset:1024
  ds_read_b64_tr_b16 a[164:165], v108 offset:8192
  ds_read_b64_tr_b16 a[166:167], v108 offset:9216
  ds_read_b64_tr_b16 a[224:225], v109 offset:0
  ds_read_b64_tr_b16 a[226:227], v109 offset:1024
  ds_read_b64_tr_b16 a[228:229], v109 offset:8192
  ds_read_b64_tr_b16 a[230:231], v109 offset:9216
  s_waitcnt vmcnt(8) lgkmcnt(0)
  s_barrier
  ds_read_b64_tr_b16 a[168:169], v108 offset:16384
  ds_read_b64_tr_b16 a[170:171], v108 offset:17408
  ds_read_b64_tr_b16 a[172:173], v108 offset:24576
  ds_read_b64_tr_b16 a[174:175], v108 offset:25600
  ds_read_b64_tr_b16 a[232:233], v109 offset:16384
  ds_read_b64_tr_b16 a[234:235], v109 offset:17408
  ds_read_b64_tr_b16 a[236:237], v109 offset:24576
  ds_read_b64_tr_b16 a[238:239], v109 offset:25600
  s_waitcnt vmcnt(4) lgkmcnt(0)
  s_barrier
  ds_read_b64_tr_b16 a[176:177], v108 offset:32768
  ds_read_b64_tr_b16 a[178:179], v108 offset:33792
  ds_read_b64_tr_b16 a[180:181], v108 offset:40960
  ds_read_b64_tr_b16 a[182:183], v108 offset:41984
  ds_read_b64_tr_b16 a[240:241], v109 offset:32768
  ds_read_b64_tr_b16 a[242:243], v109 offset:33792
  ds_read_b64_tr_b16 a[244:245], v109 offset:40960
  ds_read_b64_tr_b16 a[246:247], v109 offset:41984
  s_waitcnt vmcnt(0) lgkmcnt(0)
  s_barrier
  ds_read_b64_tr_b16 a[184:185], v108 offset:49152
  ds_read_b64_tr_b16 a[186:187], v108 offset:50176
  ds_read_b64_tr_b16 a[188:189], v108 offset:57344
  ds_read_b64_tr_b16 a[190:191], v108 offset:58368
  ds_read_b64_tr_b16 a[248:249], v109 offset:49152
  ds_read_b64_tr_b16 a[250:251], v109 offset:50176
  ds_read_b64_tr_b16 a[252:253], v109 offset:57344
  ds_read_b64_tr_b16 a[254:255], v109 offset:58368
  s_waitcnt lgkmcnt(0)
  s_mov_b32 s59, s60
  s_mov_b32 s78, s60
  s_branch L_o_start
L_p_start:
  v_lshlrev_b32 v8, 4, v0
  s_and_b32 s69, s4, 1
  s_lshl_b32 s69, s69, 7
  v_xor_b32 v110, s69, v8
  v_xor_b32 v111, 16, v110
  v_xor_b32 v112, 32, v110
  v_xor_b32 v113, 48, v110
  v_xor_b32 v114, 64, v110
  v_xor_b32 v115, 80, v110
  v_xor_b32 v116, 96, v110
  v_xor_b32 v117, 112, v110
  v_and_b32 v1, 15, v0
  v_lshrrev_b32 v2, 4, v0
  v_xor_b32 v2, v2, v1
  v_lshlrev_b32 v2, 4, v2
  v_lshl_add_u32 v4, v1, 10, v2
  v_xor_b32 v5, 64, v4
  v_xor_b32 v6, 128, v4
  v_xor_b32 v7, 192, v4
  s_lshl_b32 s68, s6, 13
  s_lshl_b32 s69, s4, 10
  s_add_u32 s68, s68, s69
  v_add_u32 v9, s68, v8
  v_add_u32 v10, s69, v9
  s_lshl_b32 s68, s60, 5
  s_add_u32 s68, s68, s6
  s_lshl_b32 s68, s68, 7
  v_mov_b32 v11, s68
  s_lshl_b32 s70, s4, 13
  s_lshl_b32 s71, s60, 15
  s_add_u32 s71, s71, s70
  s_add_u32 m0, s70, 0
  s_add_u32 s69, s71, 0
  buffer_load_dwordx4 v110, s[8:11], s69 offen lds
  s_add_u32 m0, s70, 1024
  s_add_u32 s69, s71, 1024
  buffer_load_dwordx4 v111, s[8:11], s69 offen lds
  s_add_u32 m0, s70, 2048
  s_add_u32 s69, s71, 2048
  buffer_load_dwordx4 v112, s[8:11], s69 offen lds
  s_add_u32 m0, s70, 3072
  s_add_u32 s69, s71, 3072
  buffer_load_dwordx4 v113, s[8:11], s69 offen lds
  s_add_u32 m0, s70, 4096
  s_add_u32 s69, s71, 4096
  buffer_load_dwordx4 v114, s[8:11], s69 offen lds
  s_add_u32 m0, s70, 5120
  s_add_u32 s69, s71, 5120
  buffer_load_dwordx4 v115, s[8:11], s69 offen lds
  s_add_u32 m0, s70, 6144
  s_add_u32 s69, s71, 6144
  buffer_load_dwordx4 v116, s[8:11], s69 offen lds
  s_add_u32 m0, s70, 7168
  s_add_u32 s69, s71, 7168
  buffer_load_dwordx4 v117, s[8:11], s69 offen lds
  s_waitcnt vmcnt(36) lgkmcnt(0)
  s_barrier
  ds_read_b64_tr_b16 a[0:1], v106 offset:0
  ds_read_b64_tr_b16 a[2:3], v106 offset:1024
  ds_read_b64_tr_b16 a[4:5], v106 offset:8192
  ds_read_b64_tr_b16 a[6:7], v106 offset:9216
  ds_read_b64_tr_b16 a[64:65], v107 offset:0
  ds_read_b64_tr_b16 a[66:67], v107 offset:1024
  ds_read_b64_tr_b16 a[68:69], v107 offset:8192
  ds_read_b64_tr_b16 a[70:71], v107 offset:9216
  s_waitcnt vmcnt(32) lgkmcnt(0)
  s_barrier
  s_add_u32 m0, s64, 0
  s_mov_b32 s65, 0
  buffer_load_dwordx4 v104, s[24:27], s65 offen lds
  s_add_u32 m0, s64, 1024
  s_mov_b32 s65, 32768
  buffer_load_dwordx4 v104, s[24:27], s65 offen lds
  s_add_u32 m0, s64, 2048
  s_mov_b32 s65, 65536
  buffer_load_dwordx4 v105, s[24:27], s65 offen lds
  s_add_u32 m0, s64, 3072
  s_mov_b32 s65, 98304
  buffer_load_dwordx4 v105, s[24:27], s65 offen lds
  ds_read_b64_tr_b16 a[8:9], v106 offset:16384
  ds_read_b64_tr_b16 a[10:11], v106 offset:17408
  ds_read_b64_tr_b16 a[12:13], v106 offset:24576
  ds_read_b64_tr_b16 a[14:15], v106 offset:25600
  ds_read_b64_tr_b16 a[72:73], v107 offset:16384
  ds_read_b64_tr_b16 a[74:75], v107 offset:17408
  ds_read_b64_tr_b16 a[76:77], v107 offset:24576
  ds_read_b64_tr_b16 a[78:79], v107 offset:25600
  s_waitcnt vmcnt(32) lgkmcnt(0)
  s_barrier
  s_add_u32 m0, s64, 16384
  s_mov_b32 s65, 524288
  buffer_load_dwordx4 v104, s[24:27], s65 offen lds
  s_add_u32 m0, s64, 17408
  s_mov_b32 s65, 557056
  buffer_load_dwordx4 v104, s[24:27], s65 offen lds
  s_add_u32 m0, s64, 18432
  s_mov_b32 s65, 589824
  buffer_load_dwordx4 v105, s[24:27], s65 offen lds
  s_add_u32 m0, s64, 19456
  s_mov_b32 s65, 622592
  buffer_load_dwordx4 v105, s[24:27], s65 offen lds
  ds_read_b64_tr_b16 a[16:17], v106 offset:32768
  ds_read_b64_tr_b16 a[18:19], v106 offset:33792
  ds_read_b64_tr_b16 a[20:21], v106 offset:40960
  ds_read_b64_tr_b16 a[22:23], v106 offset:41984
  ds_read_b64_tr_b16 a[80:81], v107 offset:32768
  ds_read_b64_tr_b16 a[82:83], v107 offset:33792
  ds_read_b64_tr_b16 a[84:85], v107 offset:40960
  ds_read_b64_tr_b16 a[86:87], v107 offset:41984
  s_waitcnt vmcnt(32) lgkmcnt(0)
  s_barrier
  s_add_u32 m0, s64, 32768
  s_mov_b32 s65, 1048576
  buffer_load_dwordx4 v104, s[24:27], s65 offen lds
  s_add_u32 m0, s64, 33792
  s_mov_b32 s65, 1081344
  buffer_load_dwordx4 v104, s[24:27], s65 offen lds
  s_add_u32 m0, s64, 34816
  s_mov_b32 s65, 1114112
  buffer_load_dwordx4 v105, s[24:27], s65 offen lds
  s_add_u32 m0, s64, 35840
  s_mov_b32 s65, 1146880
  buffer_load_dwordx4 v105, s[24:27], s65 offen lds
  ds_read_b64_tr_b16 a[24:25], v106 offset:49152
  ds_read_b64_tr_b16 a[26:27], v106 offset:50176
  ds_read_b64_tr_b16 a[28:29], v106 offset:57344
  ds_read_b64_tr_b16 a[30:31], v106 offset:58368
  ds_read_b64_tr_b16 a[88:89], v107 offset:49152
  ds_read_b64_tr_b16 a[90:91], v107 offset:50176
  ds_read_b64_tr_b16 a[92:93], v107 offset:57344
  ds_read_b64_tr_b16 a[94:95], v107 offset:58368
  s_waitcnt vmcnt(32) lgkmcnt(0)
  s_barrier
  s_add_u32 m0, s64, 49152
  s_mov_b32 s65, 1572864
  buffer_load_dwordx4 v104, s[24:27], s65 offen lds
  s_add_u32 m0, s64, 50176
  s_mov_b32 s65, 1605632
  buffer_load_dwordx4 v104, s[24:27], s65 offen lds
  s_add_u32 m0, s64, 51200
  s_mov_b32 s65, 1638400
  buffer_load_dwordx4 v105, s[24:27], s65 offen lds
  s_add_u32 m0, s64, 52224
  s_mov_b32 s65, 1671168
  buffer_load_dwordx4 v105, s[24:27], s65 offen lds
  ds_read_b64_tr_b16 a[32:33], v108 offset:0
  ds_read_b64_tr_b16 a[34:35], v108 offset:1024
  ds_read_b64_tr_b16 a[36:37], v108 offset:8192
  ds_read_b64_tr_b16 a[38:39], v108 offset:9216
  ds_read_b64_tr_b16 a[96:97], v109 offset:0
  ds_read_b64_tr_b16 a[98:99], v109 offset:1024
  ds_read_b64_tr_b16 a[100:101], v109 offset:8192
  ds_read_b64_tr_b16 a[102:103], v109 offset:9216
  s_waitcnt vmcnt(32) lgkmcnt(0)
  s_barrier
  s_add_u32 m0, s64, 65536
  s_mov_b32 s65, 2097152
  buffer_load_dwordx4 v104, s[24:27], s65 offen lds
  s_add_u32 m0, s64, 66560
  s_mov_b32 s65, 2129920
  buffer_load_dwordx4 v104, s[24:27], s65 offen lds
  s_add_u32 m0, s64, 67584
  s_mov_b32 s65, 2162688
  buffer_load_dwordx4 v105, s[24:27], s65 offen lds
  s_add_u32 m0, s64, 68608
  s_mov_b32 s65, 2195456
  buffer_load_dwordx4 v105, s[24:27], s65 offen lds
  ds_read_b64_tr_b16 a[40:41], v108 offset:16384
  ds_read_b64_tr_b16 a[42:43], v108 offset:17408
  ds_read_b64_tr_b16 a[44:45], v108 offset:24576
  ds_read_b64_tr_b16 a[46:47], v108 offset:25600
  ds_read_b64_tr_b16 a[104:105], v109 offset:16384
  ds_read_b64_tr_b16 a[106:107], v109 offset:17408
  ds_read_b64_tr_b16 a[108:109], v109 offset:24576
  ds_read_b64_tr_b16 a[110:111], v109 offset:25600
  s_waitcnt vmcnt(32) lgkmcnt(0)
  s_barrier
  s_add_u32 m0, s64, 81920
  s_mov_b32 s65, 2621440
  buffer_load_dwordx4 v104, s[24:27], s65 offen lds
  s_add_u32 m0, s64, 82944
  s_mov_b32 s65, 2654208
  buffer_load_dwordx4 v104, s[24:27], s65 offen lds
  s_add_u32 m0, s64, 83968
  s_mov_b32 s65, 2686976
  buffer_load_dwordx4 v105, s[24:27], s65 offen lds
  s_add_u32 m0, s64, 84992
  s_mov_b32 s65, 2719744
  buffer_load_dwordx4 v105, s[24:27], s65 offen lds
  ds_read_b64_tr_b16 a[48:49], v108 offset:32768
  ds_read_b64_tr_b16 a[50:51], v108 offset:33792
  ds_read_b64_tr_b16 a[52:53], v108 offset:40960
  ds_read_b64_tr_b16 a[54:55], v108 offset:41984
  ds_read_b64_tr_b16 a[112:113], v109 offset:32768
  ds_read_b64_tr_b16 a[114:115], v109 offset:33792
  ds_read_b64_tr_b16 a[116:117], v109 offset:40960
  ds_read_b64_tr_b16 a[118:119], v109 offset:41984
  s_waitcnt vmcnt(32) lgkmcnt(0)
  s_barrier
  s_add_u32 m0, s64, 98304
  s_mov_b32 s65, 3145728
  buffer_load_dwordx4 v104, s[24:27], s65 offen lds
  s_add_u32 m0, s64, 99328
  s_mov_b32 s65, 3178496
  buffer_load_dwordx4 v104, s[24:27], s65 offen lds
  s_add_u32 m0, s64, 100352
  s_mov_b32 s65, 3211264
  buffer_load_dwordx4 v105, s[24:27], s65 offen lds
  s_add_u32 m0, s64, 101376
  s_mov_b32 s65, 3244032
  buffer_load_dwordx4 v105, s[24:27], s65 offen lds
  ds_read_b64_tr_b16 a[56:57], v108 offset:49152
  ds_read_b64_tr_b16 a[58:59], v108 offset:50176
  ds_read_b64_tr_b16 a[60:61], v108 offset:57344
  ds_read_b64_tr_b16 a[62:63], v108 offset:58368
  ds_read_b64_tr_b16 a[120:121], v109 offset:49152
  ds_read_b64_tr_b16 a[122:123], v109 offset:50176
  ds_read_b64_tr_b16 a[124:125], v109 offset:57344
  ds_read_b64_tr_b16 a[126:127], v109 offset:58368
  s_waitcnt vmcnt(24) lgkmcnt(0)
  s_barrier
  s_add_u32 m0, s64, 114688
  s_mov_b32 s65, 3670016
  buffer_load_dwordx4 v104, s[24:27], s65 offen lds
  s_add_u32 m0, s64, 115712
  s_mov_b32 s65, 3702784
  buffer_load_dwordx4 v104, s[24:27], s65 offen lds
  s_add_u32 m0, s64, 116736
  s_mov_b32 s65, 3735552
  buffer_load_dwordx4 v105, s[24:27], s65 offen lds
  s_add_u32 m0, s64, 117760
  s_mov_b32 s65, 3768320
  buffer_load_dwordx4 v105, s[24:27], s65 offen lds
  ds_read_b64_tr_b16 a[128:129], v106 offset:0
  ds_read_b64_tr_b16 a[130:131], v106 offset:1024
  ds_read_b64_tr_b16 a[132:133], v106 offset:8192
  ds_read_b64_tr_b16 a[134:135], v106 offset:9216
  ds_read_b64_tr_b16 a[192:193], v107 offset:0
  ds_read_b64_tr_b16 a[194:195], v107 offset:1024
  ds_read_b64_tr_b16 a[196:197], v107 offset:8192
  ds_read_b64_tr_b16 a[198:199], v107 offset:9216
  s_waitcnt vmcnt(24) lgkmcnt(0)
  s_barrier
  s_add_u32 m0, s64, 0
  s_mov_b32 s65, 0
  buffer_load_dwordx4 v104, s[16:19], s65 offen lds
  s_add_u32 m0, s64, 1024
  s_mov_b32 s65, 32768
  buffer_load_dwordx4 v104, s[16:19], s65 offen lds
  s_add_u32 m0, s64, 2048
  s_mov_b32 s65, 65536
  buffer_load_dwordx4 v105, s[16:19], s65 offen lds
  s_add_u32 m0, s64, 3072
  s_mov_b32 s65, 98304
  buffer_load_dwordx4 v105, s[16:19], s65 offen lds
  ds_read_b64_tr_b16 a[136:137], v106 offset:16384
  ds_read_b64_tr_b16 a[138:139], v106 offset:17408
  ds_read_b64_tr_b16 a[140:141], v106 offset:24576
  ds_read_b64_tr_b16 a[142:143], v106 offset:25600
  ds_read_b64_tr_b16 a[200:201], v107 offset:16384
  ds_read_b64_tr_b16 a[202:203], v107 offset:17408
  ds_read_b64_tr_b16 a[204:205], v107 offset:24576
  ds_read_b64_tr_b16 a[206:207], v107 offset:25600
  s_waitcnt vmcnt(24) lgkmcnt(0)
  s_barrier
  s_add_u32 m0, s64, 16384
  s_mov_b32 s65, 524288
  buffer_load_dwordx4 v104, s[16:19], s65 offen lds
  s_add_u32 m0, s64, 17408
  s_mov_b32 s65, 557056
  buffer_load_dwordx4 v104, s[16:19], s65 offen lds
  s_add_u32 m0, s64, 18432
  s_mov_b32 s65, 589824
  buffer_load_dwordx4 v105, s[16:19], s65 offen lds
  s_add_u32 m0, s64, 19456
  s_mov_b32 s65, 622592
  buffer_load_dwordx4 v105, s[16:19], s65 offen lds
  ds_read_b64_tr_b16 a[144:145], v106 offset:32768
  ds_read_b64_tr_b16 a[146:147], v106 offset:33792
  ds_read_b64_tr_b16 a[148:149], v106 offset:40960
  ds_read_b64_tr_b16 a[150:151], v106 offset:41984
  ds_read_b64_tr_b16 a[208:209], v107 offset:32768
  ds_read_b64_tr_b16 a[210:211], v107 offset:33792
  ds_read_b64_tr_b16 a[212:213], v107 offset:40960
  ds_read_b64_tr_b16 a[214:215], v107 offset:41984
  s_waitcnt vmcnt(24) lgkmcnt(0)
  s_barrier
  s_add_u32 m0, s64, 32768
  s_mov_b32 s65, 1048576
  buffer_load_dwordx4 v104, s[16:19], s65 offen lds
  s_add_u32 m0, s64, 33792
  s_mov_b32 s65, 1081344
  buffer_load_dwordx4 v104, s[16:19], s65 offen lds
  s_add_u32 m0, s64, 34816
  s_mov_b32 s65, 1114112
  buffer_load_dwordx4 v105, s[16:19], s65 offen lds
  s_add_u32 m0, s64, 35840
  s_mov_b32 s65, 1146880
  buffer_load_dwordx4 v105, s[16:19], s65 offen lds
  ds_read_b64_tr_b16 a[152:153], v106 offset:49152
  ds_read_b64_tr_b16 a[154:155], v106 offset:50176
  ds_read_b64_tr_b16 a[156:157], v106 offset:57344
  ds_read_b64_tr_b16 a[158:159], v106 offset:58368
  ds_read_b64_tr_b16 a[216:217], v107 offset:49152
  ds_read_b64_tr_b16 a[218:219], v107 offset:50176
  ds_read_b64_tr_b16 a[220:221], v107 offset:57344
  ds_read_b64_tr_b16 a[222:223], v107 offset:58368
  s_waitcnt vmcnt(24) lgkmcnt(0)
  s_barrier
  s_add_u32 m0, s64, 49152
  s_mov_b32 s65, 1572864
  buffer_load_dwordx4 v104, s[16:19], s65 offen lds
  s_add_u32 m0, s64, 50176
  s_mov_b32 s65, 1605632
  buffer_load_dwordx4 v104, s[16:19], s65 offen lds
  s_add_u32 m0, s64, 51200
  s_mov_b32 s65, 1638400
  buffer_load_dwordx4 v105, s[16:19], s65 offen lds
  s_add_u32 m0, s64, 52224
  s_mov_b32 s65, 1671168
  buffer_load_dwordx4 v105, s[16:19], s65 offen lds
  ds_read_b64_tr_b16 a[160:161], v108 offset:0
  ds_read_b64_tr_b16 a[162:163], v108 offset:1024
  ds_read_b64_tr_b16 a[164:165], v108 offset:8192
  ds_read_b64_tr_b16 a[166:167], v108 offset:9216
  ds_read_b64_tr_b16 a[224:225], v109 offset:0
  ds_read_b64_tr_b16 a[226:227], v109 offset:1024
  ds_read_b64_tr_b16 a[228:229], v109 offset:8192
  ds_read_b64_tr_b16 a[230:231], v109 offset:9216
  s_waitcnt vmcnt(24) lgkmcnt(0)
  s_barrier
  s_add_u32 m0, s64, 65536
  s_mov_b32 s65, 2097152
  buffer_load_dwordx4 v104, s[16:19], s65 offen lds
  s_add_u32 m0, s64, 66560
  s_mov_b32 s65, 2129920
  buffer_load_dwordx4 v104, s[16:19], s65 offen lds
  s_add_u32 m0, s64, 67584
  s_mov_b32 s65, 2162688
  buffer_load_dwordx4 v105, s[16:19], s65 offen lds
  s_add_u32 m0, s64, 68608
  s_mov_b32 s65, 2195456
  buffer_load_dwordx4 v105, s[16:19], s65 offen lds
  ds_read_b64_tr_b16 a[168:169], v108 offset:16384
  ds_read_b64_tr_b16 a[170:171], v108 offset:17408
  ds_read_b64_tr_b16 a[172:173], v108 offset:24576
  ds_read_b64_tr_b16 a[174:175], v108 offset:25600
  ds_read_b64_tr_b16 a[232:233], v109 offset:16384
  ds_read_b64_tr_b16 a[234:235], v109 offset:17408
  ds_read_b64_tr_b16 a[236:237], v109 offset:24576
  ds_read_b64_tr_b16 a[238:239], v109 offset:25600
  s_waitcnt vmcnt(24) lgkmcnt(0)
  s_barrier
  s_add_u32 m0, s64, 81920
  s_mov_b32 s65, 2621440
  buffer_load_dwordx4 v104, s[16:19], s65 offen lds
  s_add_u32 m0, s64, 82944
  s_mov_b32 s65, 2654208
  buffer_load_dwordx4 v104, s[16:19], s65 offen lds
  s_add_u32 m0, s64, 83968
  s_mov_b32 s65, 2686976
  buffer_load_dwordx4 v105, s[16:19], s65 offen lds
  s_add_u32 m0, s64, 84992
  s_mov_b32 s65, 2719744
  buffer_load_dwordx4 v105, s[16:19], s65 offen lds
  ds_read_b64_tr_b16 a[176:177], v108 offset:32768
  ds_read_b64_tr_b16 a[178:179], v108 offset:33792
  ds_read_b64_tr_b16 a[180:181], v108 offset:40960
  ds_read_b64_tr_b16 a[182:183], v108 offset:41984
  ds_read_b64_tr_b16 a[240:241], v109 offset:32768
  ds_read_b64_tr_b16 a[242:243], v109 offset:33792
  ds_read_b64_tr_b16 a[244:245], v109 offset:40960
  ds_read_b64_tr_b16 a[246:247], v109 offset:41984
  s_waitcnt vmcnt(24) lgkmcnt(0)
  s_barrier
  s_add_u32 m0, s64, 98304
  s_mov_b32 s65, 3145728
  buffer_load_dwordx4 v104, s[16:19], s65 offen lds
  s_add_u32 m0, s64, 99328
  s_mov_b32 s65, 3178496
  buffer_load_dwordx4 v104, s[16:19], s65 offen lds
  s_add_u32 m0, s64, 100352
  s_mov_b32 s65, 3211264
  buffer_load_dwordx4 v105, s[16:19], s65 offen lds
  s_add_u32 m0, s64, 101376
  s_mov_b32 s65, 3244032
  buffer_load_dwordx4 v105, s[16:19], s65 offen lds
  ds_read_b64_tr_b16 a[184:185], v108 offset:49152
  ds_read_b64_tr_b16 a[186:187], v108 offset:50176
  ds_read_b64_tr_b16 a[188:189], v108 offset:57344
  ds_read_b64_tr_b16 a[190:191], v108 offset:58368
  ds_read_b64_tr_b16 a[248:249], v109 offset:49152
  ds_read_b64_tr_b16 a[250:251], v109 offset:50176
  ds_read_b64_tr_b16 a[252:253], v109 offset:57344
  ds_read_b64_tr_b16 a[254:255], v109 offset:58368
  s_waitcnt vmcnt(24) lgkmcnt(0)
  s_barrier
  s_add_u32 m0, s64, 114688
  s_mov_b32 s65, 3670016
  buffer_load_dwordx4 v104, s[16:19], s65 offen lds
  s_add_u32 m0, s64, 115712
  s_mov_b32 s65, 3702784
  buffer_load_dwordx4 v104, s[16:19], s65 offen lds
  s_add_u32 m0, s64, 116736
  s_mov_b32 s65, 3735552
  buffer_load_dwordx4 v105, s[16:19], s65 offen lds
  s_add_u32 m0, s64, 117760
  s_mov_b32 s65, 3768320
  buffer_load_dwordx4 v105, s[16:19], s65 offen lds
  ds_read_b64_tr_b16 v[128:129], v106 offset:0
  ds_read_b64_tr_b16 v[130:131], v106 offset:1024
  ds_read_b64_tr_b16 v[132:133], v106 offset:8192
  ds_read_b64_tr_b16 v[134:135], v106 offset:9216
  ds_read_b64_tr_b16 v[192:193], v107 offset:0
  ds_read_b64_tr_b16 v[194:195], v107 offset:1024
  ds_read_b64_tr_b16 v[196:197], v107 offset:8192
  ds_read_b64_tr_b16 v[198:199], v107 offset:9216
  s_waitcnt vmcnt(24) lgkmcnt(0)
  s_barrier
  ds_read_b64_tr_b16 v[136:137], v106 offset:16384
  ds_read_b64_tr_b16 v[138:139], v106 offset:17408
  ds_read_b64_tr_b16 v[140:141], v106 offset:24576
  ds_read_b64_tr_b16 v[142:143], v106 offset:25600
  ds_read_b64_tr_b16 v[200:201], v107 offset:16384
  ds_read_b64_tr_b16 v[202:203], v107 offset:17408
  ds_read_b64_tr_b16 v[204:205], v107 offset:24576
  ds_read_b64_tr_b16 v[206:207], v107 offset:25600
  s_waitcnt vmcnt(20) lgkmcnt(0)
  s_barrier
  ds_read_b64_tr_b16 v[144:145], v106 offset:32768
  ds_read_b64_tr_b16 v[146:147], v106 offset:33792
  ds_read_b64_tr_b16 v[148:149], v106 offset:40960
  ds_read_b64_tr_b16 v[150:151], v106 offset:41984
  ds_read_b64_tr_b16 v[208:209], v107 offset:32768
  ds_read_b64_tr_b16 v[210:211], v107 offset:33792
  ds_read_b64_tr_b16 v[212:213], v107 offset:40960
  ds_read_b64_tr_b16 v[214:215], v107 offset:41984
  s_waitcnt vmcnt(16) lgkmcnt(0)
  s_barrier
  ds_read_b64_tr_b16 v[152:153], v106 offset:49152
  ds_read_b64_tr_b16 v[154:155], v106 offset:50176
  ds_read_b64_tr_b16 v[156:157], v106 offset:57344
  ds_read_b64_tr_b16 v[158:159], v106 offset:58368
  ds_read_b64_tr_b16 v[216:217], v107 offset:49152
  ds_read_b64_tr_b16 v[218:219], v107 offset:50176
  ds_read_b64_tr_b16 v[220:221], v107 offset:57344
  ds_read_b64_tr_b16 v[222:223], v107 offset:58368
  s_waitcnt vmcnt(12) lgkmcnt(0)
  s_barrier
  ds_read_b64_tr_b16 v[160:161], v108 offset:0
  ds_read_b64_tr_b16 v[162:163], v108 offset:1024
  ds_read_b64_tr_b16 v[164:165], v108 offset:8192
  ds_read_b64_tr_b16 v[166:167], v108 offset:9216
  ds_read_b64_tr_b16 v[224:225], v109 offset:0
  ds_read_b64_tr_b16 v[226:227], v109 offset:1024
  ds_read_b64_tr_b16 v[228:229], v109 offset:8192
  ds_read_b64_tr_b16 v[230:231], v109 offset:9216
  s_waitcnt vmcnt(8) lgkmcnt(0)
  s_barrier
  ds_read_b64_tr_b16 v[168:169], v108 offset:16384
  ds_read_b64_tr_b16 v[170:171], v108 offset:17408
  ds_read_b64_tr_b16 v[172:173], v108 offset:24576
  ds_read_b64_tr_b16 v[174:175], v108 offset:25600
  ds_read_b64_tr_b16 v[232:233], v109 offset:16384
  ds_read_b64_tr_b16 v[234:235], v109 offset:17408
  ds_read_b64_tr_b16 v[236:237], v109 offset:24576
  ds_read_b64_tr_b16 v[238:239], v109 offset:25600
  s_waitcnt vmcnt(4) lgkmcnt(0)
  s_barrier
  ds_read_b64_tr_b16 v[176:177], v108 offset:32768
  ds_read_b64_tr_b16 v[178:179], v108 offset:33792
  ds_read_b64_tr_b16 v[180:181], v108 offset:40960
  ds_read_b64_tr_b16 v[182:183], v108 offset:41984
  ds_read_b64_tr_b16 v[240:241], v109 offset:32768
  ds_read_b64_tr_b16 v[242:243], v109 offset:33792
  ds_read_b64_tr_b16 v[244:245], v109 offset:40960
  ds_read_b64_tr_b16 v[246:247], v109 offset:41984
  s_waitcnt vmcnt(0) lgkmcnt(0)
  s_barrier
  ds_read_b64_tr_b16 v[184:185], v108 offset:49152
  ds_read_b64_tr_b16 v[186:187], v108 offset:50176
  ds_read_b64_tr_b16 v[188:189], v108 offset:57344
  ds_read_b64_tr_b16 v[190:191], v108 offset:58368
  ds_read_b64_tr_b16 v[248:249], v109 offset:49152
  ds_read_b64_tr_b16 v[250:251], v109 offset:50176
  ds_read_b64_tr_b16 v[252:253], v109 offset:57344
  ds_read_b64_tr_b16 v[254:255], v109 offset:58368
  s_waitcnt lgkmcnt(0)
L_wd_10:
  s_sub_u32 s56, s56, 1
  s_cbranch_scc1 L_timeout
  s_mov_b64 exec, 1
  buffer_load_dword v1, off, s[48:51], 0 offset:228 sc1
  s_mov_b64 exec, -1
  s_waitcnt vmcnt(0)
  v_readfirstlane_b32 s57, v1
  s_nop 0
  s_cmp_ge_u32 s57, 1
  s_cbranch_scc1 L_wd_11
  s_sleep 8
  s_branch L_wd_10
L_wd_11:
  s_mov_b32 s72, s60
  s_mov_b32 s73, 0
  s_mov_b32 s74, 32768
  s_mov_b32 s77, 0x40000000
L_p_loop:
  s_waitcnt vmcnt(0)
  s_barrier
  s_add_u32 s75, s72, 2
  s_min_u32 s75, s75, 63
  s_lshl_b32 s71, s75, 15
  s_add_u32 s71, s71, s70
  s_add_u32 s76, s74, s70
  ds_read_b128 v[16:19], v4 offset:0
  ds_read_b128 v[20:23], v4 offset:16384
  s_waitcnt lgkmcnt(0)
  v_mfma_f32_16x16x32_bf16 v[32:35], a[0:3], v[16:19], 0
  ds_read_b128 v[24:27], v5 offset:0
  v_mfma_f32_16x16x32_bf16 v[36:39], a[0:3], v[20:23], 0
  ds_read_b128 v[28:31], v5 offset:16384
  v_mfma_f32_16x16x32_bf16 v[40:43], a[64:67], v[16:19], 0
  v_mfma_f32_16x16x32_bf16 v[44:47], a[64:67], v[20:23], 0
  s_add_u32 s78, s77, 33554432
  buffer_store_dwordx4 v[80:83], v9, s[52:55], s78 offen sc1
  v_mfma_f32_16x16x32_bf16 v[48:51], v[128:131], v[16:19], 0
  v_mfma_f32_16x16x32_bf16 v[52:55], v[128:131], v[20:23], 0
  v_mfma_f32_16x16x32_bf16 v[56:59], v[192:195], v[16:19], 0
  v_mfma_f32_16x16x32_bf16 v[60:63], v[192:195], v[20:23], 0
  s_add_u32 s78, s77, 33558528
  buffer_store_dwordx4 v[84:87], v9, s[52:55], s78 offen sc1
  v_mfma_f32_16x16x32_bf16 v[64:67], v[16:19], a[128:131], 0
  v_mfma_f32_16x16x32_bf16 v[68:71], v[16:19], a[192:195], 0
  v_mfma_f32_16x16x32_bf16 v[72:75], v[20:23], a[128:131], 0
  v_mfma_f32_16x16x32_bf16 v[76:79], v[20:23], a[192:195], 0
  s_waitcnt lgkmcnt(0)
  v_mfma_f32_16x16x32_bf16 v[32:35], a[4:7], v[24:27], v[32:35]
  ds_read_b128 v[16:19], v6 offset:0
  v_mfma_f32_16x16x32_bf16 v[36:39], a[4:7], v[28:31], v[36:39]
  ds_read_b128 v[20:23], v6 offset:16384
  v_mfma_f32_16x16x32_bf16 v[40:43], a[68:71], v[24:27], v[40:43]
  v_mfma_f32_16x16x32_bf16 v[44:47], a[68:71], v[28:31], v[44:47]
  s_add_u32 s78, s77, 50331648
  buffer_store_dwordx4 v[88:91], v10, s[52:55], s78 offen sc1
  v_mfma_f32_16x16x32_bf16 v[48:51], v[132:135], v[24:27], v[48:51]
  v_mfma_f32_16x16x32_bf16 v[52:55], v[132:135], v[28:31], v[52:55]
  v_mfma_f32_16x16x32_bf16 v[56:59], v[196:199], v[24:27], v[56:59]
  v_mfma_f32_16x16x32_bf16 v[60:63], v[196:199], v[28:31], v[60:63]
  s_add_u32 s78, s77, 50332672
  buffer_store_dwordx4 v[92:95], v10, s[52:55], s78 offen sc1
  v_mfma_f32_16x16x32_bf16 v[64:67], v[24:27], a[132:135], v[64:67]
  v_mfma_f32_16x16x32_bf16 v[68:71], v[24:27], a[196:199], v[68:71]
  v_mfma_f32_16x16x32_bf16 v[72:75], v[28:31], a[132:135], v[72:75]
  v_mfma_f32_16x16x32_bf16 v[76:79], v[28:31], a[196:199], v[76:79]
  s_waitcnt lgkmcnt(0)
  v_mfma_f32_16x16x32_bf16 v[32:35], a[8:11], v[16:19], v[32:35]
  ds_read_b128 v[24:27], v7 offset:0
  v_mfma_f32_16x16x32_bf16 v[36:39], a[8:11], v[20:23], v[36:39]
  ds_read_b128 v[28:31], v7 offset:16384
  v_mfma_f32_16x16x32_bf16 v[40:43], a[72:75], v[16:19], v[40:43]
  v_mfma_f32_16x16x32_bf16 v[44:47], a[72:75], v[20:23], v[44:47]
  s_add_u32 s78, s77, 16777216
  buffer_store_dwordx4 v[96:99], v9, s[52:55], s78 offen sc1
  v_mfma_f32_16x16x32_bf16 v[48:51], v[136:139], v[16:19], v[48:51]
  v_mfma_f32_16x16x32_bf16 v[52:55], v[136:139], v[20:23], v[52:55]
  v_mfma_f32_16x16x32_bf16 v[56:59], v[200:203], v[16:19], v[56:59]
  v_mfma_f32_16x16x32_bf16 v[60:63], v[200:203], v[20:23], v[60:63]
  s_add_u32 s78, s77, 16781312
  buffer_store_dwordx4 v[100:103], v9, s[52:55], s78 offen sc1
  v_mfma_f32_16x16x32_bf16 v[64:67], v[16:19], a[136:139], v[64:67]
  v_mfma_f32_16x16x32_bf16 v[68:71], v[16:19], a[200:203], v[68:71]
  v_mfma_f32_16x16x32_bf16 v[72:75], v[20:23], a[136:139], v[72:75]
  v_mfma_f32_16x16x32_bf16 v[76:79], v[20:23], a[200:203], v[76:79]
  s_waitcnt lgkmcnt(0)
  v_mfma_f32_16x16x32_bf16 v[32:35], a[12:15], v[24:27], v[32:35]
  ds_read_b128 v[16:19], v4 offset:256
  v_mfma_f32_16x16x32_bf16 v[36:39], a[12:15], v[28:31], v[36:39]
  ds_read_b128 v[20:23], v4 offset:16640
  v_mfma_f32_16x16x32_bf16 v[40:43], a[76:79], v[24:27], v[40:43]
  v_mfma_f32_16x16x32_bf16 v[44:47], a[76:79], v[28:31], v[44:47]
  v_mfma_f32_16x16x32_bf16 v[48:51], v[140:143], v[24:27], v[48:51]
  s_add_u32 m0, s76, 0
  s_add_u32 s69, s71, 0
  buffer_load_dwordx4 v110, s[8:11], s69 offen lds
  v_mfma_f32_16x16x32_bf16 v[52:55], v[140:143], v[28:31], v[52:55]
  v_mfma_f32_16x16x32_bf16 v[56:59], v[204:207], v[24:27], v[56:59]
  v_mfma_f32_16x16x32_bf16 v[60:63], v[204:207], v[28:31], v[60:63]
  v_mfma_f32_16x16x32_bf16 v[64:67], v[24:27], a[140:143], v[64:67]
  v_mfma_f32_16x16x32_bf16 v[68:71], v[24:27], a[204:207], v[68:71]
  v_mfma_f32_16x16x32_bf16 v[72:75], v[28:31], a[140:143], v[72:75]
  v_mfma_f32_16x16x32_bf16 v[76:79], v[28:31], a[204:207], v[76:79]
  s_waitcnt lgkmcnt(0)
  v_mfma_f32_16x16x32_bf16 v[32:35], a[16:19], v[16:19], v[32:35]
  ds_read_b128 v[24:27], v5 offset:256
  v_mfma_f32_16x16x32_bf16 v[36:39], a[16:19], v[20:23], v[36:39]
  ds_read_b128 v[28:31], v5 offset:16640
  v_mfma_f32_16x16x32_bf16 v[40:43], a[80:83], v[16:19], v[40:43]
  v_mfma_f32_16x16x32_bf16 v[44:47], a[80:83], v[20:23], v[44:47]
  v_mfma_f32_16x16x32_bf16 v[48:51], v[144:147], v[16:19], v[48:51]
  s_add_u32 m0, s76, 1024
  s_add_u32 s69, s71, 1024
  buffer_load_dwordx4 v111, s[8:11], s69 offen lds
  v_mfma_f32_16x16x32_bf16 v[52:55], v[144:147], v[20:23], v[52:55]
  v_mfma_f32_16x16x32_bf16 v[56:59], v[208:211], v[16:19], v[56:59]
  v_mfma_f32_16x16x32_bf16 v[60:63], v[208:211], v[20:23], v[60:63]
  v_mfma_f32_16x16x32_bf16 v[64:67], v[16:19], a[144:147], v[64:67]
  v_mfma_f32_16x16x32_bf16 v[68:71], v[16:19], a[208:211], v[68:71]
  v_mfma_f32_16x16x32_bf16 v[72:75], v[20:23], a[144:147], v[72:75]
  v_mfma_f32_16x16x32_bf16 v[76:79], v[20:23], a[208:211], v[76:79]
  s_waitcnt lgkmcnt(0)
  v_mfma_f32_16x16x32_bf16 v[32:35], a[20:23], v[24:27], v[32:35]
  ds_read_b128 v[16:19], v6 offset:256
  v_mfma_f32_16x16x32_bf16 v[36:39], a[20:23], v[28:31], v[36:39]
  ds_read_b128 v[20:23], v6 offset:16640
  v_mfma_f32_16x16x32_bf16 v[40:43], a[84:87], v[24:27], v[40:43]
  v_mfma_f32_16x16x32_bf16 v[44:47], a[84:87], v[28:31], v[44:47]
  v_mfma_f32_16x16x32_bf16 v[48:51], v[148:151], v[24:27], v[48:51]
  s_add_u32 m0, s76, 2048
  s_add_u32 s69, s71, 2048
  buffer_load_dwordx4 v112, s[8:11], s69 offen lds
  v_mfma_f32_16x16x32_bf16 v[52:55], v[148:151], v[28:31], v[52:55]
  v_mfma_f32_16x16x32_bf16 v[56:59], v[212:215], v[24:27], v[56:59]
  v_mfma_f32_16x16x32_bf16 v[60:63], v[212:215], v[28:31], v[60:63]
  v_mfma_f32_16x16x32_bf16 v[64:67], v[24:27], a[148:151], v[64:67]
  v_mfma_f32_16x16x32_bf16 v[68:71], v[24:27], a[212:215], v[68:71]
  v_mfma_f32_16x16x32_bf16 v[72:75], v[28:31], a[148:151], v[72:75]
  v_mfma_f32_16x16x32_bf16 v[76:79], v[28:31], a[212:215], v[76:79]
  s_waitcnt lgkmcnt(0)
  v_mfma_f32_16x16x32_bf16 v[32:35], a[24:27], v[16:19], v[32:35]
  ds_read_b128 v[24:27], v7 offset:256
  v_mfma_f32_16x16x32_bf16 v[36:39], a[24:27], v[20:23], v[36:39]
  ds_read_b128 v[28:31], v7 offset:16640
  v_mfma_f32_16x16x32_bf16 v[40:43], a[88:91], v[16:19], v[40:43]
  v_mfma_f32_16x16x32_bf16 v[44:47], a[88:91], v[20:23], v[44:47]
  v_mfma_f32_16x16x32_bf16 v[48:51], v[152:155], v[16:19], v[48:51]
  s_add_u32 m0, s76, 3072
  s_add_u32 s69, s71, 3072
  buffer_load_dwordx4 v113, s[8:11], s69 offen lds
  v_mfma_f32_16x16x32_bf16 v[52:55], v[152:155], v[20:23], v[52:55]
  v_mfma_f32_16x16x32_bf16 v[56:59], v[216:219], v[16:19], v[56:59]
  v_mfma_f32_16x16x32_bf16 v[60:63], v[216:219], v[20:23], v[60:63]
  v_mfma_f32_16x16x32_bf16 v[64:67], v[16:19], a[152:155], v[64:67]
  v_mfma_f32_16x16x32_bf16 v[68:71], v[16:19], a[216:219], v[68:71]
  v_mfma_f32_16x16x32_bf16 v[72:75], v[20:23], a[152:155], v[72:75]
  v_mfma_f32_16x16x32_bf16 v[76:79], v[20:23], a[216:219], v[76:79]
  s_waitcnt lgkmcnt(0)
  v_mfma_f32_16x16x32_bf16 v[32:35], a[28:31], v[24:27], v[32:35]
  ds_read_b128 v[16:19], v4 offset:512
  v_mfma_f32_16x16x32_bf16 v[36:39], a[28:31], v[28:31], v[36:39]
  ds_read_b128 v[20:23], v4 offset:16896
  v_mfma_f32_16x16x32_bf16 v[40:43], a[92:95], v[24:27], v[40:43]
  v_mfma_f32_16x16x32_bf16 v[44:47], a[92:95], v[28:31], v[44:47]
  v_mfma_f32_16x16x32_bf16 v[48:51], v[156:159], v[24:27], v[48:51]
  s_add_u32 m0, s76, 4096
  s_add_u32 s69, s71, 4096
  buffer_load_dwordx4 v114, s[8:11], s69 offen lds
  v_mfma_f32_16x16x32_bf16 v[52:55], v[156:159], v[28:31], v[52:55]
  v_mfma_f32_16x16x32_bf16 v[56:59], v[220:223], v[24:27], v[56:59]
  v_mfma_f32_16x16x32_bf16 v[60:63], v[220:223], v[28:31], v[60:63]
  v_mfma_f32_16x16x32_bf16 v[64:67], v[24:27], a[156:159], v[64:67]
  v_mfma_f32_16x16x32_bf16 v[68:71], v[24:27], a[220:223], v[68:71]
  v_mfma_f32_16x16x32_bf16 v[72:75], v[28:31], a[156:159], v[72:75]
  v_mfma_f32_16x16x32_bf16 v[76:79], v[28:31], a[220:223], v[76:79]
  s_waitcnt lgkmcnt(0)
  v_mfma_f32_16x16x32_bf16 v[32:35], a[32:35], v[16:19], v[32:35]
  ds_read_b128 v[24:27], v5 offset:512
  v_mfma_f32_16x16x32_bf16 v[36:39], a[32:35], v[20:23], v[36:39]
  ds_read_b128 v[28:31], v5 offset:16896
  v_mfma_f32_16x16x32_bf16 v[40:43], a[96:99], v[16:19], v[40:43]
  v_mfma_f32_16x16x32_bf16 v[44:47], a[96:99], v[20:23], v[44:47]
  v_mfma_f32_16x16x32_bf16 v[48:51], v[160:163], v[16:19], v[48:51]
  s_add_u32 m0, s76, 5120
  s_add_u32 s69, s71, 5120
  buffer_load_dwordx4 v115, s[8:11], s69 offen lds
  v_mfma_f32_16x16x32_bf16 v[52:55], v[160:163], v[20:23], v[52:55]
  v_mfma_f32_16x16x32_bf16 v[56:59], v[224:227], v[16:19], v[56:59]
  v_mfma_f32_16x16x32_bf16 v[60:63], v[224:227], v[20:23], v[60:63]
  v_mfma_f32_16x16x32_bf16 v[64:67], v[16:19], a[160:163], v[64:67]
  v_mfma_f32_16x16x32_bf16 v[68:71], v[16:19], a[224:227], v[68:71]
  v_mfma_f32_16x16x32_bf16 v[72:75], v[20:23], a[160:163], v[72:75]
  v_mfma_f32_16x16x32_bf16 v[76:79], v[20:23], a[224:227], v[76:79]
  s_waitcnt vmcnt(6)
  s_barrier
  v_mov_b32 v12, s73
  s_mov_b64 exec, 1
  buffer_store_dword v12, v11, s[52:55], 0 offen sc1
  s_mov_b64 exec, -1
  s_waitcnt lgkmcnt(0)
  v_mfma_f32_16x16x32_bf16 v[32:35], a[36:39], v[24:27], v[32:35]
  ds_read_b128 v[16:19], v6 offset:512
  v_mfma_f32_16x16x32_bf16 v[36:39], a[36:39], v[28:31], v[36:39]
  ds_read_b128 v[20:23], v6 offset:16896
  v_mfma_f32_16x16x32_bf16 v[40:43], a[100:103], v[24:27], v[40:43]
  v_mfma_f32_16x16x32_bf16 v[44:47], a[100:103], v[28:31], v[44:47]
  v_mfma_f32_16x16x32_bf16 v[48:51], v[164:167], v[24:27], v[48:51]
  s_add_u32 m0, s76, 6144
  s_add_u32 s69, s71, 6144
  buffer_load_dwordx4 v116, s[8:11], s69 offen lds
  v_mfma_f32_16x16x32_bf16 v[52:55], v[164:167], v[28:31], v[52:55]
  v_mfma_f32_16x16x32_bf16 v[56:59], v[228:231], v[24:27], v[56:59]
  v_mfma_f32_16x16x32_bf16 v[60:63], v[228:231], v[28:31], v[60:63]
  v_mfma_f32_16x16x32_bf16 v[64:67], v[24:27], a[164:167], v[64:67]
  v_mfma_f32_16x16x32_bf16 v[68:71], v[24:27], a[228:231], v[68:71]
  v_mfma_f32_16x16x32_bf16 v[72:75], v[28:31], a[164:167], v[72:75]
  v_mfma_f32_16x16x32_bf16 v[76:79], v[28:31], a[228:231], v[76:79]
  s_waitcnt lgkmcnt(0)
  v_mfma_f32_16x16x32_bf16 v[32:35], a[40:43], v[16:19], v[32:35]
  ds_read_b128 v[24:27], v7 offset:512
  v_mfma_f32_16x16x32_bf16 v[36:39], a[40:43], v[20:23], v[36:39]
  ds_read_b128 v[28:31], v7 offset:16896
  v_mfma_f32_16x16x32_bf16 v[40:43], a[104:107], v[16:19], v[40:43]
  v_mfma_f32_16x16x32_bf16 v[44:47], a[104:107], v[20:23], v[44:47]
  v_mfma_f32_16x16x32_bf16 v[48:51], v[168:171], v[16:19], v[48:51]
  s_add_u32 m0, s76, 7168
  s_add_u32 s69, s71, 7168
  buffer_load_dwordx4 v117, s[8:11], s69 offen lds
  v_mfma_f32_16x16x32_bf16 v[52:55], v[168:171], v[20:23], v[52:55]
  v_mfma_f32_16x16x32_bf16 v[56:59], v[232:235], v[16:19], v[56:59]
  v_mfma_f32_16x16x32_bf16 v[60:63], v[232:235], v[20:23], v[60:63]
  v_mfma_f32_16x16x32_bf16 v[64:67], v[16:19], a[168:171], v[64:67]
  v_mfma_f32_16x16x32_bf16 v[68:71], v[16:19], a[232:235], v[68:71]
  v_mfma_f32_16x16x32_bf16 v[72:75], v[20:23], a[168:171], v[72:75]
  v_mfma_f32_16x16x32_bf16 v[76:79], v[20:23], a[232:235], v[76:79]
  s_waitcnt lgkmcnt(0)
  v_mfma_f32_16x16x32_bf16 v[32:35], a[44:47], v[24:27], v[32:35]
  ds_read_b128 v[16:19], v4 offset:768
  v_mfma_f32_16x16x32_bf16 v[36:39], a[44:47], v[28:31], v[36:39]
  ds_read_b128 v[20:23], v4 offset:17152
  v_mfma_f32_16x16x32_bf16 v[40:43], a[108:111], v[24:27], v[40:43]
  v_mfma_f32_16x16x32_bf16 v[44:47], a[108:111], v[28:31], v[44:47]
  v_mfma_f32_16x16x32_bf16 v[48:51], v[172:175], v[24:27], v[48:51]
  v_mfma_f32_16x16x32_bf16 v[52:55], v[172:175], v[28:31], v[52:55]
  v_mfma_f32_16x16x32_bf16 v[56:59], v[236:239], v[24:27], v[56:59]
  v_mfma_f32_16x16x32_bf16 v[60:63], v[236:239], v[28:31], v[60:63]
  v_mfma_f32_16x16x32_bf16 v[64:67], v[24:27], a[172:175], v[64:67]
  v_mfma_f32_16x16x32_bf16 v[68:71], v[24:27], a[236:239], v[68:71]
  v_mfma_f32_16x16x32_bf16 v[72:75], v[28:31], a[172:175], v[72:75]
  v_mfma_f32_16x16x32_bf16 v[76:79], v[28:31], a[236:239], v[76:79]
  s_waitcnt lgkmcnt(0)
  v_mfma_f32_16x16x32_bf16 v[32:35], a[48:51], v[16:19], v[32:35]
  ds_read_b128 v[24:27], v5 offset:768
  v_mfma_f32_16x16x32_bf16 v[36:39], a[48:51], v[20:23], v[36:39]
  ds_read_b128 v[28:31], v5 offset:17152
  v_mfma_f32_16x16x32_bf16 v[40:43], a[112:115], v[16:19], v[40:43]
  v_mfma_f32_16x16x32_bf16 v[44:47], a[112:115], v[20:23], v[44:47]
  v_mfma_f32_16x16x32_bf16 v[48:51], v[176:179], v[16:19], v[48:51]
  v_mfma_f32_16x16x32_bf16 v[52:55], v[176:179], v[20:23], v[52:55]
  v_mfma_f32_16x16x32_bf16 v[56:59], v[240:243], v[16:19], v[56:59]
  v_mfma_f32_16x16x32_bf16 v[60:63], v[240:243], v[20:23], v[60:63]
  v_mfma_f32_16x16x32_bf16 v[64:67], v[16:19], a[176:179], v[64:67]
  v_mfma_f32_16x16x32_bf16 v[68:71], v[16:19], a[240:243], v[68:71]
  v_mfma_f32_16x16x32_bf16 v[72:75], v[20:23], a[176:179], v[72:75]
  v_mfma_f32_16x16x32_bf16 v[76:79], v[20:23], a[240:243], v[76:79]
  s_waitcnt lgkmcnt(0)
  v_mfma_f32_16x16x32_bf16 v[32:35], a[52:55], v[24:27], v[32:35]
  ds_read_b128 v[16:19], v6 offset:768
  v_mfma_f32_16x16x32_bf16 v[36:39], a[52:55], v[28:31], v[36:39]
  ds_read_b128 v[20:23], v6 offset:17152
  v_mfma_f32_16x16x32_bf16 v[40:43], a[116:119], v[24:27], v[40:43]
  v_mfma_f32_16x16x32_bf16 v[44:47], a[116:119], v[28:31], v[44:47]
  v_mfma_f32_16x16x32_bf16 v[48:51], v[180:183], v[24:27], v[48:51]
  v_mfma_f32_16x16x32_bf16 v[52:55], v[180:183], v[28:31], v[52:55]
  v_mfma_f32_16x16x32_bf16 v[56:59], v[244:247], v[24:27], v[56:59]
  v_mfma_f32_16x16x32_bf16 v[60:63], v[244:247], v[28:31], v[60:63]
  v_mfma_f32_16x16x32_bf16 v[64:67], v[24:27], a[180:183], v[64:67]
  v_mfma_f32_16x16x32_bf16 v[68:71], v[24:27], a[244:247], v[68:71]
  v_mfma_f32_16x16x32_bf16 v[72:75], v[28:31], a[180:183], v[72:75]
  v_mfma_f32_16x16x32_bf16 v[76:79], v[28:31], a[244:247], v[76:79]
  s_waitcnt lgkmcnt(0)
  v_mfma_f32_16x16x32_bf16 v[32:35], a[56:59], v[16:19], v[32:35]
  ds_read_b128 v[24:27], v7 offset:768
  v_mfma_f32_16x16x32_bf16 v[36:39], a[56:59], v[20:23], v[36:39]
  ds_read_b128 v[28:31], v7 offset:17152
  v_mfma_f32_16x16x32_bf16 v[40:43], a[120:123], v[16:19], v[40:43]
  v_mfma_f32_16x16x32_bf16 v[44:47], a[120:123], v[20:23], v[44:47]
  v_mfma_f32_16x16x32_bf16 v[48:51], v[184:187], v[16:19], v[48:51]
  v_mfma_f32_16x16x32_bf16 v[52:55], v[184:187], v[20:23], v[52:55]
  v_mfma_f32_16x16x32_bf16 v[56:59], v[248:251], v[16:19], v[56:59]
  v_mfma_f32_16x16x32_bf16 v[60:63], v[248:251], v[20:23], v[60:63]
  v_mfma_f32_16x16x32_bf16 v[64:67], v[16:19], a[184:187], v[64:67]
  v_mfma_f32_16x16x32_bf16 v[68:71], v[16:19], a[248:251], v[68:71]
  v_mfma_f32_16x16x32_bf16 v[72:75], v[20:23], a[184:187], v[72:75]
  v_mfma_f32_16x16x32_bf16 v[76:79], v[20:23], a[248:251], v[76:79]
  s_waitcnt lgkmcnt(0)
  v_mfma_f32_16x16x32_bf16 v[32:35], a[60:63], v[24:27], v[32:35]
  v_mfma_f32_16x16x32_bf16 v[36:39], a[60:63], v[28:31], v[36:39]
  v_mfma_f32_16x16x32_bf16 v[40:43], a[124:127], v[24:27], v[40:43]
  v_mfma_f32_16x16x32_bf16 v[44:47], a[124:127], v[28:31], v[44:47]
  v_mfma_f32_16x16x32_bf16 v[48:51], v[188:191], v[24:27], v[48:51]
  v_mfma_f32_16x16x32_bf16 v[52:55], v[188:191], v[28:31], v[52:55]
  v_cvt_pk_bf16_f32 v80, v32, v33
  v_cvt_pk_bf16_f32 v82, v34, v35
  v_mfma_f32_16x16x32_bf16 v[56:59], v[252:255], v[24:27], v[56:59]
  v_cvt_pk_bf16_f32 v81, v40, v41
  v_cvt_pk_bf16_f32 v83, v42, v43
  v_mfma_f32_16x16x32_bf16 v[60:63], v[252:255], v[28:31], v[60:63]
  v_cvt_pk_bf16_f32 v84, v36, v37
  v_cvt_pk_bf16_f32 v86, v38, v39
  v_mfma_f32_16x16x32_bf16 v[64:67], v[24:27], a[188:191], v[64:67]
  v_cvt_pk_bf16_f32 v85, v44, v45
  v_cvt_pk_bf16_f32 v87, v46, v47
  v_mfma_f32_16x16x32_bf16 v[68:71], v[24:27], a[252:255], v[68:71]
  v_cvt_pk_bf16_f32 v96, v48, v49
  v_cvt_pk_bf16_f32 v98, v50, v51
  v_mfma_f32_16x16x32_bf16 v[72:75], v[28:31], a[188:191], v[72:75]
  v_cvt_pk_bf16_f32 v97, v56, v57
  v_cvt_pk_bf16_f32 v99, v58, v59
  v_mfma_f32_16x16x32_bf16 v[76:79], v[28:31], a[252:255], v[76:79]
  v_cvt_pk_bf16_f32 v100, v52, v53
  v_cvt_pk_bf16_f32 v102, v54, v55
  v_cvt_pk_bf16_f32 v101, v60, v61
  v_cvt_pk_bf16_f32 v103, v62, v63
  v_cvt_pk_bf16_f32 v88, v64, v65
  v_cvt_pk_bf16_f32 v89, v66, v67
  v_cvt_pk_bf16_f32 v90, v72, v73
  v_cvt_pk_bf16_f32 v91, v74, v75
  v_cvt_pk_bf16_f32 v92, v68, v69
  v_cvt_pk_bf16_f32 v93, v70, v71
  v_cvt_pk_bf16_f32 v94, v76, v77
  v_cvt_pk_bf16_f32 v95, v78, v79
  s_lshl_b32 s77, s72, 18
  s_add_u32 s73, s73, 1
  v_xor_b32 v4, 0x8000, v4
  v_xor_b32 v5, 0x8000, v5
  v_xor_b32 v6, 0x8000, v6
  v_xor_b32 v7, 0x8000, v7
  s_xor_b32 s74, s74, 32768
  s_add_u32 s72, s72, 2
  s_cmp_lt_u32 s72, 64
  s_cbranch_scc1 L_p_loop
  s_add_u32 s78, s77, 33554432
  buffer_store_dwordx4 v[80:83], v9, s[52:55], s78 offen sc1
  s_add_u32 s78, s77, 33558528
  buffer_store_dwordx4 v[84:87], v9, s[52:55], s78 offen sc1
  s_add_u32 s78, s77, 50331648
  buffer_store_dwordx4 v[88:91], v10, s[52:55], s78 offen sc1
  s_add_u32 s78, s77, 50332672
  buffer_store_dwordx4 v[92:95], v10, s[52:55], s78 offen sc1
  s_add_u32 s78, s77, 16777216
  buffer_store_dwordx4 v[96:99], v9, s[52:55], s78 offen sc1
  s_add_u32 s78, s77, 16781312
  buffer_store_dwordx4 v[100:103], v9, s[52:55], s78 offen sc1
  s_waitcnt vmcnt(0)
  s_barrier
  v_mov_b32 v12, s73
  s_mov_b64 exec, 1
  buffer_store_dword v12, v11, s[52:55], 0 offen sc1
  s_mov_b64 exec, -1
  s_add_u32 s59, s60, 2
  s_add_u32 s78, s60, 46
L_o_start:
  v_and_b32 v1, 15, v0
  v_lshrrev_b32 v2, 4, v0
  v_lshlrev_b32 v3, 12, v2
  v_lshl_add_u32 v3, v1, 3, v3
  s_lshl_b32 s61, s6, 17
  s_lshl_b32 s62, s4, 8
  s_add_u32 s61, s61, s62
  v_add_u32 v22, s61, v3
  s_mov_b32 s68, 0
  buffer_load_dwordx2 v[128:129], v22, s[28:31], s68 offen
  buffer_load_dwordx2 v[130:131], v22, s[28:31], s68 offen offset:1024
  s_mov_b32 s68, 2048
  buffer_load_dwordx2 v[144:145], v22, s[28:31], s68 offen
  buffer_load_dwordx2 v[146:147], v22, s[28:31], s68 offen offset:1024
  s_mov_b32 s68, 16384
  buffer_load_dwordx2 v[160:161], v22, s[28:31], s68 offen
  buffer_load_dwordx2 v[162:163], v22, s[28:31], s68 offen offset:1024
  s_mov_b32 s68, 18432
  buffer_load_dwordx2 v[176:177], v22, s[28:31], s68 offen
  buffer_load_dwordx2 v[178:179], v22, s[28:31], s68 offen offset:1024
  s_mov_b32 s68, 128
  buffer_load_dwordx2 v[192:193], v22, s[28:31], s68 offen
  buffer_load_dwordx2 v[194:195], v22, s[28:31], s68 offen offset:1024
  s_mov_b32 s68, 2176
  buffer_load_dwordx2 v[208:209], v22, s[28:31], s68 offen
  buffer_load_dwordx2 v[210:211], v22, s[28:31], s68 offen offset:1024
  s_mov_b32 s68, 16512
  buffer_load_dwordx2 v[224:225], v22, s[28:31], s68 offen
  buffer_load_dwordx2 v[226:227], v22, s[28:31], s68 offen offset:1024
  s_mov_b32 s68, 18560
  buffer_load_dwordx2 v[240:241], v22, s[28:31], s68 offen
  buffer_load_dwordx2 v[242:243], v22, s[28:31], s68 offen offset:1024
  s_mov_b32 s68, 32768
  buffer_load_dwordx2 v[132:133], v22, s[28:31], s68 offen
  buffer_load_dwordx2 v[134:135], v22, s[28:31], s68 offen offset:1024
  s_mov_b32 s68, 34816
  buffer_load_dwordx2 v[148:149], v22, s[28:31], s68 offen
  buffer_load_dwordx2 v[150:151], v22, s[28:31], s68 offen offset:1024
  s_mov_b32 s68, 49152
  buffer_load_dwordx2 v[164:165], v22, s[28:31], s68 offen
  buffer_load_dwordx2 v[166:167], v22, s[28:31], s68 offen offset:1024
  s_mov_b32 s68, 51200
  buffer_load_dwordx2 v[180:181], v22, s[28:31], s68 offen
  buffer_load_dwordx2 v[182:183], v22, s[28:31], s68 offen offset:1024
  s_mov_b32 s68, 32896
  buffer_load_dwordx2 v[196:197], v22, s[28:31], s68 offen
  buffer_load_dwordx2 v[198:199], v22, s[28:31], s68 offen offset:1024
  s_mov_b32 s68, 34944
  buffer_load_dwordx2 v[212:213], v22, s[28:31], s68 offen
  buffer_load_dwordx2 v[214:215], v22, s[28:31], s68 offen offset:1024
  s_mov_b32 s68, 49280
  buffer_load_dwordx2 v[228:229], v22, s[28:31], s68 offen
  buffer_load_dwordx2 v[230:231], v22, s[28:31], s68 offen offset:1024
  s_mov_b32 s68, 51328
  buffer_load_dwordx2 v[244:245], v22, s[28:31], s68 offen
  buffer_load_dwordx2 v[246:247], v22, s[28:31], s68 offen offset:1024
  s_mov_b32 s68, 65536
  buffer_load_dwordx2 v[136:137], v22, s[28:31], s68 offen
  buffer_load_dwordx2 v[138:139], v22, s[28:31], s68 offen offset:1024
  s_mov_b32 s68, 67584
  buffer_load_dwordx2 v[152:153], v22, s[28:31], s68 offen
  buffer_load_dwordx2 v[154:155], v22, s[28:31], s68 offen offset:1024
  s_mov_b32 s68, 81920
  buffer_load_dwordx2 v[168:169], v22, s[28:31], s68 offen
  buffer_load_dwordx2 v[170:171], v22, s[28:31], s68 offen offset:1024
  s_mov_b32 s68, 83968
  buffer_load_dwordx2 v[184:185], v22, s[28:31], s68 offen
  buffer_load_dwordx2 v[186:187], v22, s[28:31], s68 offen offset:1024
  s_mov_b32 s68, 65664
  buffer_load_dwordx2 v[200:201], v22, s[28:31], s68 offen
  buffer_load_dwordx2 v[202:203], v22, s[28:31], s68 offen offset:1024
  s_mov_b32 s68, 67712
  buffer_load_dwordx2 v[216:217], v22, s[28:31], s68 offen
  buffer_load_dwordx2 v[218:219], v22, s[28:31], s68 offen offset:1024
  s_mov_b32 s68, 82048
  buffer_load_dwordx2 v[232:233], v22, s[28:31], s68 offen
  buffer_load_dwordx2 v[234:235], v22, s[28:31], s68 offen offset:1024
  s_mov_b32 s68, 84096
  buffer_load_dwordx2 v[248:249], v22, s[28:31], s68 offen
  buffer_load_dwordx2 v[250:251], v22, s[28:31], s68 offen offset:1024
  s_mov_b32 s68, 98304
  buffer_load_dwordx2 v[140:141], v22, s[28:31], s68 offen
  buffer_load_dwordx2 v[142:143], v22, s[28:31], s68 offen offset:1024
  s_mov_b32 s68, 100352
  buffer_load_dwordx2 v[156:157], v22, s[28:31], s68 offen
  buffer_load_dwordx2 v[158:159], v22, s[28:31], s68 offen offset:1024
  s_mov_b32 s68, 114688
  buffer_load_dwordx2 v[172:173], v22, s[28:31], s68 offen
  buffer_load_dwordx2 v[174:175], v22, s[28:31], s68 offen offset:1024
  s_mov_b32 s68, 116736
  buffer_load_dwordx2 v[188:189], v22, s[28:31], s68 offen
  buffer_load_dwordx2 v[190:191], v22, s[28:31], s68 offen offset:1024
  s_mov_b32 s68, 98432
  buffer_load_dwordx2 v[204:205], v22, s[28:31], s68 offen
  buffer_load_dwordx2 v[206:207], v22, s[28:31], s68 offen offset:1024
  s_mov_b32 s68, 100480
  buffer_load_dwordx2 v[220:221], v22, s[28:31], s68 offen
  buffer_load_dwordx2 v[222:223], v22, s[28:31], s68 offen offset:1024
  s_mov_b32 s68, 114816
  buffer_load_dwordx2 v[236:237], v22, s[28:31], s68 offen
  buffer_load_dwordx2 v[238:239], v22, s[28:31], s68 offen offset:1024
  s_mov_b32 s68, 116864
  buffer_load_dwordx2 v[252:253], v22, s[28:31], s68 offen
  buffer_load_dwordx2 v[254:255], v22, s[28:31], s68 offen offset:1024
  v_lshlrev_b32 v6, 4, v0
  s_lshl_b32 s61, s4, 11
  v_add_u32 v5, s61, v6
  s_add_u32 s73, s61, 32768
  s_lshl_b32 s62, s6, 13
  v_add_u32 v15, s62, v5
  v_add_u32 v7, 32768, v6
  v_bfe_u32 v3, v0, 1, 1
  v_mov_b32 v4, 0x4444
  v_mov_b32 v26, 0xeeee
  v_cmp_eq_u32 vcc, 1, v3
  s_nop 1
  v_cndmask_b32 v4, v4, v26, vcc
  v_and_b32 v29, 1, v0
  v_mov_b32 v27, 0x3f80
  v_mov_b32 v28, 0x3f800000
  v_cmp_eq_u32 vcc, 1, v29
  s_nop 1
  v_cndmask_b32 v27, v27, v28, vcc
  v_lshrrev_b32 v26, 1, v1
  v_cmp_eq_u32 vcc, 0, v26
  s_nop 1
  v_cndmask_b32 v8, 0, v27, vcc
  v_cmp_eq_u32 vcc, 1, v26
  s_nop 1
  v_cndmask_b32 v9, 0, v27, vcc
  v_cmp_eq_u32 vcc, 2, v26
  s_nop 1
  v_cndmask_b32 v10, 0, v27, vcc
  v_cmp_eq_u32 vcc, 3, v26
  s_nop 1
  v_cndmask_b32 v11, 0, v27, vcc
  v_lshlrev_b32 v27, 4, v1
  v_lshl_add_u32 v27, v2, 2, v27
  s_lshl_b32 s62, s4, 9
  v_add_u32 v12, s62, v27
  v_bfe_u32 v27, v0, 3, 1
  v_lshlrev_b32 v27, 8, v27
  v_lshl_add_u32 v27, v2, 6, v27
  v_bfe_u32 v28, v0, 2, 1
  v_lshl_add_u32 v27, v28, 4, v27
  v_lshl_add_u32 v13, v3, 3, v27
  v_lshlrev_b32 v27, 17, v2
  v_lshl_add_u32 v27, v1, 4, v27
  s_lshl_b32 s62, s6, 10
  s_lshl_b32 s63, s4, 8
  s_add_u32 s62, s62, s63
  v_add_u32 v16, s62, v27
  v_lshlrev_b32 v27, 10, v2
  v_lshl_add_u32 v27, v1, 4, v27
  s_lshl_b32 s62, s6, 15
  s_add_u32 s62, s62, s63
  v_add_u32 v17, s62, v27
  v_lshlrev_b32 v27, 7, v2
  v_lshl_add_u32 v27, v1, 3, v27
  s_lshl_b32 s62, s6, 11
  s_add_u32 s62, s62, s63
  v_add_u32 v18, s62, v27
  s_lshl_b32 s62, s59, 2
  s_add_u32 s62, s62, s4
  s_lshl_b32 s62, s62, 12
  s_add_u32 s62, s62, 65536
  v_and_b32 v27, 31, v0
  v_lshlrev_b32 v27, 7, v27
  v_add_u32 v20, s62, v27
  s_lshl_b32 s63, s6, 7
  s_add_u32 s62, s62, s63
  v_mov_b32 v19, s62
  v_mov_b32 v21, 0xf149f2ca
  s_mov_b32 s96, 0xffff0000
  s_mov_b32 s97, 0xffff0000
  v_lshlrev_b32 v27, 2, v2
  v_add_u32 v28, 0, v27
  v_cmp_le_u32 s[80:81], v28, v1
  v_add_u32 v28, 1, v27
  v_cmp_le_u32 s[82:83], v28, v1
  v_add_u32 v28, 2, v27
  v_cmp_le_u32 s[84:85], v28, v1
  v_add_u32 v28, 3, v27
  v_cmp_le_u32 s[86:87], v28, v1
  s_mov_b32 s79, 0x3e0293ee
  s_mov_b32 s61, 0x05040100
  s_mov_b32 s62, 0x07060302
  s_waitcnt vmcnt(56)
  v_perm_b32 v48, v130, v128, s61
  v_perm_b32 v52, v130, v128, s62
  v_perm_b32 v56, v131, v129, s61
  v_perm_b32 v60, v131, v129, s62
  v_perm_b32 v49, v146, v144, s61
  v_perm_b32 v53, v146, v144, s62
  v_perm_b32 v57, v147, v145, s61
  v_perm_b32 v61, v147, v145, s62
  v_perm_b32 v50, v162, v160, s61
  v_perm_b32 v54, v162, v160, s62
  v_perm_b32 v58, v163, v161, s61
  v_perm_b32 v62, v163, v161, s62
  v_perm_b32 v51, v178, v176, s61
  v_perm_b32 v55, v178, v176, s62
  v_perm_b32 v59, v179, v177, s61
  v_perm_b32 v63, v179, v177, s62
  v_mov_b32 v128, v48
  v_mov_b32 v129, v49
  v_mov_b32 v130, v50
  v_mov_b32 v131, v51
  v_mov_b32 v144, v52
  v_mov_b32 v145, v53
  v_mov_b32 v146, v54
  v_mov_b32 v147, v55
  v_mov_b32 v160, v56
  v_mov_b32 v161, v57
  v_mov_b32 v162, v58
  v_mov_b32 v163, v59
  v_mov_b32 v176, v60
  v_mov_b32 v177, v61
  v_mov_b32 v178, v62
  v_mov_b32 v179, v63
  s_waitcnt vmcnt(48)
  v_perm_b32 v48, v194, v192, s61
  v_perm_b32 v52, v194, v192, s62
  v_perm_b32 v56, v195, v193, s61
  v_perm_b32 v60, v195, v193, s62
  v_perm_b32 v49, v210, v208, s61
  v_perm_b32 v53, v210, v208, s62
  v_perm_b32 v57, v211, v209, s61
  v_perm_b32 v61, v211, v209, s62
  v_perm_b32 v50, v226, v224, s61
  v_perm_b32 v54, v226, v224, s62
  v_perm_b32 v58, v227, v225, s61
  v_perm_b32 v62, v227, v225, s62
  v_perm_b32 v51, v242, v240, s61
  v_perm_b32 v55, v242, v240, s62
  v_perm_b32 v59, v243, v241, s61
  v_perm_b32 v63, v243, v241, s62
  v_mov_b32 v192, v48
  v_mov_b32 v193, v49
  v_mov_b32 v194, v50
  v_mov_b32 v195, v51
  v_mov_b32 v208, v52
  v_mov_b32 v209, v53
  v_mov_b32 v210, v54
  v_mov_b32 v211, v55
  v_mov_b32 v224, v56
  v_mov_b32 v225, v57
  v_mov_b32 v226, v58
  v_mov_b32 v227, v59
  v_mov_b32 v240, v60
  v_mov_b32 v241, v61
  v_mov_b32 v242, v62
  v_mov_b32 v243, v63
  s_waitcnt vmcnt(40)
  v_perm_b32 v48, v134, v132, s61
  v_perm_b32 v52, v134, v132, s62
  v_perm_b32 v56, v135, v133, s61
  v_perm_b32 v60, v135, v133, s62
  v_perm_b32 v49, v150, v148, s61
  v_perm_b32 v53, v150, v148, s62
  v_perm_b32 v57, v151, v149, s61
  v_perm_b32 v61, v151, v149, s62
  v_perm_b32 v50, v166, v164, s61
  v_perm_b32 v54, v166, v164, s62
  v_perm_b32 v58, v167, v165, s61
  v_perm_b32 v62, v167, v165, s62
  v_perm_b32 v51, v182, v180, s61
  v_perm_b32 v55, v182, v180, s62
  v_perm_b32 v59, v183, v181, s61
  v_perm_b32 v63, v183, v181, s62
  v_mov_b32 v132, v48
  v_mov_b32 v133, v49
  v_mov_b32 v134, v50
  v_mov_b32 v135, v51
  v_mov_b32 v148, v52
  v_mov_b32 v149, v53
  v_mov_b32 v150, v54
  v_mov_b32 v151, v55
  v_mov_b32 v164, v56
  v_mov_b32 v165, v57
  v_mov_b32 v166, v58
  v_mov_b32 v167, v59
  v_mov_b32 v180, v60
  v_mov_b32 v181, v61
  v_mov_b32 v182, v62
  v_mov_b32 v183, v63
  s_waitcnt vmcnt(32)
  v_perm_b32 v48, v198, v196, s61
  v_perm_b32 v52, v198, v196, s62
  v_perm_b32 v56, v199, v197, s61
  v_perm_b32 v60, v199, v197, s62
  v_perm_b32 v49, v214, v212, s61
  v_perm_b32 v53, v214, v212, s62
  v_perm_b32 v57, v215, v213, s61
  v_perm_b32 v61, v215, v213, s62
  v_perm_b32 v50, v230, v228, s61
  v_perm_b32 v54, v230, v228, s62
  v_perm_b32 v58, v231, v229, s61
  v_perm_b32 v62, v231, v229, s62
  v_perm_b32 v51, v246, v244, s61
  v_perm_b32 v55, v246, v244, s62
  v_perm_b32 v59, v247, v245, s61
  v_perm_b32 v63, v247, v245, s62
  v_mov_b32 v196, v48
  v_mov_b32 v197, v49
  v_mov_b32 v198, v50
  v_mov_b32 v199, v51
  v_mov_b32 v212, v52
  v_mov_b32 v213, v53
  v_mov_b32 v214, v54
  v_mov_b32 v215, v55
  v_mov_b32 v228, v56
  v_mov_b32 v229, v57
  v_mov_b32 v230, v58
  v_mov_b32 v231, v59
  v_mov_b32 v244, v60
  v_mov_b32 v245, v61
  v_mov_b32 v246, v62
  v_mov_b32 v247, v63
  s_waitcnt vmcnt(24)
  v_perm_b32 v48, v138, v136, s61
  v_perm_b32 v52, v138, v136, s62
  v_perm_b32 v56, v139, v137, s61
  v_perm_b32 v60, v139, v137, s62
  v_perm_b32 v49, v154, v152, s61
  v_perm_b32 v53, v154, v152, s62
  v_perm_b32 v57, v155, v153, s61
  v_perm_b32 v61, v155, v153, s62
  v_perm_b32 v50, v170, v168, s61
  v_perm_b32 v54, v170, v168, s62
  v_perm_b32 v58, v171, v169, s61
  v_perm_b32 v62, v171, v169, s62
  v_perm_b32 v51, v186, v184, s61
  v_perm_b32 v55, v186, v184, s62
  v_perm_b32 v59, v187, v185, s61
  v_perm_b32 v63, v187, v185, s62
  v_mov_b32 v136, v48
  v_mov_b32 v137, v49
  v_mov_b32 v138, v50
  v_mov_b32 v139, v51
  v_mov_b32 v152, v52
  v_mov_b32 v153, v53
  v_mov_b32 v154, v54
  v_mov_b32 v155, v55
  v_mov_b32 v168, v56
  v_mov_b32 v169, v57
  v_mov_b32 v170, v58
  v_mov_b32 v171, v59
  v_mov_b32 v184, v60
  v_mov_b32 v185, v61
  v_mov_b32 v186, v62
  v_mov_b32 v187, v63
  s_waitcnt vmcnt(16)
  v_perm_b32 v48, v202, v200, s61
  v_perm_b32 v52, v202, v200, s62
  v_perm_b32 v56, v203, v201, s61
  v_perm_b32 v60, v203, v201, s62
  v_perm_b32 v49, v218, v216, s61
  v_perm_b32 v53, v218, v216, s62
  v_perm_b32 v57, v219, v217, s61
  v_perm_b32 v61, v219, v217, s62
  v_perm_b32 v50, v234, v232, s61
  v_perm_b32 v54, v234, v232, s62
  v_perm_b32 v58, v235, v233, s61
  v_perm_b32 v62, v235, v233, s62
  v_perm_b32 v51, v250, v248, s61
  v_perm_b32 v55, v250, v248, s62
  v_perm_b32 v59, v251, v249, s61
  v_perm_b32 v63, v251, v249, s62
  v_mov_b32 v200, v48
  v_mov_b32 v201, v49
  v_mov_b32 v202, v50
  v_mov_b32 v203, v51
  v_mov_b32 v216, v52
  v_mov_b32 v217, v53
  v_mov_b32 v218, v54
  v_mov_b32 v219, v55
  v_mov_b32 v232, v56
  v_mov_b32 v233, v57
  v_mov_b32 v234, v58
  v_mov_b32 v235, v59
  v_mov_b32 v248, v60
  v_mov_b32 v249, v61
  v_mov_b32 v250, v62
  v_mov_b32 v251, v63
  s_waitcnt vmcnt(8)
  v_perm_b32 v48, v142, v140, s61
  v_perm_b32 v52, v142, v140, s62
  v_perm_b32 v56, v143, v141, s61
  v_perm_b32 v60, v143, v141, s62
  v_perm_b32 v49, v158, v156, s61
  v_perm_b32 v53, v158, v156, s62
  v_perm_b32 v57, v159, v157, s61
  v_perm_b32 v61, v159, v157, s62
  v_perm_b32 v50, v174, v172, s61
  v_perm_b32 v54, v174, v172, s62
  v_perm_b32 v58, v175, v173, s61
  v_perm_b32 v62, v175, v173, s62
  v_perm_b32 v51, v190, v188, s61
  v_perm_b32 v55, v190, v188, s62
  v_perm_b32 v59, v191, v189, s61
  v_perm_b32 v63, v191, v189, s62
  v_mov_b32 v140, v48
  v_mov_b32 v141, v49
  v_mov_b32 v142, v50
  v_mov_b32 v143, v51
  v_mov_b32 v156, v52
  v_mov_b32 v157, v53
  v_mov_b32 v158, v54
  v_mov_b32 v159, v55
  v_mov_b32 v172, v56
  v_mov_b32 v173, v57
  v_mov_b32 v174, v58
  v_mov_b32 v175, v59
  v_mov_b32 v188, v60
  v_mov_b32 v189, v61
  v_mov_b32 v190, v62
  v_mov_b32 v191, v63
  s_waitcnt vmcnt(0)
  v_perm_b32 v48, v206, v204, s61
  v_perm_b32 v52, v206, v204, s62
  v_perm_b32 v56, v207, v205, s61
  v_perm_b32 v60, v207, v205, s62
  v_perm_b32 v49, v222, v220, s61
  v_perm_b32 v53, v222, v220, s62
  v_perm_b32 v57, v223, v221, s61
  v_perm_b32 v61, v223, v221, s62
  v_perm_b32 v50, v238, v236, s61
  v_perm_b32 v54, v238, v236, s62
  v_perm_b32 v58, v239, v237, s61
  v_perm_b32 v62, v239, v237, s62
  v_perm_b32 v51, v254, v252, s61
  v_perm_b32 v55, v254, v252, s62
  v_perm_b32 v59, v255, v253, s61
  v_perm_b32 v63, v255, v253, s62
  v_mov_b32 v204, v48
  v_mov_b32 v205, v49
  v_mov_b32 v206, v50
  v_mov_b32 v207, v51
  v_mov_b32 v220, v52
  v_mov_b32 v221, v53
  v_mov_b32 v222, v54
  v_mov_b32 v223, v55
  v_mov_b32 v236, v56
  v_mov_b32 v237, v57
  v_mov_b32 v238, v58
  v_mov_b32 v239, v59
  v_mov_b32 v252, v60
  v_mov_b32 v253, v61
  v_mov_b32 v254, v62
  v_mov_b32 v255, v63
L_wd_12:
  s_sub_u32 s56, s56, 1
  s_cbranch_scc1 L_timeout
  s_mov_b64 exec, 1
  buffer_load_dword v1, off, s[48:51], 0 offset:32 sc1
  s_mov_b64 exec, -1
  s_waitcnt vmcnt(0)
  v_readfirstlane_b32 s57, v1
  s_nop 0
  s_and_b32 s58, s57, 0xffff
  s_cmp_ge_u32 s58, 32
  s_cbranch_scc1 L_wd_13
  s_sleep 8
  s_branch L_wd_12
L_wd_13:
L_wd_14:
  s_sub_u32 s56, s56, 1
  s_cbranch_scc1 L_timeout
  s_mov_b64 exec, 1
  buffer_load_dword v1, off, s[48:51], 0 offset:228 sc1
  s_mov_b64 exec, -1
  s_waitcnt vmcnt(0)
  v_readfirstlane_b32 s57, v1
  s_nop 0
  s_cmp_ge_u32 s57, 1
  s_cbranch_scc1 L_wd_15
  s_sleep 8
  s_branch L_wd_14
L_wd_15:
  s_lshl_b32 s61, s60, 12
  s_lshl_b32 s62, s6, 7
  s_add_u32 s61, s61, s62
L_o_w0:
  s_sub_u32 s56, s56, 1
  s_cbranch_scc1 L_timeout
  s_sleep 8
  buffer_load_dword v1, off, s[52:55], s61 sc1
  s_waitcnt vmcnt(0)
  v_cmp_eq_u32 vcc, 0, v1
  s_cbranch_vccnz L_o_w0
  s_lshl_b32 s75, s4, 11
  v_mov_b32 v120, -1
  v_mov_b32 v121, -1
  v_mov_b32 v122, -1
  v_mov_b32 v123, -1
  s_add_u32 s63, s59, 60
  s_lshl_b32 s63, s63, 20
  s_add_u32 s63, s63, 67108864
  s_add_u32 s61, s63, 0
  buffer_store_dwordx4 v[120:123], v16, s[52:55], s61 offen sc1
  s_add_u32 s61, s63, 32768
  buffer_store_dwordx4 v[120:123], v16, s[52:55], s61 offen sc1
  s_add_u32 s61, s63, 65536
  buffer_store_dwordx4 v[120:123], v16, s[52:55], s61 offen sc1
  s_add_u32 s61, s63, 98304
  buffer_store_dwordx4 v[120:123], v16, s[52:55], s61 offen sc1
  s_add_u32 s61, s63, 524288
  buffer_store_dwordx4 v[120:123], v16, s[52:55], s61 offen sc1
  s_add_u32 s61, s63, 557056
  buffer_store_dwordx4 v[120:123], v16, s[52:55], s61 offen sc1
  s_add_u32 s61, s63, 589824
  buffer_store_dwordx4 v[120:123], v16, s[52:55], s61 offen sc1
  s_add_u32 s61, s63, 622592
  buffer_store_dwordx4 v[120:123], v16, s[52:55], s61 offen sc1
  s_barrier
  s_mov_b32 s70, 0
  s_mov_b32 s71, s78
  s_mov_b32 s72, s78
  s_lshl_b32 s61, s71, 18
  s_add_u32 s62, s61, 16777216
  s_add_u32 m0, s73, 0
  s_nop 0
  buffer_load_dwordx4 v15, s[52:55], s62 offen sc1 lds
  buffer_load_dwordx4 v15, s[52:55], s62 offen offset:1024 sc1 lds
  s_add_u32 s62, s61, 33554432
  s_add_u32 m0, s73, 8192
  s_nop 0
  buffer_load_dwordx4 v15, s[52:55], s62 offen sc1 lds
  buffer_load_dwordx4 v15, s[52:55], s62 offen offset:1024 sc1 lds
  s_add_u32 s62, s61, 50331648
  s_add_u32 m0, s73, 16384
  s_nop 0
  buffer_load_dwordx4 v15, s[52:55], s62 offen sc1 lds
  buffer_load_dwordx4 v15, s[52:55], s62 offen offset:1024 sc1 lds
  s_xor_b32 s73, s73, 98304
  s_lshl_b32 s61, s71, 13
  s_add_u32 s61, s61, 2097152
  s_mov_b32 m0, s75
  s_nop 0
  buffer_load_dwordx4 v5, s[52:55], s61 offen sc1 lds
  buffer_load_dwordx4 v5, s[52:55], s61 offen offset:1024 sc1 lds
  s_mov_b32 s74, 0
  v_mov_b32 v22, 0
  s_waitcnt vmcnt(0)
L_o_loop:
  s_waitcnt vmcnt(8)
  s_barrier
  ds_read_b128 v[56:59], v7 offset:0
  ds_read_b128 v[60:63], v7 offset:1024
  ds_read_b128 v[64:67], v7 offset:2048
  ds_read_b128 v[68:71], v7 offset:3072
  ds_read_b128 v[72:75], v7 offset:4096
  ds_read_b128 v[76:79], v7 offset:5120
  ds_read_b128 v[80:83], v7 offset:6144
  ds_read_b128 v[84:87], v7 offset:7168
  ds_read_b128 v[40:43], v7 offset:12288
  ds_read_b128 v[44:47], v7 offset:13312
  ds_read_b128 v[48:51], v7 offset:14336
  ds_read_b128 v[52:55], v7 offset:15360
  ds_read_b128 v[24:27], v7 offset:8192
  ds_read_b128 v[28:31], v7 offset:9216
  s_waitcnt lgkmcnt(6)
  ds_read_b128 v[32:35], v7 offset:10240
  ds_read_b128 v[36:39], v7 offset:11264
  v_mov_b64 v[88:89], 0
  v_mov_b64 v[90:91], 0
  v_mov_b64 v[92:93], 0
  v_mov_b64 v[94:95], 0
  v_mov_b64 v[96:97], 0
  v_mov_b64 v[98:99], 0
  v_mov_b64 v[100:101], 0
  v_mov_b64 v[102:103], 0
  s_waitcnt lgkmcnt(4)
  v_mfma_f32_16x16x32_bf16 v[104:107], v[40:43], v[72:75], 0
  v_mfma_f32_16x16x32_bf16 v[104:107], v[44:47], v[76:79], v[104:107]
  v_mfma_f32_16x16x32_bf16 v[104:107], v[48:51], v[80:83], v[104:107]
  v_mfma_f32_16x16x32_bf16 v[104:107], v[52:55], v[84:87], v[104:107]
  s_waitcnt lgkmcnt(0)
  v_mfma_f32_16x16x32_bf16 v[112:115], v[24:27], v[56:59], 0
  v_mfma_f32_16x16x32_bf16 v[112:115], v[28:31], v[60:63], v[112:115]
  v_mfma_f32_16x16x32_bf16 v[112:115], v[32:35], v[64:67], v[112:115]
  v_mfma_f32_16x16x32_bf16 v[112:115], v[36:39], v[68:71], v[112:115]
  v_mfma_f32_16x16x32_bf16 v[116:119], v[24:27], v[72:75], 0
  v_mfma_f32_16x16x32_bf16 v[116:119], v[28:31], v[76:79], v[116:119]
  v_mfma_f32_16x16x32_bf16 v[116:119], v[32:35], v[80:83], v[116:119]
  v_mfma_f32_16x16x32_bf16 v[116:119], v[36:39], v[84:87], v[116:119]
  s_lshl_b32 s63, s71, 13
  s_add_u32 s63, s63, 2097152
  ds_read_b128 v[24:27], v6 offset:0
  ds_read_b128 v[28:31], v6 offset:1024
  ds_read_b128 v[32:35], v6 offset:2048
  ds_read_b128 v[36:39], v6 offset:3072
  ds_read_b128 v[40:43], v6 offset:4096
  ds_read_b128 v[44:47], v6 offset:5120
  ds_read_b128 v[48:51], v6 offset:6144
  ds_read_b128 v[52:55], v6 offset:7168
  v_cndmask_b32 v104, v21, v104, s[80:81]
  v_cndmask_b32 v105, v21, v105, s[82:83]
  v_cndmask_b32 v106, v21, v106, s[84:85]
  v_cndmask_b32 v107, v21, v107, s[86:87]
  v_cndmask_b32 v112, v21, v112, s[80:81]
  v_cndmask_b32 v113, v21, v113, s[82:83]
  v_cndmask_b32 v114, v21, v114, s[84:85]
  v_cndmask_b32 v115, v21, v115, s[86:87]
  s_waitcnt lgkmcnt(0)
  v_max_u32 v1, v24, v25
  v_max3_u32 v1, v1, v26, v27
  v_max3_u32 v1, v1, v28, v29
  v_max3_u32 v1, v1, v30, v31
  v_max3_u32 v1, v1, v32, v33
  v_max3_u32 v1, v1, v34, v35
  v_max3_u32 v1, v1, v36, v37
  v_max3_u32 v1, v1, v38, v39
  v_max3_u32 v1, v1, v40, v41
  v_max3_u32 v1, v1, v42, v43
  v_max3_u32 v1, v1, v44, v45
  v_max3_u32 v1, v1, v46, v47
  v_max3_u32 v1, v1, v48, v49
  v_max3_u32 v1, v1, v50, v51
  v_max3_u32 v1, v1, v52, v53
  v_max3_u32 v1, v1, v54, v55
  v_cmp_eq_u32 vcc, -1, v1
  s_cbranch_vccz L_o_go
  buffer_load_dwordx4 v[120:123], v5, s[52:55], s63 offen sc1
  buffer_load_dwordx4 v[124:127], v5, s[52:55], s63 offen offset:1024 sc1
  s_barrier
  s_waitcnt vmcnt(2)
  v_mov_b32 v1, s70
  s_mov_b64 exec, 1
  buffer_store_dword v1, v19, s[52:55], 0 offen sc1
  s_mov_b64 exec, -1
  s_waitcnt vmcnt(1)
L_o_pa:
  v_max3_u32 v1, v120, v121, v122
  v_max3_u32 v2, v123, v124, v125
  v_max3_u32 v1, v1, v126, v127
  v_max_u32 v1, v1, v2
  v_cmp_eq_u32 vcc, -1, v1
  s_cbranch_vccz L_o_got
L_o_pb:
  s_sub_u32 s56, s56, 1
  s_cbranch_scc1 L_timeout
  v_cmp_ge_u32 vcc, s74, v22
  s_sub_u32 s76, s70, 1
  s_max_i32 s76, s76, 0
  s_cbranch_vccnz L_o_idle
  s_cmp_lt_u32 s71, 44
  s_cbranch_scc1 L_o_idle
  s_cmp_ge_u32 s74, s76
  s_cselect_b32 s57, s71, 0
  s_cmp_ge_u32 s57, 60
  s_cbranch_scc1 L_o_tight
L_o_rp_16:
  s_cmp_ge_u32 s74, s76
  s_cbranch_scc1 L_o_rp_17
L_o_fw_18:
  v_cmp_ge_u32 vcc, s74, v22
  s_cbranch_vccz L_o_fw_19
  s_sub_u32 s56, s56, 1
  s_cbranch_scc1 L_timeout
  buffer_load_dword v22, v20, s[52:55], 0 offen sc1
  s_waitcnt vmcnt(0)
  s_branch L_o_fw_18
L_o_fw_19:
  s_lshl_b32 s61, s72, 20
  s_add_u32 s61, s61, 67108864
  buffer_load_dwordx4 v[24:27], v17, s[52:55], s61 offen sc1
  s_add_u32 s61, s61, 4096
  buffer_load_dwordx4 v[28:31], v17, s[52:55], s61 offen sc1
  s_add_u32 s61, s61, 4096
  buffer_load_dwordx4 v[32:35], v17, s[52:55], s61 offen sc1
  s_add_u32 s61, s61, 4096
  buffer_load_dwordx4 v[36:39], v17, s[52:55], s61 offen sc1
  s_add_u32 s61, s61, 4096
  buffer_load_dwordx4 v[40:43], v17, s[52:55], s61 offen sc1
  s_add_u32 s61, s61, 4096
  buffer_load_dwordx4 v[44:47], v17, s[52:55], s61 offen sc1
  s_add_u32 s61, s61, 4096
  buffer_load_dwordx4 v[48:51], v17, s[52:55], s61 offen sc1
  s_add_u32 s61, s61, 4096
  buffer_load_dwordx4 v[52:55], v17, s[52:55], s61 offen sc1
  s_waitcnt vmcnt(0)
  v_mfma_f32_16x16x32_bf16 v[120:123], v[8:11], v[24:27], 0
  v_mfma_f32_16x16x32_bf16 v[120:123], v[8:11], v[28:31], v[120:123]
  v_mfma_f32_16x16x32_bf16 v[120:123], v[8:11], v[32:35], v[120:123]
  v_mfma_f32_16x16x32_bf16 v[120:123], v[8:11], v[36:39], v[120:123]
  v_mfma_f32_16x16x32_bf16 v[120:123], v[8:11], v[40:43], v[120:123]
  v_mfma_f32_16x16x32_bf16 v[120:123], v[8:11], v[44:47], v[120:123]
  v_mfma_f32_16x16x32_bf16 v[120:123], v[8:11], v[48:51], v[120:123]
  v_mfma_f32_16x16x32_bf16 v[120:123], v[8:11], v[52:55], v[120:123]
  s_lshl_b32 s61, s72, 16
  s_add_u32 s74, s74, 1
  s_cmp_ge_u32 s72, 44
  s_cselect_b32 s57, 4, 2
  s_add_u32 s72, s72, s57
  s_nop 2
  v_cvt_pk_bf16_f32 v120, v120, v121
  v_cvt_pk_bf16_f32 v121, v122, v123
  s_mov_b32 exec_hi, 0
  buffer_store_dwordx2 v[120:121], v18, s[44:47], s61 offen
  s_mov_b64 exec, -1
  s_branch L_o_rp_16
L_o_rp_17:
L_o_idle:
  s_sleep 16
  buffer_load_dword v22, v20, s[52:55], 0 offen sc1
  s_lshl_b32 s57, s6, 6
  s_add_u32 s57, s57, s75
  s_add_u32 s58, s57, s63
  s_mov_b64 exec, 1
  buffer_load_dword v1, off, s[52:55], s58 sc1
  s_waitcnt vmcnt(0)
  v_cmp_eq_u32 vcc, -1, v1
  s_mov_b64 exec, -1
  s_cbranch_vccnz L_o_pb
  buffer_load_dwordx4 v[120:123], v5, s[52:55], s63 offen sc1
  buffer_load_dwordx4 v[124:127], v5, s[52:55], s63 offen offset:1024 sc1
  s_waitcnt vmcnt(0)
  s_branch L_o_pa
L_o_tight:
  buffer_load_dwordx4 v[120:123], v5, s[52:55], s63 offen sc1
  buffer_load_dwordx4 v[124:127], v5, s[52:55], s63 offen offset:1024 sc1
  s_sleep 8
L_o_t2:
  buffer_load_dwordx4 v[96:99], v5, s[52:55], s63 offen sc1
  buffer_load_dwordx4 v[100:103], v5, s[52:55], s63 offen offset:1024 sc1
  s_waitcnt vmcnt(2)
  v_max3_u32 v1, v120, v121, v122
  v_max3_u32 v2, v123, v124, v125
  v_max3_u32 v1, v1, v126, v127
  v_max_u32 v1, v1, v2
  v_cmp_eq_u32 vcc, -1, v1
  s_cbranch_vccz L_o_got
  s_sub_u32 s56, s56, 1
  s_cbranch_scc1 L_timeout
  buffer_load_dwordx4 v[120:123], v5, s[52:55], s63 offen sc1
  buffer_load_dwordx4 v[124:127], v5, s[52:55], s63 offen offset:1024 sc1
  s_waitcnt vmcnt(2)
  v_max3_u32 v1, v96, v97, v98
  v_max3_u32 v2, v99, v100, v101
  v_max3_u32 v1, v1, v102, v103
  v_max_u32 v1, v1, v2
  v_cmp_eq_u32 vcc, -1, v1
  s_cbranch_vccnz L_o_t2
  ds_write_b128 v5, v[96:99] offset:0
  ds_write_b128 v5, v[100:103] offset:1024
  s_branch L_o_tb
L_o_got:
  ds_write_b128 v5, v[120:123] offset:0
  ds_write_b128 v5, v[124:127] offset:1024
L_o_tb:
  s_waitcnt lgkmcnt(0)
  s_barrier
  ds_read_b128 v[24:27], v6 offset:0
  ds_read_b128 v[28:31], v6 offset:1024
  ds_read_b128 v[32:35], v6 offset:2048
  ds_read_b128 v[36:39], v6 offset:3072
  ds_read_b128 v[40:43], v6 offset:4096
  ds_read_b128 v[44:47], v6 offset:5120
  ds_read_b128 v[48:51], v6 offset:6144
  ds_read_b128 v[52:55], v6 offset:7168
L_o_go:
  s_mov_b32 s76, 1
  s_mov_b32 s61, 0xc0000000
  s_cmp_ge_u32 s74, s70
  s_cbranch_scc1 L_o_nored
  v_cmp_ge_u32 vcc, s74, v22
  s_add_u32 s77, s74, 2
  s_cmp_lt_u32 s77, s70
  s_cbranch_scc1 L_o_red
  s_cbranch_vccnz L_o_nored
L_o_red:
  s_mov_b32 s76, 0
L_o_fw_20:
  v_cmp_ge_u32 vcc, s74, v22
  s_cbranch_vccz L_o_fw_21
  s_sub_u32 s56, s56, 1
  s_cbranch_scc1 L_timeout
  buffer_load_dword v22, v20, s[52:55], 0 offen sc1
  s_waitcnt vmcnt(0)
  s_branch L_o_fw_20
L_o_fw_21:
  s_lshl_b32 s61, s72, 20
  s_add_u32 s61, s61, 67108864
L_o_nored:
  s_mov_b32 s68, s61
  s_lshl_b32 s69, s75, 2
  s_cmp_ge_u32 s71, 60
  s_cbranch_scc1 L_o_lastkv
  s_sub_u32 s57, s71, 44
  s_cmp_gt_u32 s57, 1
  s_cbranch_scc1 L_o_pok
  s_lshl_b32 s61, s60, 12
  s_lshl_b32 s62, s6, 7
  s_add_u32 s61, s61, s62
L_o_w1:
  s_sub_u32 s56, s56, 1
  s_cbranch_scc1 L_timeout
  buffer_load_dword v1, off, s[52:55], s61 sc1
  s_waitcnt vmcnt(0)
  v_cmp_gt_u32 vcc, 32, v1
  s_cbranch_vccnz L_o_w1
L_o_pok:
  s_cmp_ge_u32 s71, 44
  s_cselect_b32 s57, 4, 2
  s_add_u32 s63, s71, s57
  s_cmp_gt_u32 s63, 63
  s_cselect_b32 s63, 0x3000, s63
  s_lshl_b32 s61, s63, 18
  s_waitcnt lgkmcnt(7)
  v_smfmac_f32_16x16x64_bf16 v[88:91], v[24:27], a[0:7], v4
  s_add_u32 m0, s69, 98304
  v_smfmac_f32_16x16x64_bf16 v[92:95], v[24:27], a[64:71], v4
  buffer_load_dwordx4 v17, s[52:55], s68 offen sc1 lds
  s_waitcnt lgkmcnt(6)
  v_smfmac_f32_16x16x64_bf16 v[88:91], v[28:31], a[8:15], v4
  s_add_u32 m0, s69, 99328
  s_add_u32 s68, s68, 4096
  v_smfmac_f32_16x16x64_bf16 v[92:95], v[28:31], a[72:79], v4
  buffer_load_dwordx4 v17, s[52:55], s68 offen sc1 lds
  s_waitcnt lgkmcnt(5)
  v_smfmac_f32_16x16x64_bf16 v[88:91], v[32:35], a[16:23], v4
  s_add_u32 m0, s69, 100352
  s_add_u32 s68, s68, 4096
  v_smfmac_f32_16x16x64_bf16 v[92:95], v[32:35], a[80:87], v4
  buffer_load_dwordx4 v17, s[52:55], s68 offen sc1 lds
  s_waitcnt lgkmcnt(4)
  v_smfmac_f32_16x16x64_bf16 v[88:91], v[36:39], a[24:31], v4
  s_add_u32 m0, s69, 101376
  s_add_u32 s68, s68, 4096
  v_smfmac_f32_16x16x64_bf16 v[92:95], v[36:39], a[88:95], v4
  buffer_load_dwordx4 v17, s[52:55], s68 offen sc1 lds
  s_waitcnt lgkmcnt(3)
  v_smfmac_f32_16x16x64_bf16 v[88:91], v[40:43], a[32:39], v4
  s_add_u32 m0, s69, 102400
  s_add_u32 s68, s68, 4096
  v_smfmac_f32_16x16x64_bf16 v[92:95], v[40:43], a[96:103], v4
  buffer_load_dwordx4 v17, s[52:55], s68 offen sc1 lds
  s_waitcnt lgkmcnt(2)
  v_smfmac_f32_16x16x64_bf16 v[88:91], v[44:47], a[40:47], v4
  s_add_u32 m0, s69, 103424
  s_add_u32 s68, s68, 4096
  v_smfmac_f32_16x16x64_bf16 v[92:95], v[44:47], a[104:111], v4
  buffer_load_dwordx4 v17, s[52:55], s68 offen sc1 lds
  s_waitcnt lgkmcnt(1)
  v_smfmac_f32_16x16x64_bf16 v[88:91], v[48:51], a[48:55], v4
  s_add_u32 m0, s69, 104448
  s_add_u32 s68, s68, 4096
  v_smfmac_f32_16x16x64_bf16 v[92:95], v[48:51], a[112:119], v4
  buffer_load_dwordx4 v17, s[52:55], s68 offen sc1 lds
  s_waitcnt lgkmcnt(0)
  v_smfmac_f32_16x16x64_bf16 v[88:91], v[52:55], a[56:63], v4
  s_add_u32 m0, s69, 105472
  s_add_u32 s68, s68, 4096
  v_smfmac_f32_16x16x64_bf16 v[92:95], v[52:55], a[120:127], v4
  buffer_load_dwordx4 v17, s[52:55], s68 offen sc1 lds
  v_smfmac_f32_16x16x64_bf16 v[96:99], v[24:27], a[128:135], v4
  s_add_u32 s62, s61, 16777216
  s_add_u32 m0, s73, 0
  v_smfmac_f32_16x16x64_bf16 v[100:103], v[24:27], a[192:199], v4
  buffer_load_dwordx4 v15, s[52:55], s62 offen sc1 lds
  v_add_f32 v88, v88, v90
  v_add_f32 v89, v89, v91
  v_cvt_pk_bf16_f32 v88, v88, v89
  v_add_f32 v92, v92, v94
  v_add_f32 v93, v93, v95
  v_cvt_pk_bf16_f32 v92, v92, v93
  ds_write_b32 v12, v88 offset:8192
  ds_write_b32 v12, v92 offset:8448
  v_smfmac_f32_16x16x64_bf16 v[96:99], v[28:31], a[136:143], v4
  v_smfmac_f32_16x16x64_bf16 v[100:103], v[28:31], a[200:207], v4
  buffer_load_dwordx4 v15, s[52:55], s62 offen offset:1024 sc1 lds
  v_smfmac_f32_16x16x64_bf16 v[96:99], v[32:35], a[144:151], v4
  s_add_u32 s62, s61, 33554432
  s_add_u32 m0, s73, 8192
  v_smfmac_f32_16x16x64_bf16 v[100:103], v[32:35], a[208:215], v4
  buffer_load_dwordx4 v15, s[52:55], s62 offen sc1 lds
  v_smfmac_f32_16x16x64_bf16 v[96:99], v[36:39], a[152:159], v4
  v_smfmac_f32_16x16x64_bf16 v[100:103], v[36:39], a[216:223], v4
  buffer_load_dwordx4 v15, s[52:55], s62 offen offset:1024 sc1 lds
  s_waitcnt lgkmcnt(0)
  s_barrier
  v_smfmac_f32_16x16x64_bf16 v[96:99], v[40:43], a[160:167], v4
  s_add_u32 s62, s61, 50331648
  s_add_u32 m0, s73, 16384
  v_smfmac_f32_16x16x64_bf16 v[100:103], v[40:43], a[224:231], v4
  buffer_load_dwordx4 v15, s[52:55], s62 offen sc1 lds
  ds_read_b64_tr_b16 v[24:25], v13 offset:8192
  ds_read_b64_tr_b16 v[26:27], v13 offset:8224
  v_smfmac_f32_16x16x64_bf16 v[96:99], v[44:47], a[168:175], v4
  v_smfmac_f32_16x16x64_bf16 v[100:103], v[44:47], a[232:239], v4
  buffer_load_dwordx4 v15, s[52:55], s62 offen offset:1024 sc1 lds
  ds_read_b64_tr_b16 v[28:29], v13 offset:8704
  ds_read_b64_tr_b16 v[30:31], v13 offset:8736
  v_smfmac_f32_16x16x64_bf16 v[96:99], v[48:51], a[176:183], v4
  s_xor_b32 s73, s73, 98304
  v_smfmac_f32_16x16x64_bf16 v[100:103], v[48:51], a[240:247], v4
  ds_read_b64_tr_b16 v[32:33], v13 offset:9216
  ds_read_b64_tr_b16 v[34:35], v13 offset:9248
  v_smfmac_f32_16x16x64_bf16 v[96:99], v[52:55], a[184:191], v4
  v_smfmac_f32_16x16x64_bf16 v[100:103], v[52:55], a[248:255], v4
  ds_read_b64_tr_b16 v[36:37], v13 offset:9728
  ds_read_b64_tr_b16 v[38:39], v13 offset:9760
  s_waitcnt lgkmcnt(0)
  v_mfma_f32_16x16x32_bf16 v[88:91], v[24:27], v[56:59], 0
  v_mfma_f32_16x16x32_bf16 v[88:91], v[28:31], v[60:63], v[88:91]
  v_mfma_f32_16x16x32_bf16 v[88:91], v[32:35], v[64:67], v[88:91]
  v_mfma_f32_16x16x32_bf16 v[88:91], v[36:39], v[68:71], v[88:91]
  v_mfma_f32_16x16x32_bf16 v[92:95], v[24:27], v[72:75], 0
  v_mfma_f32_16x16x32_bf16 v[92:95], v[28:31], v[76:79], v[92:95]
  v_mfma_f32_16x16x32_bf16 v[92:95], v[32:35], v[80:83], v[92:95]
  v_mfma_f32_16x16x32_bf16 v[92:95], v[36:39], v[84:87], v[92:95]
  s_waitcnt vmcnt(14)
  v_mov_b32 v1, s70
  s_mov_b64 exec, 1
  buffer_store_dword v1, v19, s[52:55], 0 offen sc1
  s_mov_b64 exec, -1
  s_branch L_o_kvd
L_o_lastkv:
  s_waitcnt lgkmcnt(7)
  v_smfmac_f32_16x16x64_bf16 v[88:91], v[24:27], a[0:7], v4
  s_add_u32 m0, s69, 98304
  v_smfmac_f32_16x16x64_bf16 v[92:95], v[24:27], a[64:71], v4
  buffer_load_dwordx4 v17, s[52:55], s68 offen sc1 lds
  s_waitcnt lgkmcnt(6)
  v_smfmac_f32_16x16x64_bf16 v[88:91], v[28:31], a[8:15], v4
  s_add_u32 m0, s69, 99328
  s_add_u32 s68, s68, 4096
  v_smfmac_f32_16x16x64_bf16 v[92:95], v[28:31], a[72:79], v4
  buffer_load_dwordx4 v17, s[52:55], s68 offen sc1 lds
  s_waitcnt lgkmcnt(5)
  v_smfmac_f32_16x16x64_bf16 v[88:91], v[32:35], a[16:23], v4
  s_add_u32 m0, s69, 100352
  s_add_u32 s68, s68, 4096
  v_smfmac_f32_16x16x64_bf16 v[92:95], v[32:35], a[80:87], v4
  buffer_load_dwordx4 v17, s[52:55], s68 offen sc1 lds
  s_waitcnt lgkmcnt(4)
  v_smfmac_f32_16x16x64_bf16 v[88:91], v[36:39], a[24:31], v4
  s_add_u32 m0, s69, 101376
  s_add_u32 s68, s68, 4096
  v_smfmac_f32_16x16x64_bf16 v[92:95], v[36:39], a[88:95], v4
  buffer_load_dwordx4 v17, s[52:55], s68 offen sc1 lds
  s_waitcnt lgkmcnt(3)
  v_smfmac_f32_16x16x64_bf16 v[88:91], v[40:43], a[32:39], v4
  s_add_u32 m0, s69, 102400
  s_add_u32 s68, s68, 4096
  v_smfmac_f32_16x16x64_bf16 v[92:95], v[40:43], a[96:103], v4
  buffer_load_dwordx4 v17, s[52:55], s68 offen sc1 lds
  s_waitcnt lgkmcnt(2)
  v_smfmac_f32_16x16x64_bf16 v[88:91], v[44:47], a[40:47], v4
  s_add_u32 m0, s69, 103424
  s_add_u32 s68, s68, 4096
  v_smfmac_f32_16x16x64_bf16 v[92:95], v[44:47], a[104:111], v4
  buffer_load_dwordx4 v17, s[52:55], s68 offen sc1 lds
  s_waitcnt lgkmcnt(1)
  v_smfmac_f32_16x16x64_bf16 v[88:91], v[48:51], a[48:55], v4
  s_add_u32 m0, s69, 104448
  s_add_u32 s68, s68, 4096
  v_smfmac_f32_16x16x64_bf16 v[92:95], v[48:51], a[112:119], v4
  buffer_load_dwordx4 v17, s[52:55], s68 offen sc1 lds
  s_waitcnt lgkmcnt(0)
  v_smfmac_f32_16x16x64_bf16 v[88:91], v[52:55], a[56:63], v4
  s_add_u32 m0, s69, 105472
  s_add_u32 s68, s68, 4096
  v_smfmac_f32_16x16x64_bf16 v[92:95], v[52:55], a[120:127], v4
  buffer_load_dwordx4 v17, s[52:55], s68 offen sc1 lds
  s_waitcnt vmcnt(8)
  v_mov_b64 v[96:97], 0
  v_mov_b64 v[98:99], 0
  v_mov_b64 v[100:101], 0
  v_mov_b64 v[102:103], 0
  v_smfmac_f32_16x16x64_bf16 v[96:99], v[24:27], a[128:135], v4
  s_nop 0
  v_smfmac_f32_16x16x64_bf16 v[100:103], v[24:27], a[192:199], v4
  v_add_f32 v88, v88, v90
  v_add_f32 v89, v89, v91
  v_cvt_pk_bf16_f32 v88, v88, v89
  v_add_f32 v92, v92, v94
  v_add_f32 v93, v93, v95
  v_cvt_pk_bf16_f32 v92, v92, v93
  ds_write_b32 v12, v88 offset:8192
  ds_write_b32 v12, v92 offset:8448
  v_smfmac_f32_16x16x64_bf16 v[96:99], v[28:31], a[136:143], v4
  v_smfmac_f32_16x16x64_bf16 v[100:103], v[28:31], a[200:207], v4
  v_smfmac_f32_16x16x64_bf16 v[96:99], v[32:35], a[144:151], v4
  v_smfmac_f32_16x16x64_bf16 v[100:103], v[32:35], a[208:215], v4
  v_smfmac_f32_16x16x64_bf16 v[96:99], v[36:39], a[152:159], v4
  v_smfmac_f32_16x16x64_bf16 v[100:103], v[36:39], a[216:223], v4
  s_waitcnt lgkmcnt(0)
  s_barrier
  v_smfmac_f32_16x16x64_bf16 v[96:99], v[40:43], a[160:167], v4
  v_smfmac_f32_16x16x64_bf16 v[100:103], v[40:43], a[224:231], v4
  ds_read_b64_tr_b16 v[24:25], v13 offset:8192
  ds_read_b64_tr_b16 v[26:27], v13 offset:8224
  v_smfmac_f32_16x16x64_bf16 v[96:99], v[44:47], a[168:175], v4
  v_smfmac_f32_16x16x64_bf16 v[100:103], v[44:47], a[232:239], v4
  ds_read_b64_tr_b16 v[28:29], v13 offset:8704
  ds_read_b64_tr_b16 v[30:31], v13 offset:8736
  v_smfmac_f32_16x16x64_bf16 v[96:99], v[48:51], a[176:183], v4
  v_smfmac_f32_16x16x64_bf16 v[100:103], v[48:51], a[240:247], v4
  ds_read_b64_tr_b16 v[32:33], v13 offset:9216
  ds_read_b64_tr_b16 v[34:35], v13 offset:9248
  v_smfmac_f32_16x16x64_bf16 v[96:99], v[52:55], a[184:191], v4
  v_smfmac_f32_16x16x64_bf16 v[100:103], v[52:55], a[248:255], v4
  ds_read_b64_tr_b16 v[36:37], v13 offset:9728
  ds_read_b64_tr_b16 v[38:39], v13 offset:9760
  s_waitcnt lgkmcnt(0)
  v_mfma_f32_16x16x32_bf16 v[88:91], v[24:27], v[56:59], 0
  v_mfma_f32_16x16x32_bf16 v[88:91], v[28:31], v[60:63], v[88:91]
  v_mfma_f32_16x16x32_bf16 v[88:91], v[32:35], v[64:67], v[88:91]
  v_mfma_f32_16x16x32_bf16 v[88:91], v[36:39], v[68:71], v[88:91]
  v_mfma_f32_16x16x32_bf16 v[92:95], v[24:27], v[72:75], 0
  v_mfma_f32_16x16x32_bf16 v[92:95], v[28:31], v[76:79], v[92:95]
  v_mfma_f32_16x16x32_bf16 v[92:95], v[32:35], v[80:83], v[92:95]
  v_mfma_f32_16x16x32_bf16 v[92:95], v[36:39], v[84:87], v[92:95]
  s_waitcnt vmcnt(8)
  v_mov_b32 v1, s70
  s_mov_b64 exec, 1
  buffer_store_dword v1, v19, s[52:55], 0 offen sc1
  s_mov_b64 exec, -1
L_o_kvd:
  v_add_f32 v96, v96, v98
  v_add_f32 v97, v97, v99
  v_cvt_pk_bf16_f32 v98, v96, v97
  v_cndmask_b32 v96, v98, 0, s[96:97]
  v_cndmask_b32 v97, 0, v98, s[96:97]
  v_add_f32 v100, v100, v102
  v_add_f32 v101, v101, v103
  v_cvt_pk_bf16_f32 v102, v100, v101
  v_cndmask_b32 v100, v102, 0, s[96:97]
  v_cndmask_b32 v101, 0, v102, s[96:97]
  s_lshl_b32 s61, s4, 11
  v_add_u32 v3, s61, v7
  ds_read_b128 v[48:51], v3 offset:16384
  ds_read_b128 v[52:55], v3 offset:17408
  v_xor_b32 v7, 98304, v7
  v_max3_f32 v1, v88, v89, v90
  v_max3_f32 v1, v1, v91, v112
  v_max3_f32 v1, v1, v113, v114
  v_max_f32 v1, v1, v115
  v_mov_b32 v2, v1
  s_nop 1
  v_permlane16_swap_b32 v1, v2
  v_max_f32 v1, v1, v2
  v_mov_b32 v2, v1
  s_nop 1
  v_permlane32_swap_b32 v1, v2
  v_max_f32 v1, v1, v2
  v_mul_f32 v1, s79, v1
  v_fma_f32 v88, v88, s79, -v1
  v_fma_f32 v89, v89, s79, -v1
  v_fma_f32 v90, v90, s79, -v1
  v_fma_f32 v91, v91, s79, -v1
  v_fma_f32 v112, v112, s79, -v1
  v_fma_f32 v113, v113, s79, -v1
  v_fma_f32 v114, v114, s79, -v1
  v_fma_f32 v115, v115, s79, -v1
  v_exp_f32 v88, v88
  v_exp_f32 v89, v89
  v_exp_f32 v90, v90
  v_exp_f32 v91, v91
  v_exp_f32 v112, v112
  v_exp_f32 v113, v113
  v_exp_f32 v114, v114
  v_exp_f32 v115, v115
  v_cvt_pk_bf16_f32 v56, v112, v113
  v_cvt_pk_bf16_f32 v57, v114, v115
  v_mov_b32 v58, 0
  v_mov_b32 v59, 0
  v_cvt_pk_bf16_f32 v64, v88, v89
  v_cvt_pk_bf16_f32 v65, v90, v91
  s_waitcnt lgkmcnt(0)
  v_mfma_f32_16x16x32_bf16 v[32:35], v[48:51], v[56:59], 0
  v_mfma_f32_16x16x32_bf16 v[40:43], v[52:55], v[56:59], 0
  s_nop 1
  v_mfma_f32_16x16x16_bf16 v[32:35], v[96:97], v[64:65], v[32:35]
  s_nop 1
  v_mfma_f32_16x16x16_bf16 v[40:43], v[100:101], v[64:65], v[40:43]
  v_add_f32 v1, v88, v89
  v_add_f32 v2, v90, v91
  v_add_f32 v1, v1, v2
  v_mul_f32 v1, 0.5, v1
  v_add_f32 v1, v1, v112
  v_add_f32 v1, v1, v113
  v_add_f32 v1, v1, v114
  v_add_f32 v1, v1, v115
  v_mov_b32 v2, v1
  s_nop 1
  v_permlane16_swap_b32 v1, v2
  v_add_f32 v1, v1, v2
  v_mov_b32 v2, v1
  s_nop 1
  v_permlane32_swap_b32 v1, v2
  v_add_f32 v1, v1, v2
  v_rcp_f32 v68, v1
  v_max3_f32 v1, v92, v93, v94
  v_max3_f32 v1, v1, v95, v116
  v_max3_f32 v1, v1, v117, v118
  v_max3_f32 v1, v1, v119, v104
  v_max3_f32 v1, v1, v105, v106
  v_max_f32 v1, v1, v107
  v_mov_b32 v2, v1
  s_nop 1
  v_permlane16_swap_b32 v1, v2
  v_max_f32 v1, v1, v2
  v_mov_b32 v2, v1
  s_nop 1
  v_permlane32_swap_b32 v1, v2
  v_max_f32 v1, v1, v2
  v_mul_f32 v1, s79, v1
  v_fma_f32 v92, v92, s79, -v1
  v_fma_f32 v93, v93, s79, -v1
  v_fma_f32 v94, v94, s79, -v1
  v_fma_f32 v95, v95, s79, -v1
  v_fma_f32 v116, v116, s79, -v1
  v_fma_f32 v117, v117, s79, -v1
  v_fma_f32 v118, v118, s79, -v1
  v_fma_f32 v119, v119, s79, -v1
  v_fma_f32 v104, v104, s79, -v1
  v_fma_f32 v105, v105, s79, -v1
  v_fma_f32 v106, v106, s79, -v1
  v_fma_f32 v107, v107, s79, -v1
  v_exp_f32 v92, v92
  v_exp_f32 v93, v93
  v_exp_f32 v94, v94
  v_exp_f32 v95, v95
  v_exp_f32 v116, v116
  v_exp_f32 v117, v117
  v_exp_f32 v118, v118
  v_exp_f32 v119, v119
  v_exp_f32 v104, v104
  v_exp_f32 v105, v105
  v_exp_f32 v106, v106
  v_exp_f32 v107, v107
  v_cvt_pk_bf16_f32 v60, v116, v117
  v_cvt_pk_bf16_f32 v61, v118, v119
  v_cvt_pk_bf16_f32 v62, v104, v105
  v_cvt_pk_bf16_f32 v63, v106, v107
  v_cvt_pk_bf16_f32 v66, v92, v93
  v_cvt_pk_bf16_f32 v67, v94, v95
  v_mfma_f32_16x16x32_bf16 v[36:39], v[48:51], v[60:63], 0
  v_mfma_f32_16x16x32_bf16 v[44:47], v[52:55], v[60:63], 0
  s_nop 1
  v_mfma_f32_16x16x16_bf16 v[36:39], v[96:97], v[66:67], v[36:39]
  s_nop 1
  v_mfma_f32_16x16x16_bf16 v[44:47], v[100:101], v[66:67], v[44:47]
  v_add_f32 v1, v92, v93
  v_add_f32 v2, v94, v95
  v_add_f32 v1, v1, v2
  v_mul_f32 v1, 0.5, v1
  v_add_f32 v1, v1, v116
  v_add_f32 v1, v1, v117
  v_add_f32 v1, v1, v118
  v_add_f32 v1, v1, v119
  v_add_f32 v1, v1, v104
  v_add_f32 v1, v1, v105
  v_add_f32 v1, v1, v106
  v_add_f32 v1, v1, v107
  v_mov_b32 v2, v1
  s_nop 1
  v_permlane16_swap_b32 v1, v2
  v_add_f32 v1, v1, v2
  v_mov_b32 v2, v1
  s_nop 1
  v_permlane32_swap_b32 v1, v2
  v_add_f32 v1, v1, v2
  v_rcp_f32 v69, v1
  v_mul_f32 v32, v32, v68
  v_mul_f32 v33, v33, v68
  v_mul_f32 v34, v34, v68
  v_mul_f32 v35, v35, v68
  v_cvt_pk_bf16_f32 v120, v32, v33
  v_cvt_pk_bf16_f32 v121, v34, v35
  v_mul_f32 v40, v40, v68
  v_mul_f32 v41, v41, v68
  v_mul_f32 v42, v42, v68
  v_mul_f32 v43, v43, v68
  v_cvt_pk_bf16_f32 v122, v40, v41
  v_cvt_pk_bf16_f32 v123, v42, v43
  ds_write_b128 v5, v[120:123] offset:12288
  v_mul_f32 v36, v36, v69
  v_mul_f32 v37, v37, v69
  v_mul_f32 v38, v38, v69
  v_mul_f32 v39, v39, v69
  v_cvt_pk_bf16_f32 v124, v36, v37
  v_cvt_pk_bf16_f32 v125, v38, v39
  v_mul_f32 v44, v44, v69
  v_mul_f32 v45, v45, v69
  v_mul_f32 v46, v46, v69
  v_mul_f32 v47, v47, v69
  v_cvt_pk_bf16_f32 v126, v44, v45
  v_cvt_pk_bf16_f32 v127, v46, v47
  ds_write_b128 v5, v[124:127] offset:13312
  s_waitcnt lgkmcnt(0)
  s_barrier
  ds_read_b128 v[56:59], v6 offset:12288
  ds_read_b128 v[60:63], v6 offset:14336
  ds_read_b128 v[64:67], v6 offset:16384
  ds_read_b128 v[68:71], v6 offset:18432
  ds_read_b128 v[72:75], v6 offset:13312
  ds_read_b128 v[76:79], v6 offset:15360
  ds_read_b128 v[80:83], v6 offset:17408
  ds_read_b128 v[84:87], v6 offset:19456
  s_cmp_ge_u32 s71, 44
  s_cselect_b32 s57, 4, 2
  s_add_u32 s63, s71, s57
  s_cmp_gt_u32 s63, 63
  s_cselect_b32 s63, 0x3000, s63
  buffer_load_dword v22, v20, s[52:55], 0 offen sc1
  s_lshl_b32 s61, s63, 13
  s_add_u32 s61, s61, 2097152
  s_mov_b32 m0, s75
  s_nop 0
  buffer_load_dwordx4 v5, s[52:55], s61 offen sc1 lds
  buffer_load_dwordx4 v5, s[52:55], s61 offen offset:1024 sc1 lds
  s_waitcnt lgkmcnt(0)
  s_lshl_b32 s63, s71, 20
  s_add_u32 s63, s63, 67108864
  v_mfma_f32_16x16x32_bf16 v[24:27], v[56:59], v[128:131], 0
  v_mfma_f32_16x16x32_bf16 v[28:31], v[56:59], v[144:147], 0
  v_mfma_f32_16x16x32_bf16 v[32:35], v[56:59], v[160:163], 0
  v_mfma_f32_16x16x32_bf16 v[36:39], v[56:59], v[176:179], 0
  v_mfma_f32_16x16x32_bf16 v[40:43], v[56:59], v[192:195], 0
  v_mfma_f32_16x16x32_bf16 v[44:47], v[56:59], v[208:211], 0
  v_mfma_f32_16x16x32_bf16 v[48:51], v[56:59], v[224:227], 0
  v_mfma_f32_16x16x32_bf16 v[52:55], v[56:59], v[240:243], 0
  v_mfma_f32_16x16x32_bf16 v[24:27], v[60:63], v[132:135], v[24:27]
  v_mfma_f32_16x16x32_bf16 v[28:31], v[60:63], v[148:151], v[28:31]
  v_mfma_f32_16x16x32_bf16 v[32:35], v[60:63], v[164:167], v[32:35]
  v_mfma_f32_16x16x32_bf16 v[36:39], v[60:63], v[180:183], v[36:39]
  v_mfma_f32_16x16x32_bf16 v[40:43], v[60:63], v[196:199], v[40:43]
  v_mfma_f32_16x16x32_bf16 v[44:47], v[60:63], v[212:215], v[44:47]
  v_mfma_f32_16x16x32_bf16 v[48:51], v[60:63], v[228:231], v[48:51]
  v_mfma_f32_16x16x32_bf16 v[52:55], v[60:63], v[244:247], v[52:55]
  v_mfma_f32_16x16x32_bf16 v[24:27], v[64:67], v[136:139], v[24:27]
  v_mfma_f32_16x16x32_bf16 v[28:31], v[64:67], v[152:155], v[28:31]
  v_mfma_f32_16x16x32_bf16 v[32:35], v[64:67], v[168:171], v[32:35]
  v_mfma_f32_16x16x32_bf16 v[36:39], v[64:67], v[184:187], v[36:39]
  v_mfma_f32_16x16x32_bf16 v[40:43], v[64:67], v[200:203], v[40:43]
  v_mfma_f32_16x16x32_bf16 v[44:47], v[64:67], v[216:219], v[44:47]
  v_mfma_f32_16x16x32_bf16 v[48:51], v[64:67], v[232:235], v[48:51]
  v_mfma_f32_16x16x32_bf16 v[52:55], v[64:67], v[248:251], v[52:55]
  v_mfma_f32_16x16x32_bf16 v[24:27], v[68:71], v[140:143], v[24:27]
  v_mfma_f32_16x16x32_bf16 v[28:31], v[68:71], v[156:159], v[28:31]
  v_mfma_f32_16x16x32_bf16 v[32:35], v[68:71], v[172:175], v[32:35]
  v_mfma_f32_16x16x32_bf16 v[36:39], v[68:71], v[188:191], v[36:39]
  v_mfma_f32_16x16x32_bf16 v[40:43], v[68:71], v[204:207], v[40:43]
  v_mfma_f32_16x16x32_bf16 v[44:47], v[68:71], v[220:223], v[44:47]
  v_mfma_f32_16x16x32_bf16 v[48:51], v[68:71], v[236:239], v[48:51]
  v_mfma_f32_16x16x32_bf16 v[52:55], v[68:71], v[252:255], v[52:55]
  v_mfma_f32_16x16x32_bf16 v[88:91], v[72:75], v[128:131], 0
  v_mfma_f32_16x16x32_bf16 v[92:95], v[72:75], v[144:147], 0
  v_mfma_f32_16x16x32_bf16 v[96:99], v[72:75], v[160:163], 0
  v_cvt_pk_bf16_f32 v120, v24, v28
  v_cvt_pk_bf16_f32 v121, v32, v36
  v_mfma_f32_16x16x32_bf16 v[100:103], v[72:75], v[176:179], 0
  v_cvt_pk_bf16_f32 v122, v40, v44
  v_cvt_pk_bf16_f32 v123, v48, v52
  v_mfma_f32_16x16x32_bf16 v[104:107], v[72:75], v[192:195], 0
  v_min_u32 v120, -2, v120
  v_min_u32 v121, -2, v121
  v_mfma_f32_16x16x32_bf16 v[108:111], v[72:75], v[208:211], 0
  v_min_u32 v122, -2, v122
  v_min_u32 v123, -2, v123
  v_mfma_f32_16x16x32_bf16 v[112:115], v[72:75], v[224:227], 0
  s_add_u32 s61, s63, 0
  buffer_store_dwordx4 v[120:123], v16, s[52:55], s61 offen sc1
  v_cvt_pk_bf16_f32 v124, v25, v29
  v_mfma_f32_16x16x32_bf16 v[116:119], v[72:75], v[240:243], 0
  v_cvt_pk_bf16_f32 v125, v33, v37
  v_cvt_pk_bf16_f32 v126, v41, v45
  v_mfma_f32_16x16x32_bf16 v[88:91], v[76:79], v[132:135], v[88:91]
  v_cvt_pk_bf16_f32 v127, v49, v53
  v_min_u32 v124, -2, v124
  v_mfma_f32_16x16x32_bf16 v[92:95], v[76:79], v[148:151], v[92:95]
  v_min_u32 v125, -2, v125
  v_min_u32 v126, -2, v126
  v_mfma_f32_16x16x32_bf16 v[96:99], v[76:79], v[164:167], v[96:99]
  v_min_u32 v127, -2, v127
  s_add_u32 s61, s63, 32768
  buffer_store_dwordx4 v[124:127], v16, s[52:55], s61 offen sc1
  v_mfma_f32_16x16x32_bf16 v[100:103], v[76:79], v[180:183], v[100:103]
  v_cvt_pk_bf16_f32 v120, v26, v30
  v_cvt_pk_bf16_f32 v121, v34, v38
  v_mfma_f32_16x16x32_bf16 v[104:107], v[76:79], v[196:199], v[104:107]
  v_cvt_pk_bf16_f32 v122, v42, v46
  v_cvt_pk_bf16_f32 v123, v50, v54
  v_mfma_f32_16x16x32_bf16 v[108:111], v[76:79], v[212:215], v[108:111]
  v_min_u32 v120, -2, v120
  v_min_u32 v121, -2, v121
  v_mfma_f32_16x16x32_bf16 v[112:115], v[76:79], v[228:231], v[112:115]
  v_min_u32 v122, -2, v122
  v_min_u32 v123, -2, v123
  v_mfma_f32_16x16x32_bf16 v[116:119], v[76:79], v[244:247], v[116:119]
  s_add_u32 s61, s63, 65536
  buffer_store_dwordx4 v[120:123], v16, s[52:55], s61 offen sc1
  v_cvt_pk_bf16_f32 v124, v27, v31
  v_mfma_f32_16x16x32_bf16 v[88:91], v[80:83], v[136:139], v[88:91]
  v_cvt_pk_bf16_f32 v125, v35, v39
  v_cvt_pk_bf16_f32 v126, v43, v47
  v_mfma_f32_16x16x32_bf16 v[92:95], v[80:83], v[152:155], v[92:95]
  v_cvt_pk_bf16_f32 v127, v51, v55
  v_min_u32 v124, -2, v124
  v_mfma_f32_16x16x32_bf16 v[96:99], v[80:83], v[168:171], v[96:99]
  v_min_u32 v125, -2, v125
  v_min_u32 v126, -2, v126
  v_mfma_f32_16x16x32_bf16 v[100:103], v[80:83], v[184:187], v[100:103]
  v_min_u32 v127, -2, v127
  s_add_u32 s61, s63, 98304
  buffer_store_dwordx4 v[124:127], v16, s[52:55], s61 offen sc1
  v_mfma_f32_16x16x32_bf16 v[104:107], v[80:83], v[200:203], v[104:107]
  v_mfma_f32_16x16x32_bf16 v[108:111], v[80:83], v[216:219], v[108:111]
  v_mfma_f32_16x16x32_bf16 v[112:115], v[80:83], v[232:235], v[112:115]
  v_mfma_f32_16x16x32_bf16 v[116:119], v[80:83], v[248:251], v[116:119]
  v_mfma_f32_16x16x32_bf16 v[88:91], v[84:87], v[140:143], v[88:91]
  v_mfma_f32_16x16x32_bf16 v[92:95], v[84:87], v[156:159], v[92:95]
  v_mfma_f32_16x16x32_bf16 v[96:99], v[84:87], v[172:175], v[96:99]
  v_mfma_f32_16x16x32_bf16 v[100:103], v[84:87], v[188:191], v[100:103]
  v_mfma_f32_16x16x32_bf16 v[104:107], v[84:87], v[204:207], v[104:107]
  v_mfma_f32_16x16x32_bf16 v[108:111], v[84:87], v[220:223], v[108:111]
  v_mfma_f32_16x16x32_bf16 v[112:115], v[84:87], v[236:239], v[112:115]
  v_mfma_f32_16x16x32_bf16 v[116:119], v[84:87], v[252:255], v[116:119]
  v_cvt_pk_bf16_f32 v120, v88, v92
  v_cvt_pk_bf16_f32 v121, v96, v100
  v_cvt_pk_bf16_f32 v122, v104, v108
  s_nop 4
  v_cvt_pk_bf16_f32 v123, v112, v116
  v_min_u32 v120, -2, v120
  v_min_u32 v121, -2, v121
  v_min_u32 v122, -2, v122
  v_min_u32 v123, -2, v123
  s_add_u32 s61, s63, 524288
  buffer_store_dwordx4 v[120:123], v16, s[52:55], s61 offen sc1
  v_cvt_pk_bf16_f32 v124, v89, v93
  v_cvt_pk_bf16_f32 v125, v97, v101
  v_cvt_pk_bf16_f32 v126, v105, v109
  v_cvt_pk_bf16_f32 v127, v113, v117
  v_min_u32 v124, -2, v124
  v_min_u32 v125, -2, v125
  v_min_u32 v126, -2, v126
  v_min_u32 v127, -2, v127
  s_add_u32 s61, s63, 557056
  buffer_store_dwordx4 v[124:127], v16, s[52:55], s61 offen sc1
  v_cvt_pk_bf16_f32 v120, v90, v94
  v_cvt_pk_bf16_f32 v121, v98, v102
  v_cvt_pk_bf16_f32 v122, v106, v110
  v_cvt_pk_bf16_f32 v123, v114, v118
  v_min_u32 v120, -2, v120
  v_min_u32 v121, -2, v121
  v_min_u32 v122, -2, v122
  v_min_u32 v123, -2, v123
  s_add_u32 s61, s63, 589824
  buffer_store_dwordx4 v[120:123], v16, s[52:55], s61 offen sc1
  v_cvt_pk_bf16_f32 v124, v91, v95
  v_cvt_pk_bf16_f32 v125, v99, v103
  v_cvt_pk_bf16_f32 v126, v107, v111
  v_cvt_pk_bf16_f32 v127, v115, v119
  v_min_u32 v124, -2, v124
  v_min_u32 v125, -2, v125
  v_min_u32 v126, -2, v126
  v_min_u32 v127, -2, v127
  s_add_u32 s61, s63, 622592
  buffer_store_dwordx4 v[124:127], v16, s[52:55], s61 offen sc1
  s_cmp_eq_u32 s76, 1
  s_cbranch_scc1 L_o_nored2
  s_waitcnt vmcnt(12)
  s_lshl_b32 s62, s75, 2
  s_add_u32 s62, s62, 98304
  v_add_u32 v3, s62, v6
  ds_read_b128 v[24:27], v3 offset:0
  ds_read_b128 v[28:31], v3 offset:1024
  ds_read_b128 v[32:35], v3 offset:2048
  ds_read_b128 v[36:39], v3 offset:3072
  ds_read_b128 v[40:43], v3 offset:4096
  ds_read_b128 v[44:47], v3 offset:5120
  ds_read_b128 v[48:51], v3 offset:6144
  ds_read_b128 v[52:55], v3 offset:7168
  s_waitcnt lgkmcnt(0)
  v_mfma_f32_16x16x32_bf16 v[56:59], v[8:11], v[24:27], 0
  v_mfma_f32_16x16x32_bf16 v[56:59], v[8:11], v[28:31], v[56:59]
  v_mfma_f32_16x16x32_bf16 v[56:59], v[8:11], v[32:35], v[56:59]
  v_mfma_f32_16x16x32_bf16 v[56:59], v[8:11], v[36:39], v[56:59]
  v_mfma_f32_16x16x32_bf16 v[56:59], v[8:11], v[40:43], v[56:59]
  v_mfma_f32_16x16x32_bf16 v[56:59], v[8:11], v[44:47], v[56:59]
  v_mfma_f32_16x16x32_bf16 v[56:59], v[8:11], v[48:51], v[56:59]
  v_mfma_f32_16x16x32_bf16 v[56:59], v[8:11], v[52:55], v[56:59]
  s_lshl_b32 s61, s72, 16
  s_add_u32 s74, s74, 1
  s_cmp_ge_u32 s72, 44
  s_cselect_b32 s57, 4, 2
  s_add_u32 s72, s72, s57
  s_nop 2
  v_cvt_pk_bf16_f32 v56, v56, v57
  v_cvt_pk_bf16_f32 v57, v58, v59
  s_mov_b32 exec_hi, 0
  buffer_store_dwordx2 v[56:57], v18, s[44:47], s61 offen
  s_mov_b64 exec, -1
L_o_nored2:
  s_add_u32 s70, s70, 1
  s_cmp_ge_u32 s71, 44
  s_cselect_b32 s57, 4, 2
  s_add_u32 s71, s71, s57
  s_cmp_lt_u32 s71, 64
  s_cbranch_scc1 L_o_loop
  s_sub_u32 s76, s70, 1
L_o_rp_22:
  s_cmp_ge_u32 s74, s76
  s_cbranch_scc1 L_o_rp_23
L_o_fw_24:
  v_cmp_ge_u32 vcc, s74, v22
  s_cbranch_vccz L_o_fw_25
  s_sub_u32 s56, s56, 1
  s_cbranch_scc1 L_timeout
  buffer_load_dword v22, v20, s[52:55], 0 offen sc1
  s_waitcnt vmcnt(0)
  s_branch L_o_fw_24
L_o_fw_25:
  s_lshl_b32 s61, s72, 20
  s_add_u32 s61, s61, 67108864
  buffer_load_dwordx4 v[88:91], v17, s[52:55], s61 offen sc1
  s_add_u32 s61, s61, 4096
  buffer_load_dwordx4 v[92:95], v17, s[52:55], s61 offen sc1
  s_add_u32 s61, s61, 4096
  buffer_load_dwordx4 v[96:99], v17, s[52:55], s61 offen sc1
  s_add_u32 s61, s61, 4096
  buffer_load_dwordx4 v[100:103], v17, s[52:55], s61 offen sc1
  s_add_u32 s61, s61, 4096
  buffer_load_dwordx4 v[104:107], v17, s[52:55], s61 offen sc1
  s_add_u32 s61, s61, 4096
  buffer_load_dwordx4 v[108:111], v17, s[52:55], s61 offen sc1
  s_add_u32 s61, s61, 4096
  buffer_load_dwordx4 v[112:115], v17, s[52:55], s61 offen sc1
  s_add_u32 s61, s61, 4096
  buffer_load_dwordx4 v[116:119], v17, s[52:55], s61 offen sc1
  s_waitcnt vmcnt(0)
  v_mfma_f32_16x16x32_bf16 v[56:59], v[8:11], v[88:91], 0
  v_mfma_f32_16x16x32_bf16 v[56:59], v[8:11], v[92:95], v[56:59]
  v_mfma_f32_16x16x32_bf16 v[56:59], v[8:11], v[96:99], v[56:59]
  v_mfma_f32_16x16x32_bf16 v[56:59], v[8:11], v[100:103], v[56:59]
  v_mfma_f32_16x16x32_bf16 v[56:59], v[8:11], v[104:107], v[56:59]
  v_mfma_f32_16x16x32_bf16 v[56:59], v[8:11], v[108:111], v[56:59]
  v_mfma_f32_16x16x32_bf16 v[56:59], v[8:11], v[112:115], v[56:59]
  v_mfma_f32_16x16x32_bf16 v[56:59], v[8:11], v[116:119], v[56:59]
  s_lshl_b32 s61, s72, 16
  s_add_u32 s74, s74, 1
  s_cmp_ge_u32 s72, 44
  s_cselect_b32 s57, 4, 2
  s_add_u32 s72, s72, s57
  s_nop 2
  v_cvt_pk_bf16_f32 v56, v56, v57
  v_cvt_pk_bf16_f32 v57, v58, v59
  s_mov_b32 exec_hi, 0
  buffer_store_dwordx2 v[56:57], v18, s[44:47], s61 offen
  s_mov_b64 exec, -1
  s_branch L_o_rp_22
L_o_rp_23:
  s_waitcnt vmcnt(2)
L_o_last:
  s_sub_u32 s56, s56, 1
  s_cbranch_scc1 L_timeout
  s_lshl_b32 s61, s72, 20
  s_add_u32 s61, s61, 67108864
  buffer_load_dwordx4 v[88:91], v17, s[52:55], s61 offen sc1
  s_add_u32 s61, s61, 4096
  buffer_load_dwordx4 v[92:95], v17, s[52:55], s61 offen sc1
  s_add_u32 s61, s61, 4096
  buffer_load_dwordx4 v[96:99], v17, s[52:55], s61 offen sc1
  s_add_u32 s61, s61, 4096
  buffer_load_dwordx4 v[100:103], v17, s[52:55], s61 offen sc1
  s_add_u32 s61, s61, 4096
  buffer_load_dwordx4 v[104:107], v17, s[52:55], s61 offen sc1
  s_add_u32 s61, s61, 4096
  buffer_load_dwordx4 v[108:111], v17, s[52:55], s61 offen sc1
  s_add_u32 s61, s61, 4096
  buffer_load_dwordx4 v[112:115], v17, s[52:55], s61 offen sc1
  s_add_u32 s61, s61, 4096
  buffer_load_dwordx4 v[116:119], v17, s[52:55], s61 offen sc1
  s_waitcnt vmcnt(0)
  v_max_u32 v1, v88, v89
  v_max3_u32 v1, v1, v90, v91
  v_max3_u32 v1, v1, v92, v93
  v_max3_u32 v1, v1, v94, v95
  v_max3_u32 v1, v1, v96, v97
  v_max3_u32 v1, v1, v98, v99
  v_max3_u32 v1, v1, v100, v101
  v_max3_u32 v1, v1, v102, v103
  v_max3_u32 v1, v1, v104, v105
  v_max3_u32 v1, v1, v106, v107
  v_max3_u32 v1, v1, v108, v109
  v_max3_u32 v1, v1, v110, v111
  v_max3_u32 v1, v1, v112, v113
  v_max3_u32 v1, v1, v114, v115
  v_max3_u32 v1, v1, v116, v117
  v_max3_u32 v1, v1, v118, v119
  v_cmp_eq_u32 vcc, -1, v1
  s_cbranch_vccnz L_o_last
  v_mfma_f32_16x16x32_bf16 v[56:59], v[8:11], v[88:91], 0
  v_mfma_f32_16x16x32_bf16 v[56:59], v[8:11], v[92:95], v[56:59]
  v_mfma_f32_16x16x32_bf16 v[56:59], v[8:11], v[96:99], v[56:59]
  v_mfma_f32_16x16x32_bf16 v[56:59], v[8:11], v[100:103], v[56:59]
  v_mfma_f32_16x16x32_bf16 v[56:59], v[8:11], v[104:107], v[56:59]
  v_mfma_f32_16x16x32_bf16 v[56:59], v[8:11], v[108:111], v[56:59]
  v_mfma_f32_16x16x32_bf16 v[56:59], v[8:11], v[112:115], v[56:59]
  v_mfma_f32_16x16x32_bf16 v[56:59], v[8:11], v[116:119], v[56:59]
  s_lshl_b32 s61, s72, 16
  s_add_u32 s74, s74, 1
  s_cmp_ge_u32 s72, 44
  s_cselect_b32 s57, 4, 2
  s_add_u32 s72, s72, s57
  s_nop 2
  v_cvt_pk_bf16_f32 v56, v56, v57
  v_cvt_pk_bf16_f32 v57, v58, v59
  s_mov_b32 exec_hi, 0
  buffer_store_dwordx2 v[56:57], v18, s[44:47], s61 offen
  s_mov_b64 exec, -1
  s_endpgm
L_chain:
  s_setprio 3
  v_lshrrev_b32 v1, 4, v0
  v_and_b32 v2, 15, v0
  v_lshlrev_b32 v3, 1, v1
  v_xor_b32 v2, v2, v3
  v_lshlrev_b32 v2, 4, v2
  v_lshl_add_u32 v2, v1, 13, v2
  s_lshl_b32 s64, s6, 8
  s_lshl_b32 s65, s4, 17
  s_add_u32 s64, s64, s65
  v_add_u32 v100, s64, v2
  v_xor_b32 v101, 0x80, v100
  s_lshl_b32 s64, s4, 12
  s_add_u32 s64, s64, 32768
  s_add_u32 m0, s64, 0
  s_mov_b32 s65, 0
  buffer_load_dwordx4 v100, s[16:19], s65 offen lds
  s_add_u32 m0, s64, 1024
  s_mov_b32 s65, 32768
  buffer_load_dwordx4 v100, s[16:19], s65 offen lds
  s_add_u32 m0, s64, 2048
  s_mov_b32 s65, 65536
  buffer_load_dwordx4 v101, s[16:19], s65 offen lds
  s_add_u32 m0, s64, 3072
  s_mov_b32 s65, 98304
  buffer_load_dwordx4 v101, s[16:19], s65 offen lds
  s_add_u32 m0, s64, 16384
  s_mov_b32 s65, 524288
  buffer_load_dwordx4 v100, s[16:19], s65 offen lds
  s_add_u32 m0, s64, 17408
  s_mov_b32 s65, 557056
  buffer_load_dwordx4 v100, s[16:19], s65 offen lds
  s_add_u32 m0, s64, 18432
  s_mov_b32 s65, 589824
  buffer_load_dwordx4 v101, s[16:19], s65 offen lds
  s_add_u32 m0, s64, 19456
  s_mov_b32 s65, 622592
  buffer_load_dwordx4 v101, s[16:19], s65 offen lds
  s_add_u32 m0, s64, 32768
  s_mov_b32 s65, 1048576
  buffer_load_dwordx4 v100, s[16:19], s65 offen lds
  s_add_u32 m0, s64, 33792
  s_mov_b32 s65, 1081344
  buffer_load_dwordx4 v100, s[16:19], s65 offen lds
  s_add_u32 m0, s64, 34816
  s_mov_b32 s65, 1114112
  buffer_load_dwordx4 v101, s[16:19], s65 offen lds
  s_add_u32 m0, s64, 35840
  s_mov_b32 s65, 1146880
  buffer_load_dwordx4 v101, s[16:19], s65 offen lds
  s_add_u32 m0, s64, 49152
  s_mov_b32 s65, 1572864
  buffer_load_dwordx4 v100, s[16:19], s65 offen lds
  s_add_u32 m0, s64, 50176
  s_mov_b32 s65, 1605632
  buffer_load_dwordx4 v100, s[16:19], s65 offen lds
  s_add_u32 m0, s64, 51200
  s_mov_b32 s65, 1638400
  buffer_load_dwordx4 v101, s[16:19], s65 offen lds
  s_add_u32 m0, s64, 52224
  s_mov_b32 s65, 1671168
  buffer_load_dwordx4 v101, s[16:19], s65 offen lds
  s_add_u32 m0, s64, 65536
  s_mov_b32 s65, 2097152
  buffer_load_dwordx4 v100, s[16:19], s65 offen lds
  s_add_u32 m0, s64, 66560
  s_mov_b32 s65, 2129920
  buffer_load_dwordx4 v100, s[16:19], s65 offen lds
  s_add_u32 m0, s64, 67584
  s_mov_b32 s65, 2162688
  buffer_load_dwordx4 v101, s[16:19], s65 offen lds
  s_add_u32 m0, s64, 68608
  s_mov_b32 s65, 2195456
  buffer_load_dwordx4 v101, s[16:19], s65 offen lds
  s_add_u32 m0, s64, 81920
  s_mov_b32 s65, 2621440
  buffer_load_dwordx4 v100, s[16:19], s65 offen lds
  s_add_u32 m0, s64, 82944
  s_mov_b32 s65, 2654208
  buffer_load_dwordx4 v100, s[16:19], s65 offen lds
  s_add_u32 m0, s64, 83968
  s_mov_b32 s65, 2686976
  buffer_load_dwordx4 v101, s[16:19], s65 offen lds
  s_add_u32 m0, s64, 84992
  s_mov_b32 s65, 2719744
  buffer_load_dwordx4 v101, s[16:19], s65 offen lds
  s_add_u32 m0, s64, 98304
  s_mov_b32 s65, 3145728
  buffer_load_dwordx4 v100, s[16:19], s65 offen lds
  s_add_u32 m0, s64, 99328
  s_mov_b32 s65, 3178496
  buffer_load_dwordx4 v100, s[16:19], s65 offen lds
  s_add_u32 m0, s64, 100352
  s_mov_b32 s65, 3211264
  buffer_load_dwordx4 v101, s[16:19], s65 offen lds
  s_add_u32 m0, s64, 101376
  s_mov_b32 s65, 3244032
  buffer_load_dwordx4 v101, s[16:19], s65 offen lds
  s_add_u32 m0, s64, 114688
  s_mov_b32 s65, 3670016
  buffer_load_dwordx4 v100, s[16:19], s65 offen lds
  s_add_u32 m0, s64, 115712
  s_mov_b32 s65, 3702784
  buffer_load_dwordx4 v100, s[16:19], s65 offen lds
  s_add_u32 m0, s64, 116736
  s_mov_b32 s65, 3735552
  buffer_load_dwordx4 v101, s[16:19], s65 offen lds
  s_add_u32 m0, s64, 117760
  s_mov_b32 s65, 3768320
  buffer_load_dwordx4 v101, s[16:19], s65 offen lds
  v_lshrrev_b32 v1, 4, v0
  v_bfe_u32 v2, v0, 2, 2
  v_lshl_add_u32 v3, v1, 3, v2
  v_lshlrev_b32 v102, 8, v3
  v_and_b32 v1, 1, v1
  v_lshlrev_b32 v1, 3, v1
  v_lshl_add_u32 v1, v2, 1, v1
  v_bfe_u32 v2, v0, 1, 1
  s_lshl_b32 s65, s4, 2
  v_add_u32 v2, s65, v2
  v_xor_b32 v1, v1, v2
  v_lshl_add_u32 v102, v1, 4, v102
  v_and_b32 v1, 1, v0
  v_lshl_add_u32 v102, v1, 3, v102
  v_add_u32 v102, 32768, v102
  v_xor_b32 v103, 32, v102
  v_add_u32 v104, 0x10000, v102
  v_add_u32 v105, 0x10000, v103
  v_and_b32 v1, 15, v0
  v_lshrrev_b32 v2, 4, v0
  v_bfe_u32 v3, v0, 1, 1
  v_and_b32 v28, 3, v0
  v_and_b32 v29, 1, v0
  v_and_b32 v30, 1, v2
  v_lshrrev_b32 v31, 1, v2
  v_lshrrev_b32 v26, 2, v1
  v_lshlrev_b32 v8, 4, v0
  s_lshl_b32 s60, s4, 11
  v_add_u32 v7, s60, v8
  s_lshl_b32 s69, s60, 1
  s_add_u32 s69, s69, 16384
  v_add_u32 v9, s64, v8
  v_mov_b32 v4, 0x4444
  v_mov_b32 v27, 0xeeee
  v_cmp_eq_u32 vcc, 1, v3
  s_nop 1
  v_cndmask_b32 v4, v4, v27, vcc
  v_mov_b32 v27, 0
  v_mov_b32 v32, 0x3f80
  v_cmp_eq_u32 vcc, 0, v28
  s_nop 1
  v_cndmask_b32 v27, v27, v32, vcc
  v_mov_b32 v32, 0x3f800000
  v_cmp_eq_u32 vcc, 1, v28
  s_nop 1
  v_cndmask_b32 v27, v27, v32, vcc
  v_cmp_eq_u32 vcc, 0, v26
  s_nop 1
  v_cndmask_b32 v124, 0, v27, vcc
  v_cmp_eq_u32 vcc, 1, v26
  s_nop 1
  v_cndmask_b32 v125, 0, v27, vcc
  v_cmp_eq_u32 vcc, 2, v26
  s_nop 1
  v_cndmask_b32 v126, 0, v27, vcc
  v_cmp_eq_u32 vcc, 3, v26
  s_nop 1
  v_cndmask_b32 v127, 0, v27, vcc
  v_mov_b32 v32, 0x3f803f80
  v_cmp_eq_u32 vcc, 2, v28
  s_nop 1
  v_cndmask_b32 v124, v124, v32, vcc
  v_cndmask_b32 v125, v125, v32, vcc
  v_cndmask_b32 v126, v126, v32, vcc
  v_cndmask_b32 v127, v127, v32, vcc
  v_lshl_add_u32 v27, v26, 2, v2
  v_lshlrev_b32 v27, 11, v27
  v_lshl_add_u32 v27, v28, 4, v27
  s_lshl_b32 s61, s4, 16
  s_lshl_b32 s62, s6, 6
  s_add_u32 s61, s61, s62
  s_add_u32 s61, s61, 1048576
  v_add_u32 v5, s61, v27
  s_and_b32 s61, s4, 1
  s_lshl_b32 s61, s61, 5
  s_add_u32 s61, s61, s6
  s_lshr_b32 s62, s61, 4
  s_lshl_b32 s62, s62, 5
  s_and_b32 s61, s61, 15
  s_add_u32 s61, s61, s62
  s_lshr_b32 s62, s4, 1
  s_lshl_b32 s62, s62, 4
  s_add_u32 s77, s61, s62
  s_lshl_b32 s61, s77, 11
  s_add_u32 s76, s61, 1048576
  v_lshlrev_b32 v27, 4, v2
  v_lshl_add_u32 v27, v28, 2, v27
  s_lshl_b32 s61, s77, 6
  v_add_u32 v6, s61, v27
  v_mov_b32 v33, 0x80000000
  v_cmp_lt_u32 vcc, 3, v1
  s_nop 1
  v_cndmask_b32 v6, v6, v33, vcc
  v_lshlrev_b32 v27, 4, v1
  v_lshl_add_u32 v27, v2, 2, v27
  s_mul_i32 s61, s4, 576
  s_add_u32 s62, s61, 8192
  v_add_u32 v10, s62, v27
  v_lshrrev_b32 v27, 1, v26
  v_mul_u32_u24 v27, 288, v27
  v_lshl_add_u32 v27, v2, 6, v27
  v_and_b32 v32, 1, v26
  v_lshl_add_u32 v27, v32, 4, v27
  v_lshl_add_u32 v11, v3, 3, v27
  v_mul_u32_u24 v27, 288, v30
  v_lshl_add_u32 v27, v31, 7, v27
  v_lshl_add_u32 v27, v1, 3, v27
  s_add_u32 s62, s61, 10496
  v_add_u32 v12, s62, v27
  v_mul_u32_u24 v27, 576, v31
  v_mul_u32_u24 v32, 288, v29
  v_add_u32 v27, v27, v32
  v_lshl_add_u32 v27, v3, 7, v27
  v_lshl_add_u32 v27, v30, 6, v27
  v_lshl_add_u32 v13, v26, 3, v27
  v_lshrrev_b32 v27, 3, v1
  v_lshl_add_u32 v27, v27, 2, v28
  v_lshlrev_b32 v27, 4, v27
  v_lshl_add_u32 v27, v2, 7, v27
  s_lshl_b32 s61, s4, 9
  v_add_u32 v14, s61, v27
  v_lshl_add_u32 v27, v26, 1, v29
  v_lshlrev_b32 v27, 4, v27
  v_lshl_add_u32 v27, v2, 7, v27
  v_lshl_add_u32 v15, v3, 9, v27
  v_and_b32 v27, 31, v0
  v_lshlrev_b32 v27, 6, v27
  v_add_u32 v27, s60, v27
  v_add_u32 v18, 262144, v27
  v_add_u32 v27, 17039360, v27
  v_cmp_lt_u32 vcc, 31, v0
  s_nop 1
  v_cndmask_b32 v18, v18, v27, vcc
  s_mov_b32 s100, 0x0f0f0f0f
  s_mov_b32 s101, 0x0f0f0f0f
  s_and_b32 s61, s77, 3
  s_lshl_b32 s61, s61, 11
  s_lshr_b32 s62, s77, 2
  s_lshl_b32 s62, s62, 5
  s_add_u32 s61, s61, s62
  v_lshlrev_b32 v27, 10, v30
  v_lshl_add_u32 v27, v28, 3, v27
  v_lshl_add_u32 v27, v31, 2, v27
  v_add_u32 v27, s61, v27
  buffer_load_dword v16, v27, s[12:15], 0 offen
  v_lshlrev_b32 v27, 14, v30
  v_lshl_add_u32 v27, v31, 12, v27
  v_lshl_add_u32 v27, v1, 3, v27
  s_lshl_b32 s61, s6, 17
  s_lshl_b32 s62, s4, 8
  s_add_u32 s61, s61, s62
  v_add_u32 v107, s61, v27
  v_lshrrev_b32 v27, 2, v0
  v_lshlrev_b32 v27, 13, v27
  v_lshl_add_u32 v27, v28, 4, v27
  s_lshl_b32 s61, s77, 6
  v_add_u32 v106, s61, v27
  v_add_u32 v0, 0x10000, v9
  v_mov_b32 v108, 0
  v_mov_b32 v112, -1
  v_mov_b32 v109, 0
  v_mov_b32 v113, -1
  v_mov_b32 v110, 0
  v_mov_b32 v114, -1
  v_mov_b32 v111, 0
  v_mov_b32 v115, -1
  buffer_store_dwordx4 v[108:111], v5, s[52:55], 0 offen sc1
  s_mov_b32 s61, 32768
  buffer_store_dwordx4 v[108:111], v5, s[52:55], s61 offen sc1
  s_mov_b32 s61, 2097152
  buffer_store_dwordx4 v[112:115], v106, s[52:55], s61 offen sc1
  s_mov_b32 s61, 2228224
  buffer_store_dwordx4 v[112:115], v106, s[52:55], s61 offen sc1
  s_mov_b32 s61, 2359296
  buffer_store_dwordx4 v[112:115], v106, s[52:55], s61 offen sc1
  s_mov_b32 s61, 2490368
  buffer_store_dwordx4 v[112:115], v106, s[52:55], s61 offen sc1
  s_mov_b64 exec, 0xfff
  s_mov_b32 s61, 1572864
  buffer_store_dwordx4 v[112:115], v106, s[52:55], s61 offen sc1
  s_mov_b64 exec, -1
  s_waitcnt vmcnt(36) lgkmcnt(0)
  s_barrier
  s_cmp_lg_u32 s4, 0
  s_cbranch_scc1 L_c_tr_27
  ds_read_b64_tr_b16 v[128:129], v102 offset:0
  ds_read_b64_tr_b16 v[130:131], v102 offset:1024
  ds_read_b64_tr_b16 v[132:133], v102 offset:8192
  ds_read_b64_tr_b16 v[134:135], v102 offset:9216
  ds_read_b64_tr_b16 v[52:53], v103 offset:0
  ds_read_b64_tr_b16 v[54:55], v103 offset:1024
  ds_read_b64_tr_b16 v[56:57], v103 offset:8192
  ds_read_b64_tr_b16 v[58:59], v103 offset:9216
  s_branch L_c_tr_26
L_c_tr_27:
  s_cmp_lg_u32 s4, 1
  s_cbranch_scc1 L_c_tr_28
  ds_read_b64_tr_b16 v[144:145], v102 offset:0
  ds_read_b64_tr_b16 v[146:147], v102 offset:1024
  ds_read_b64_tr_b16 v[148:149], v102 offset:8192
  ds_read_b64_tr_b16 v[150:151], v102 offset:9216
  ds_read_b64_tr_b16 v[68:69], v103 offset:0
  ds_read_b64_tr_b16 v[70:71], v103 offset:1024
  ds_read_b64_tr_b16 v[72:73], v103 offset:8192
  ds_read_b64_tr_b16 v[74:75], v103 offset:9216
  s_branch L_c_tr_26
L_c_tr_28:
  s_cmp_lg_u32 s4, 2
  s_cbranch_scc1 L_c_tr_29
  ds_read_b64_tr_b16 v[160:161], v102 offset:0
  ds_read_b64_tr_b16 v[162:163], v102 offset:1024
  ds_read_b64_tr_b16 v[164:165], v102 offset:8192
  ds_read_b64_tr_b16 v[166:167], v102 offset:9216
  ds_read_b64_tr_b16 v[84:85], v103 offset:0
  ds_read_b64_tr_b16 v[86:87], v103 offset:1024
  ds_read_b64_tr_b16 v[88:89], v103 offset:8192
  ds_read_b64_tr_b16 v[90:91], v103 offset:9216
  s_branch L_c_tr_26
L_c_tr_29:
  ds_read_b64_tr_b16 v[176:177], v102 offset:0
  ds_read_b64_tr_b16 v[178:179], v102 offset:1024
  ds_read_b64_tr_b16 v[180:181], v102 offset:8192
  ds_read_b64_tr_b16 v[182:183], v102 offset:9216
  ds_read_b64_tr_b16 v[192:193], v103 offset:0
  ds_read_b64_tr_b16 v[194:195], v103 offset:1024
  ds_read_b64_tr_b16 v[196:197], v103 offset:8192
  ds_read_b64_tr_b16 v[198:199], v103 offset:9216
L_c_tr_26:
  s_waitcnt vmcnt(32) lgkmcnt(0)
  s_barrier
  s_add_u32 m0, s64, 0
  s_mov_b32 s65, 0
  buffer_load_dwordx4 v100, s[20:23], s65 offen lds
  s_add_u32 m0, s64, 1024
  s_mov_b32 s65, 32768
  buffer_load_dwordx4 v100, s[20:23], s65 offen lds
  s_add_u32 m0, s64, 2048
  s_mov_b32 s65, 65536
  buffer_load_dwordx4 v101, s[20:23], s65 offen lds
  s_add_u32 m0, s64, 3072
  s_mov_b32 s65, 98304
  buffer_load_dwordx4 v101, s[20:23], s65 offen lds
  s_cmp_lg_u32 s4, 0
  s_cbranch_scc1 L_c_tr_32
  ds_read_b64_tr_b16 v[136:137], v102 offset:16384
  ds_read_b64_tr_b16 v[138:139], v102 offset:17408
  ds_read_b64_tr_b16 v[140:141], v102 offset:24576
  ds_read_b64_tr_b16 v[142:143], v102 offset:25600
  ds_read_b64_tr_b16 v[60:61], v103 offset:16384
  ds_read_b64_tr_b16 v[62:63], v103 offset:17408
  ds_read_b64_tr_b16 v[64:65], v103 offset:24576
  ds_read_b64_tr_b16 v[66:67], v103 offset:25600
  s_branch L_c_tr_31
L_c_tr_32:
  s_cmp_lg_u32 s4, 1
  s_cbranch_scc1 L_c_tr_33
  ds_read_b64_tr_b16 v[152:153], v102 offset:16384
  ds_read_b64_tr_b16 v[154:155], v102 offset:17408
  ds_read_b64_tr_b16 v[156:157], v102 offset:24576
  ds_read_b64_tr_b16 v[158:159], v102 offset:25600
  ds_read_b64_tr_b16 v[76:77], v103 offset:16384
  ds_read_b64_tr_b16 v[78:79], v103 offset:17408
  ds_read_b64_tr_b16 v[80:81], v103 offset:24576
  ds_read_b64_tr_b16 v[82:83], v103 offset:25600
  s_branch L_c_tr_31
L_c_tr_33:
  s_cmp_lg_u32 s4, 2
  s_cbranch_scc1 L_c_tr_34
  ds_read_b64_tr_b16 v[168:169], v102 offset:16384
  ds_read_b64_tr_b16 v[170:171], v102 offset:17408
  ds_read_b64_tr_b16 v[172:173], v102 offset:24576
  ds_read_b64_tr_b16 v[174:175], v102 offset:25600
  ds_read_b64_tr_b16 v[92:93], v103 offset:16384
  ds_read_b64_tr_b16 v[94:95], v103 offset:17408
  ds_read_b64_tr_b16 v[96:97], v103 offset:24576
  ds_read_b64_tr_b16 v[98:99], v103 offset:25600
  s_branch L_c_tr_31
L_c_tr_34:
  ds_read_b64_tr_b16 v[184:185], v102 offset:16384
  ds_read_b64_tr_b16 v[186:187], v102 offset:17408
  ds_read_b64_tr_b16 v[188:189], v102 offset:24576
  ds_read_b64_tr_b16 v[190:191], v102 offset:25600
  ds_read_b64_tr_b16 v[200:201], v103 offset:16384
  ds_read_b64_tr_b16 v[202:203], v103 offset:17408
  ds_read_b64_tr_b16 v[204:205], v103 offset:24576
  ds_read_b64_tr_b16 v[206:207], v103 offset:25600
L_c_tr_31:
  s_waitcnt vmcnt(32) lgkmcnt(0)
  s_barrier
  s_add_u32 m0, s64, 16384
  s_mov_b32 s65, 524288
  buffer_load_dwordx4 v100, s[20:23], s65 offen lds
  s_add_u32 m0, s64, 17408
  s_mov_b32 s65, 557056
  buffer_load_dwordx4 v100, s[20:23], s65 offen lds
  s_add_u32 m0, s64, 18432
  s_mov_b32 s65, 589824
  buffer_load_dwordx4 v101, s[20:23], s65 offen lds
  s_add_u32 m0, s64, 19456
  s_mov_b32 s65, 622592
  buffer_load_dwordx4 v101, s[20:23], s65 offen lds
  s_cmp_lg_u32 s4, 0
  s_cbranch_scc1 L_c_tr_37
  ds_read_b64_tr_b16 v[144:145], v102 offset:32768
  ds_read_b64_tr_b16 v[146:147], v102 offset:33792
  ds_read_b64_tr_b16 v[148:149], v102 offset:40960
  ds_read_b64_tr_b16 v[150:151], v102 offset:41984
  ds_read_b64_tr_b16 v[68:69], v103 offset:32768
  ds_read_b64_tr_b16 v[70:71], v103 offset:33792
  ds_read_b64_tr_b16 v[72:73], v103 offset:40960
  ds_read_b64_tr_b16 v[74:75], v103 offset:41984
  s_branch L_c_tr_36
L_c_tr_37:
  s_cmp_lg_u32 s4, 1
  s_cbranch_scc1 L_c_tr_38
  ds_read_b64_tr_b16 v[128:129], v102 offset:32768
  ds_read_b64_tr_b16 v[130:131], v102 offset:33792
  ds_read_b64_tr_b16 v[132:133], v102 offset:40960
  ds_read_b64_tr_b16 v[134:135], v102 offset:41984
  ds_read_b64_tr_b16 v[52:53], v103 offset:32768
  ds_read_b64_tr_b16 v[54:55], v103 offset:33792
  ds_read_b64_tr_b16 v[56:57], v103 offset:40960
  ds_read_b64_tr_b16 v[58:59], v103 offset:41984
  s_branch L_c_tr_36
L_c_tr_38:
  s_cmp_lg_u32 s4, 2
  s_cbranch_scc1 L_c_tr_39
  ds_read_b64_tr_b16 v[176:177], v102 offset:32768
  ds_read_b64_tr_b16 v[178:179], v102 offset:33792
  ds_read_b64_tr_b16 v[180:181], v102 offset:40960
  ds_read_b64_tr_b16 v[182:183], v102 offset:41984
  ds_read_b64_tr_b16 v[192:193], v103 offset:32768
  ds_read_b64_tr_b16 v[194:195], v103 offset:33792
  ds_read_b64_tr_b16 v[196:197], v103 offset:40960
  ds_read_b64_tr_b16 v[198:199], v103 offset:41984
  s_branch L_c_tr_36
L_c_tr_39:
  ds_read_b64_tr_b16 v[160:161], v102 offset:32768
  ds_read_b64_tr_b16 v[162:163], v102 offset:33792
  ds_read_b64_tr_b16 v[164:165], v102 offset:40960
  ds_read_b64_tr_b16 v[166:167], v102 offset:41984
  ds_read_b64_tr_b16 v[84:85], v103 offset:32768
  ds_read_b64_tr_b16 v[86:87], v103 offset:33792
  ds_read_b64_tr_b16 v[88:89], v103 offset:40960
  ds_read_b64_tr_b16 v[90:91], v103 offset:41984
L_c_tr_36:
  s_waitcnt vmcnt(32) lgkmcnt(0)
  s_barrier
  s_add_u32 m0, s64, 32768
  s_mov_b32 s65, 1048576
  buffer_load_dwordx4 v100, s[20:23], s65 offen lds
  s_add_u32 m0, s64, 33792
  s_mov_b32 s65, 1081344
  buffer_load_dwordx4 v100, s[20:23], s65 offen lds
  s_add_u32 m0, s64, 34816
  s_mov_b32 s65, 1114112
  buffer_load_dwordx4 v101, s[20:23], s65 offen lds
  s_add_u32 m0, s64, 35840
  s_mov_b32 s65, 1146880
  buffer_load_dwordx4 v101, s[20:23], s65 offen lds
  s_cmp_lg_u32 s4, 0
  s_cbranch_scc1 L_c_tr_42
  ds_read_b64_tr_b16 v[152:153], v102 offset:49152
  ds_read_b64_tr_b16 v[154:155], v102 offset:50176
  ds_read_b64_tr_b16 v[156:157], v102 offset:57344
  ds_read_b64_tr_b16 v[158:159], v102 offset:58368
  ds_read_b64_tr_b16 v[76:77], v103 offset:49152
  ds_read_b64_tr_b16 v[78:79], v103 offset:50176
  ds_read_b64_tr_b16 v[80:81], v103 offset:57344
  ds_read_b64_tr_b16 v[82:83], v103 offset:58368
  s_branch L_c_tr_41
L_c_tr_42:
  s_cmp_lg_u32 s4, 1
  s_cbranch_scc1 L_c_tr_43
  ds_read_b64_tr_b16 v[136:137], v102 offset:49152
  ds_read_b64_tr_b16 v[138:139], v102 offset:50176
  ds_read_b64_tr_b16 v[140:141], v102 offset:57344
  ds_read_b64_tr_b16 v[142:143], v102 offset:58368
  ds_read_b64_tr_b16 v[60:61], v103 offset:49152
  ds_read_b64_tr_b16 v[62:63], v103 offset:50176
  ds_read_b64_tr_b16 v[64:65], v103 offset:57344
  ds_read_b64_tr_b16 v[66:67], v103 offset:58368
  s_branch L_c_tr_41
L_c_tr_43:
  s_cmp_lg_u32 s4, 2
  s_cbranch_scc1 L_c_tr_44
  ds_read_b64_tr_b16 v[184:185], v102 offset:49152
  ds_read_b64_tr_b16 v[186:187], v102 offset:50176
  ds_read_b64_tr_b16 v[188:189], v102 offset:57344
  ds_read_b64_tr_b16 v[190:191], v102 offset:58368
  ds_read_b64_tr_b16 v[200:201], v103 offset:49152
  ds_read_b64_tr_b16 v[202:203], v103 offset:50176
  ds_read_b64_tr_b16 v[204:205], v103 offset:57344
  ds_read_b64_tr_b16 v[206:207], v103 offset:58368
  s_branch L_c_tr_41
L_c_tr_44:
  ds_read_b64_tr_b16 v[168:169], v102 offset:49152
  ds_read_b64_tr_b16 v[170:171], v102 offset:50176
  ds_read_b64_tr_b16 v[172:173], v102 offset:57344
  ds_read_b64_tr_b16 v[174:175], v102 offset:58368
  ds_read_b64_tr_b16 v[92:93], v103 offset:49152
  ds_read_b64_tr_b16 v[94:95], v103 offset:50176
  ds_read_b64_tr_b16 v[96:97], v103 offset:57344
  ds_read_b64_tr_b16 v[98:99], v103 offset:58368
L_c_tr_41:
  s_waitcnt vmcnt(32) lgkmcnt(0)
  s_barrier
  s_add_u32 m0, s64, 49152
  s_mov_b32 s65, 1572864
  buffer_load_dwordx4 v100, s[20:23], s65 offen lds
  s_add_u32 m0, s64, 50176
  s_mov_b32 s65, 1605632
  buffer_load_dwordx4 v100, s[20:23], s65 offen lds
  s_add_u32 m0, s64, 51200
  s_mov_b32 s65, 1638400
  buffer_load_dwordx4 v101, s[20:23], s65 offen lds
  s_add_u32 m0, s64, 52224
  s_mov_b32 s65, 1671168
  buffer_load_dwordx4 v101, s[20:23], s65 offen lds
  s_cmp_lg_u32 s4, 0
  s_cbranch_scc1 L_c_tr_47
  ds_read_b64_tr_b16 v[160:161], v104 offset:0
  ds_read_b64_tr_b16 v[162:163], v104 offset:1024
  ds_read_b64_tr_b16 v[164:165], v104 offset:8192
  ds_read_b64_tr_b16 v[166:167], v104 offset:9216
  ds_read_b64_tr_b16 v[84:85], v105 offset:0
  ds_read_b64_tr_b16 v[86:87], v105 offset:1024
  ds_read_b64_tr_b16 v[88:89], v105 offset:8192
  ds_read_b64_tr_b16 v[90:91], v105 offset:9216
  s_branch L_c_tr_46
L_c_tr_47:
  s_cmp_lg_u32 s4, 1
  s_cbranch_scc1 L_c_tr_48
  ds_read_b64_tr_b16 v[176:177], v104 offset:0
  ds_read_b64_tr_b16 v[178:179], v104 offset:1024
  ds_read_b64_tr_b16 v[180:181], v104 offset:8192
  ds_read_b64_tr_b16 v[182:183], v104 offset:9216
  ds_read_b64_tr_b16 v[192:193], v105 offset:0
  ds_read_b64_tr_b16 v[194:195], v105 offset:1024
  ds_read_b64_tr_b16 v[196:197], v105 offset:8192
  ds_read_b64_tr_b16 v[198:199], v105 offset:9216
  s_branch L_c_tr_46
L_c_tr_48:
  s_cmp_lg_u32 s4, 2
  s_cbranch_scc1 L_c_tr_49
  ds_read_b64_tr_b16 v[128:129], v104 offset:0
  ds_read_b64_tr_b16 v[130:131], v104 offset:1024
  ds_read_b64_tr_b16 v[132:133], v104 offset:8192
  ds_read_b64_tr_b16 v[134:135], v104 offset:9216
  ds_read_b64_tr_b16 v[52:53], v105 offset:0
  ds_read_b64_tr_b16 v[54:55], v105 offset:1024
  ds_read_b64_tr_b16 v[56:57], v105 offset:8192
  ds_read_b64_tr_b16 v[58:59], v105 offset:9216
  s_branch L_c_tr_46
L_c_tr_49:
  ds_read_b64_tr_b16 v[144:145], v104 offset:0
  ds_read_b64_tr_b16 v[146:147], v104 offset:1024
  ds_read_b64_tr_b16 v[148:149], v104 offset:8192
  ds_read_b64_tr_b16 v[150:151], v104 offset:9216
  ds_read_b64_tr_b16 v[68:69], v105 offset:0
  ds_read_b64_tr_b16 v[70:71], v105 offset:1024
  ds_read_b64_tr_b16 v[72:73], v105 offset:8192
  ds_read_b64_tr_b16 v[74:75], v105 offset:9216
L_c_tr_46:
  s_waitcnt vmcnt(32) lgkmcnt(0)
  s_barrier
  s_add_u32 m0, s64, 65536
  s_mov_b32 s65, 2097152
  buffer_load_dwordx4 v100, s[20:23], s65 offen lds
  s_add_u32 m0, s64, 66560
  s_mov_b32 s65, 2129920
  buffer_load_dwordx4 v100, s[20:23], s65 offen lds
  s_add_u32 m0, s64, 67584
  s_mov_b32 s65, 2162688
  buffer_load_dwordx4 v101, s[20:23], s65 offen lds
  s_add_u32 m0, s64, 68608
  s_mov_b32 s65, 2195456
  buffer_load_dwordx4 v101, s[20:23], s65 offen lds
  s_cmp_lg_u32 s4, 0
  s_cbranch_scc1 L_c_tr_52
  ds_read_b64_tr_b16 v[168:169], v104 offset:16384
  ds_read_b64_tr_b16 v[170:171], v104 offset:17408
  ds_read_b64_tr_b16 v[172:173], v104 offset:24576
  ds_read_b64_tr_b16 v[174:175], v104 offset:25600
  ds_read_b64_tr_b16 v[92:93], v105 offset:16384
  ds_read_b64_tr_b16 v[94:95], v105 offset:17408
  ds_read_b64_tr_b16 v[96:97], v105 offset:24576
  ds_read_b64_tr_b16 v[98:99], v105 offset:25600
  s_branch L_c_tr_51
L_c_tr_52:
  s_cmp_lg_u32 s4, 1
  s_cbranch_scc1 L_c_tr_53
  ds_read_b64_tr_b16 v[184:185], v104 offset:16384
  ds_read_b64_tr_b16 v[186:187], v104 offset:17408
  ds_read_b64_tr_b16 v[188:189], v104 offset:24576
  ds_read_b64_tr_b16 v[190:191], v104 offset:25600
  ds_read_b64_tr_b16 v[200:201], v105 offset:16384
  ds_read_b64_tr_b16 v[202:203], v105 offset:17408
  ds_read_b64_tr_b16 v[204:205], v105 offset:24576
  ds_read_b64_tr_b16 v[206:207], v105 offset:25600
  s_branch L_c_tr_51
L_c_tr_53:
  s_cmp_lg_u32 s4, 2
  s_cbranch_scc1 L_c_tr_54
  ds_read_b64_tr_b16 v[136:137], v104 offset:16384
  ds_read_b64_tr_b16 v[138:139], v104 offset:17408
  ds_read_b64_tr_b16 v[140:141], v104 offset:24576
  ds_read_b64_tr_b16 v[142:143], v104 offset:25600
  ds_read_b64_tr_b16 v[60:61], v105 offset:16384
  ds_read_b64_tr_b16 v[62:63], v105 offset:17408
  ds_read_b64_tr_b16 v[64:65], v105 offset:24576
  ds_read_b64_tr_b16 v[66:67], v105 offset:25600
  s_branch L_c_tr_51
L_c_tr_54:
  ds_read_b64_tr_b16 v[152:153], v104 offset:16384
  ds_read_b64_tr_b16 v[154:155], v104 offset:17408
  ds_read_b64_tr_b16 v[156:157], v104 offset:24576
  ds_read_b64_tr_b16 v[158:159], v104 offset:25600
  ds_read_b64_tr_b16 v[76:77], v105 offset:16384
  ds_read_b64_tr_b16 v[78:79], v105 offset:17408
  ds_read_b64_tr_b16 v[80:81], v105 offset:24576
  ds_read_b64_tr_b16 v[82:83], v105 offset:25600
L_c_tr_51:
  s_waitcnt vmcnt(32) lgkmcnt(0)
  s_barrier
  s_add_u32 m0, s64, 81920
  s_mov_b32 s65, 2621440
  buffer_load_dwordx4 v100, s[20:23], s65 offen lds
  s_add_u32 m0, s64, 82944
  s_mov_b32 s65, 2654208
  buffer_load_dwordx4 v100, s[20:23], s65 offen lds
  s_add_u32 m0, s64, 83968
  s_mov_b32 s65, 2686976
  buffer_load_dwordx4 v101, s[20:23], s65 offen lds
  s_add_u32 m0, s64, 84992
  s_mov_b32 s65, 2719744
  buffer_load_dwordx4 v101, s[20:23], s65 offen lds
  s_cmp_lg_u32 s4, 0
  s_cbranch_scc1 L_c_tr_57
  ds_read_b64_tr_b16 v[176:177], v104 offset:32768
  ds_read_b64_tr_b16 v[178:179], v104 offset:33792
  ds_read_b64_tr_b16 v[180:181], v104 offset:40960
  ds_read_b64_tr_b16 v[182:183], v104 offset:41984
  ds_read_b64_tr_b16 v[192:193], v105 offset:32768
  ds_read_b64_tr_b16 v[194:195], v105 offset:33792
  ds_read_b64_tr_b16 v[196:197], v105 offset:40960
  ds_read_b64_tr_b16 v[198:199], v105 offset:41984
  s_branch L_c_tr_56
L_c_tr_57:
  s_cmp_lg_u32 s4, 1
  s_cbranch_scc1 L_c_tr_58
  ds_read_b64_tr_b16 v[160:161], v104 offset:32768
  ds_read_b64_tr_b16 v[162:163], v104 offset:33792
  ds_read_b64_tr_b16 v[164:165], v104 offset:40960
  ds_read_b64_tr_b16 v[166:167], v104 offset:41984
  ds_read_b64_tr_b16 v[84:85], v105 offset:32768
  ds_read_b64_tr_b16 v[86:87], v105 offset:33792
  ds_read_b64_tr_b16 v[88:89], v105 offset:40960
  ds_read_b64_tr_b16 v[90:91], v105 offset:41984
  s_branch L_c_tr_56
L_c_tr_58:
  s_cmp_lg_u32 s4, 2
  s_cbranch_scc1 L_c_tr_59
  ds_read_b64_tr_b16 v[144:145], v104 offset:32768
  ds_read_b64_tr_b16 v[146:147], v104 offset:33792
  ds_read_b64_tr_b16 v[148:149], v104 offset:40960
  ds_read_b64_tr_b16 v[150:151], v104 offset:41984
  ds_read_b64_tr_b16 v[68:69], v105 offset:32768
  ds_read_b64_tr_b16 v[70:71], v105 offset:33792
  ds_read_b64_tr_b16 v[72:73], v105 offset:40960
  ds_read_b64_tr_b16 v[74:75], v105 offset:41984
  s_branch L_c_tr_56
L_c_tr_59:
  ds_read_b64_tr_b16 v[128:129], v104 offset:32768
  ds_read_b64_tr_b16 v[130:131], v104 offset:33792
  ds_read_b64_tr_b16 v[132:133], v104 offset:40960
  ds_read_b64_tr_b16 v[134:135], v104 offset:41984
  ds_read_b64_tr_b16 v[52:53], v105 offset:32768
  ds_read_b64_tr_b16 v[54:55], v105 offset:33792
  ds_read_b64_tr_b16 v[56:57], v105 offset:40960
  ds_read_b64_tr_b16 v[58:59], v105 offset:41984
L_c_tr_56:
  s_waitcnt vmcnt(32) lgkmcnt(0)
  s_barrier
  s_add_u32 m0, s64, 98304
  s_mov_b32 s65, 3145728
  buffer_load_dwordx4 v100, s[20:23], s65 offen lds
  s_add_u32 m0, s64, 99328
  s_mov_b32 s65, 3178496
  buffer_load_dwordx4 v100, s[20:23], s65 offen lds
  s_add_u32 m0, s64, 100352
  s_mov_b32 s65, 3211264
  buffer_load_dwordx4 v101, s[20:23], s65 offen lds
  s_add_u32 m0, s64, 101376
  s_mov_b32 s65, 3244032
  buffer_load_dwordx4 v101, s[20:23], s65 offen lds
  s_cmp_lg_u32 s4, 0
  s_cbranch_scc1 L_c_tr_62
  ds_read_b64_tr_b16 v[184:185], v104 offset:49152
  ds_read_b64_tr_b16 v[186:187], v104 offset:50176
  ds_read_b64_tr_b16 v[188:189], v104 offset:57344
  ds_read_b64_tr_b16 v[190:191], v104 offset:58368
  ds_read_b64_tr_b16 v[200:201], v105 offset:49152
  ds_read_b64_tr_b16 v[202:203], v105 offset:50176
  ds_read_b64_tr_b16 v[204:205], v105 offset:57344
  ds_read_b64_tr_b16 v[206:207], v105 offset:58368
  s_branch L_c_tr_61
L_c_tr_62:
  s_cmp_lg_u32 s4, 1
  s_cbranch_scc1 L_c_tr_63
  ds_read_b64_tr_b16 v[168:169], v104 offset:49152
  ds_read_b64_tr_b16 v[170:171], v104 offset:50176
  ds_read_b64_tr_b16 v[172:173], v104 offset:57344
  ds_read_b64_tr_b16 v[174:175], v104 offset:58368
  ds_read_b64_tr_b16 v[92:93], v105 offset:49152
  ds_read_b64_tr_b16 v[94:95], v105 offset:50176
  ds_read_b64_tr_b16 v[96:97], v105 offset:57344
  ds_read_b64_tr_b16 v[98:99], v105 offset:58368
  s_branch L_c_tr_61
L_c_tr_63:
  s_cmp_lg_u32 s4, 2
  s_cbranch_scc1 L_c_tr_64
  ds_read_b64_tr_b16 v[152:153], v104 offset:49152
  ds_read_b64_tr_b16 v[154:155], v104 offset:50176
  ds_read_b64_tr_b16 v[156:157], v104 offset:57344
  ds_read_b64_tr_b16 v[158:159], v104 offset:58368
  ds_read_b64_tr_b16 v[76:77], v105 offset:49152
  ds_read_b64_tr_b16 v[78:79], v105 offset:50176
  ds_read_b64_tr_b16 v[80:81], v105 offset:57344
  ds_read_b64_tr_b16 v[82:83], v105 offset:58368
  s_branch L_c_tr_61
L_c_tr_64:
  ds_read_b64_tr_b16 v[136:137], v104 offset:49152
  ds_read_b64_tr_b16 v[138:139], v104 offset:50176
  ds_read_b64_tr_b16 v[140:141], v104 offset:57344
  ds_read_b64_tr_b16 v[142:143], v104 offset:58368
  ds_read_b64_tr_b16 v[60:61], v105 offset:49152
  ds_read_b64_tr_b16 v[62:63], v105 offset:50176
  ds_read_b64_tr_b16 v[64:65], v105 offset:57344
  ds_read_b64_tr_b16 v[66:67], v105 offset:58368
L_c_tr_61:
  s_waitcnt vmcnt(24) lgkmcnt(0)
  s_barrier
  s_cmp_lg_u32 s4, 0
  s_cbranch_scc1 L_c_noarr
  s_lshl_b32 s61, s7, 16
  s_add_u32 s61, s61, 1
  v_mov_b32 v108, s61
  v_mov_b32 v109, 32
  s_mov_b64 exec, 1
  buffer_atomic_add v108, v109, s[48:51], 0 offen
  s_mov_b64 exec, -1
L_c_noarr:
  s_add_u32 m0, s64, 114688
  s_mov_b32 s65, 3670016
  buffer_load_dwordx4 v100, s[20:23], s65 offen lds
  s_add_u32 m0, s64, 115712
  s_mov_b32 s65, 3702784
  buffer_load_dwordx4 v100, s[20:23], s65 offen lds
  s_add_u32 m0, s64, 116736
  s_mov_b32 s65, 3735552
  buffer_load_dwordx4 v101, s[20:23], s65 offen lds
  s_add_u32 m0, s64, 117760
  s_mov_b32 s65, 3768320
  buffer_load_dwordx4 v101, s[20:23], s65 offen lds
  s_cmp_lg_u32 s4, 0
  s_cbranch_scc1 L_c_tr_67
  ds_read_b64_tr_b16 a[0:1], v102 offset:0
  ds_read_b64_tr_b16 a[2:3], v102 offset:1024
  ds_read_b64_tr_b16 a[4:5], v102 offset:8192
  ds_read_b64_tr_b16 a[6:7], v102 offset:9216
  ds_read_b64_tr_b16 a[64:65], v103 offset:0
  ds_read_b64_tr_b16 a[66:67], v103 offset:1024
  ds_read_b64_tr_b16 a[68:69], v103 offset:8192
  ds_read_b64_tr_b16 a[70:71], v103 offset:9216
  s_branch L_c_tr_66
L_c_tr_67:
  s_cmp_lg_u32 s4, 1
  s_cbranch_scc1 L_c_tr_68
  ds_read_b64_tr_b16 a[16:17], v102 offset:0
  ds_read_b64_tr_b16 a[18:19], v102 offset:1024
  ds_read_b64_tr_b16 a[20:21], v102 offset:8192
  ds_read_b64_tr_b16 a[22:23], v102 offset:9216
  ds_read_b64_tr_b16 a[80:81], v103 offset:0
  ds_read_b64_tr_b16 a[82:83], v103 offset:1024
  ds_read_b64_tr_b16 a[84:85], v103 offset:8192
  ds_read_b64_tr_b16 a[86:87], v103 offset:9216
  s_branch L_c_tr_66
L_c_tr_68:
  s_cmp_lg_u32 s4, 2
  s_cbranch_scc1 L_c_tr_69
  ds_read_b64_tr_b16 a[32:33], v102 offset:0
  ds_read_b64_tr_b16 a[34:35], v102 offset:1024
  ds_read_b64_tr_b16 a[36:37], v102 offset:8192
  ds_read_b64_tr_b16 a[38:39], v102 offset:9216
  ds_read_b64_tr_b16 a[96:97], v103 offset:0
  ds_read_b64_tr_b16 a[98:99], v103 offset:1024
  ds_read_b64_tr_b16 a[100:101], v103 offset:8192
  ds_read_b64_tr_b16 a[102:103], v103 offset:9216
  s_branch L_c_tr_66
L_c_tr_69:
  ds_read_b64_tr_b16 a[48:49], v102 offset:0
  ds_read_b64_tr_b16 a[50:51], v102 offset:1024
  ds_read_b64_tr_b16 a[52:53], v102 offset:8192
  ds_read_b64_tr_b16 a[54:55], v102 offset:9216
  ds_read_b64_tr_b16 a[112:113], v103 offset:0
  ds_read_b64_tr_b16 a[114:115], v103 offset:1024
  ds_read_b64_tr_b16 a[116:117], v103 offset:8192
  ds_read_b64_tr_b16 a[118:119], v103 offset:9216
L_c_tr_66:
  v_min_u32 v16, -2, v16
  s_mov_b32 s57, 1572864
  buffer_store_dword v16, v6, s[52:55], s57 offen sc1
  buffer_load_dword v3, off, s[48:51], 0 offset:228 sc1
  s_waitcnt vmcnt(26) lgkmcnt(0)
  s_barrier
  s_add_u32 m0, s64, 0
  s_mov_b32 s65, 0
  buffer_load_dwordx4 v100, s[24:27], s65 offen lds
  s_add_u32 m0, s64, 1024
  s_mov_b32 s65, 32768
  buffer_load_dwordx4 v100, s[24:27], s65 offen lds
  s_add_u32 m0, s64, 2048
  s_mov_b32 s65, 65536
  buffer_load_dwordx4 v101, s[24:27], s65 offen lds
  s_add_u32 m0, s64, 3072
  s_mov_b32 s65, 98304
  buffer_load_dwordx4 v101, s[24:27], s65 offen lds
  s_cmp_lg_u32 s4, 0
  s_cbranch_scc1 L_c_tr_72
  ds_read_b64_tr_b16 a[8:9], v102 offset:16384
  ds_read_b64_tr_b16 a[10:11], v102 offset:17408
  ds_read_b64_tr_b16 a[12:13], v102 offset:24576
  ds_read_b64_tr_b16 a[14:15], v102 offset:25600
  ds_read_b64_tr_b16 a[72:73], v103 offset:16384
  ds_read_b64_tr_b16 a[74:75], v103 offset:17408
  ds_read_b64_tr_b16 a[76:77], v103 offset:24576
  ds_read_b64_tr_b16 a[78:79], v103 offset:25600
  s_branch L_c_tr_71
L_c_tr_72:
  s_cmp_lg_u32 s4, 1
  s_cbranch_scc1 L_c_tr_73
  ds_read_b64_tr_b16 a[24:25], v102 offset:16384
  ds_read_b64_tr_b16 a[26:27], v102 offset:17408
  ds_read_b64_tr_b16 a[28:29], v102 offset:24576
  ds_read_b64_tr_b16 a[30:31], v102 offset:25600
  ds_read_b64_tr_b16 a[88:89], v103 offset:16384
  ds_read_b64_tr_b16 a[90:91], v103 offset:17408
  ds_read_b64_tr_b16 a[92:93], v103 offset:24576
  ds_read_b64_tr_b16 a[94:95], v103 offset:25600
  s_branch L_c_tr_71
L_c_tr_73:
  s_cmp_lg_u32 s4, 2
  s_cbranch_scc1 L_c_tr_74
  ds_read_b64_tr_b16 a[40:41], v102 offset:16384
  ds_read_b64_tr_b16 a[42:43], v102 offset:17408
  ds_read_b64_tr_b16 a[44:45], v102 offset:24576
  ds_read_b64_tr_b16 a[46:47], v102 offset:25600
  ds_read_b64_tr_b16 a[104:105], v103 offset:16384
  ds_read_b64_tr_b16 a[106:107], v103 offset:17408
  ds_read_b64_tr_b16 a[108:109], v103 offset:24576
  ds_read_b64_tr_b16 a[110:111], v103 offset:25600
  s_branch L_c_tr_71
L_c_tr_74:
  ds_read_b64_tr_b16 a[56:57], v102 offset:16384
  ds_read_b64_tr_b16 a[58:59], v102 offset:17408
  ds_read_b64_tr_b16 a[60:61], v102 offset:24576
  ds_read_b64_tr_b16 a[62:63], v102 offset:25600
  ds_read_b64_tr_b16 a[120:121], v103 offset:16384
  ds_read_b64_tr_b16 a[122:123], v103 offset:17408
  ds_read_b64_tr_b16 a[124:125], v103 offset:24576
  ds_read_b64_tr_b16 a[126:127], v103 offset:25600
L_c_tr_71:
  s_mov_b32 s66, 0x3e0293ee
  s_mov_b32 s67, 0xffff0000
  v_lshlrev_b32 v1, 16, v128
  v_and_b32 v2, s67, v128
  v_mul_f32 v1, s66, v1
  v_mul_f32 v2, s66, v2
  v_cvt_pk_bf16_f32 v128, v1, v2
  v_lshlrev_b32 v1, 16, v129
  v_and_b32 v2, s67, v129
  v_mul_f32 v1, s66, v1
  v_mul_f32 v2, s66, v2
  v_cvt_pk_bf16_f32 v129, v1, v2
  v_lshlrev_b32 v1, 16, v130
  v_and_b32 v2, s67, v130
  v_mul_f32 v1, s66, v1
  v_mul_f32 v2, s66, v2
  v_cvt_pk_bf16_f32 v130, v1, v2
  v_lshlrev_b32 v1, 16, v131
  v_and_b32 v2, s67, v131
  v_mul_f32 v1, s66, v1
  v_mul_f32 v2, s66, v2
  v_cvt_pk_bf16_f32 v131, v1, v2
  v_lshlrev_b32 v1, 16, v132
  v_and_b32 v2, s67, v132
  v_mul_f32 v1, s66, v1
  v_mul_f32 v2, s66, v2
  v_cvt_pk_bf16_f32 v132, v1, v2
  v_lshlrev_b32 v1, 16, v133
  v_and_b32 v2, s67, v133
  v_mul_f32 v1, s66, v1
  v_mul_f32 v2, s66, v2
  v_cvt_pk_bf16_f32 v133, v1, v2
  v_lshlrev_b32 v1, 16, v134
  v_and_b32 v2, s67, v134
  v_mul_f32 v1, s66, v1
  v_mul_f32 v2, s66, v2
  v_cvt_pk_bf16_f32 v134, v1, v2
  v_lshlrev_b32 v1, 16, v135
  v_and_b32 v2, s67, v135
  v_mul_f32 v1, s66, v1
  v_mul_f32 v2, s66, v2
  v_cvt_pk_bf16_f32 v135, v1, v2
  v_lshlrev_b32 v1, 16, v136
  v_and_b32 v2, s67, v136
  v_mul_f32 v1, s66, v1
  v_mul_f32 v2, s66, v2
  v_cvt_pk_bf16_f32 v136, v1, v2
  v_lshlrev_b32 v1, 16, v137
  v_and_b32 v2, s67, v137
  v_mul_f32 v1, s66, v1
  v_mul_f32 v2, s66, v2
  v_cvt_pk_bf16_f32 v137, v1, v2
  v_lshlrev_b32 v1, 16, v138
  v_and_b32 v2, s67, v138
  v_mul_f32 v1, s66, v1
  v_mul_f32 v2, s66, v2
  v_cvt_pk_bf16_f32 v138, v1, v2
  v_lshlrev_b32 v1, 16, v139
  v_and_b32 v2, s67, v139
  v_mul_f32 v1, s66, v1
  v_mul_f32 v2, s66, v2
  v_cvt_pk_bf16_f32 v139, v1, v2
  v_lshlrev_b32 v1, 16, v140
  v_and_b32 v2, s67, v140
  v_mul_f32 v1, s66, v1
  v_mul_f32 v2, s66, v2
  v_cvt_pk_bf16_f32 v140, v1, v2
  v_lshlrev_b32 v1, 16, v141
  v_and_b32 v2, s67, v141
  v_mul_f32 v1, s66, v1
  v_mul_f32 v2, s66, v2
  v_cvt_pk_bf16_f32 v141, v1, v2
  v_lshlrev_b32 v1, 16, v142
  v_and_b32 v2, s67, v142
  v_mul_f32 v1, s66, v1
  v_mul_f32 v2, s66, v2
  v_cvt_pk_bf16_f32 v142, v1, v2
  v_lshlrev_b32 v1, 16, v143
  v_and_b32 v2, s67, v143
  v_mul_f32 v1, s66, v1
  v_mul_f32 v2, s66, v2
  v_cvt_pk_bf16_f32 v143, v1, v2
  s_waitcnt vmcnt(26) lgkmcnt(0)
  s_barrier
  s_add_u32 m0, s64, 16384
  s_mov_b32 s65, 524288
  buffer_load_dwordx4 v100, s[24:27], s65 offen lds
  s_add_u32 m0, s64, 17408
  s_mov_b32 s65, 557056
  buffer_load_dwordx4 v100, s[24:27], s65 offen lds
  s_add_u32 m0, s64, 18432
  s_mov_b32 s65, 589824
  buffer_load_dwordx4 v101, s[24:27], s65 offen lds
  s_add_u32 m0, s64, 19456
  s_mov_b32 s65, 622592
  buffer_load_dwordx4 v101, s[24:27], s65 offen lds
  s_cmp_lg_u32 s4, 0
  s_cbranch_scc1 L_c_tr_77
  ds_read_b64_tr_b16 a[16:17], v102 offset:32768
  ds_read_b64_tr_b16 a[18:19], v102 offset:33792
  ds_read_b64_tr_b16 a[20:21], v102 offset:40960
  ds_read_b64_tr_b16 a[22:23], v102 offset:41984
  ds_read_b64_tr_b16 a[80:81], v103 offset:32768
  ds_read_b64_tr_b16 a[82:83], v103 offset:33792
  ds_read_b64_tr_b16 a[84:85], v103 offset:40960
  ds_read_b64_tr_b16 a[86:87], v103 offset:41984
  s_branch L_c_tr_76
L_c_tr_77:
  s_cmp_lg_u32 s4, 1
  s_cbranch_scc1 L_c_tr_78
  ds_read_b64_tr_b16 a[0:1], v102 offset:32768
  ds_read_b64_tr_b16 a[2:3], v102 offset:33792
  ds_read_b64_tr_b16 a[4:5], v102 offset:40960
  ds_read_b64_tr_b16 a[6:7], v102 offset:41984
  ds_read_b64_tr_b16 a[64:65], v103 offset:32768
  ds_read_b64_tr_b16 a[66:67], v103 offset:33792
  ds_read_b64_tr_b16 a[68:69], v103 offset:40960
  ds_read_b64_tr_b16 a[70:71], v103 offset:41984
  s_branch L_c_tr_76
L_c_tr_78:
  s_cmp_lg_u32 s4, 2
  s_cbranch_scc1 L_c_tr_79
  ds_read_b64_tr_b16 a[48:49], v102 offset:32768
  ds_read_b64_tr_b16 a[50:51], v102 offset:33792
  ds_read_b64_tr_b16 a[52:53], v102 offset:40960
  ds_read_b64_tr_b16 a[54:55], v102 offset:41984
  ds_read_b64_tr_b16 a[112:113], v103 offset:32768
  ds_read_b64_tr_b16 a[114:115], v103 offset:33792
  ds_read_b64_tr_b16 a[116:117], v103 offset:40960
  ds_read_b64_tr_b16 a[118:119], v103 offset:41984
  s_branch L_c_tr_76
L_c_tr_79:
  ds_read_b64_tr_b16 a[32:33], v102 offset:32768
  ds_read_b64_tr_b16 a[34:35], v102 offset:33792
  ds_read_b64_tr_b16 a[36:37], v102 offset:40960
  ds_read_b64_tr_b16 a[38:39], v102 offset:41984
  ds_read_b64_tr_b16 a[96:97], v103 offset:32768
  ds_read_b64_tr_b16 a[98:99], v103 offset:33792
  ds_read_b64_tr_b16 a[100:101], v103 offset:40960
  ds_read_b64_tr_b16 a[102:103], v103 offset:41984
L_c_tr_76:
  v_lshlrev_b32 v1, 16, v144
  v_and_b32 v2, s67, v144
  v_mul_f32 v1, s66, v1
  v_mul_f32 v2, s66, v2
  v_cvt_pk_bf16_f32 v144, v1, v2
  v_lshlrev_b32 v1, 16, v145
  v_and_b32 v2, s67, v145
  v_mul_f32 v1, s66, v1
  v_mul_f32 v2, s66, v2
  v_cvt_pk_bf16_f32 v145, v1, v2
  v_lshlrev_b32 v1, 16, v146
  v_and_b32 v2, s67, v146
  v_mul_f32 v1, s66, v1
  v_mul_f32 v2, s66, v2
  v_cvt_pk_bf16_f32 v146, v1, v2
  v_lshlrev_b32 v1, 16, v147
  v_and_b32 v2, s67, v147
  v_mul_f32 v1, s66, v1
  v_mul_f32 v2, s66, v2
  v_cvt_pk_bf16_f32 v147, v1, v2
  v_lshlrev_b32 v1, 16, v148
  v_and_b32 v2, s67, v148
  v_mul_f32 v1, s66, v1
  v_mul_f32 v2, s66, v2
  v_cvt_pk_bf16_f32 v148, v1, v2
  v_lshlrev_b32 v1, 16, v149
  v_and_b32 v2, s67, v149
  v_mul_f32 v1, s66, v1
  v_mul_f32 v2, s66, v2
  v_cvt_pk_bf16_f32 v149, v1, v2
  v_lshlrev_b32 v1, 16, v150
  v_and_b32 v2, s67, v150
  v_mul_f32 v1, s66, v1
  v_mul_f32 v2, s66, v2
  v_cvt_pk_bf16_f32 v150, v1, v2
  v_lshlrev_b32 v1, 16, v151
  v_and_b32 v2, s67, v151
  v_mul_f32 v1, s66, v1
  v_mul_f32 v2, s66, v2
  v_cvt_pk_bf16_f32 v151, v1, v2
  v_lshlrev_b32 v1, 16, v152
  v_and_b32 v2, s67, v152
  v_mul_f32 v1, s66, v1
  v_mul_f32 v2, s66, v2
  v_cvt_pk_bf16_f32 v152, v1, v2
  v_lshlrev_b32 v1, 16, v153
  v_and_b32 v2, s67, v153
  v_mul_f32 v1, s66, v1
  v_mul_f32 v2, s66, v2
  v_cvt_pk_bf16_f32 v153, v1, v2
  v_lshlrev_b32 v1, 16, v154
  v_and_b32 v2, s67, v154
  v_mul_f32 v1, s66, v1
  v_mul_f32 v2, s66, v2
  v_cvt_pk_bf16_f32 v154, v1, v2
  v_lshlrev_b32 v1, 16, v155
  v_and_b32 v2, s67, v155
  v_mul_f32 v1, s66, v1
  v_mul_f32 v2, s66, v2
  v_cvt_pk_bf16_f32 v155, v1, v2
  v_lshlrev_b32 v1, 16, v156
  v_and_b32 v2, s67, v156
  v_mul_f32 v1, s66, v1
  v_mul_f32 v2, s66, v2
  v_cvt_pk_bf16_f32 v156, v1, v2
  v_lshlrev_b32 v1, 16, v157
  v_and_b32 v2, s67, v157
  v_mul_f32 v1, s66, v1
  v_mul_f32 v2, s66, v2
  v_cvt_pk_bf16_f32 v157, v1, v2
  v_lshlrev_b32 v1, 16, v158
  v_and_b32 v2, s67, v158
  v_mul_f32 v1, s66, v1
  v_mul_f32 v2, s66, v2
  v_cvt_pk_bf16_f32 v158, v1, v2
  v_lshlrev_b32 v1, 16, v159
  v_and_b32 v2, s67, v159
  v_mul_f32 v1, s66, v1
  v_mul_f32 v2, s66, v2
  v_cvt_pk_bf16_f32 v159, v1, v2
  s_waitcnt vmcnt(26) lgkmcnt(0)
  s_barrier
  s_add_u32 m0, s64, 32768
  s_mov_b32 s65, 1048576
  buffer_load_dwordx4 v100, s[24:27], s65 offen lds
  s_add_u32 m0, s64, 33792
  s_mov_b32 s65, 1081344
  buffer_load_dwordx4 v100, s[24:27], s65 offen lds
  s_add_u32 m0, s64, 34816
  s_mov_b32 s65, 1114112
  buffer_load_dwordx4 v101, s[24:27], s65 offen lds
  s_add_u32 m0, s64, 35840
  s_mov_b32 s65, 1146880
  buffer_load_dwordx4 v101, s[24:27], s65 offen lds
  s_cmp_lg_u32 s4, 0
  s_cbranch_scc1 L_c_tr_82
  ds_read_b64_tr_b16 a[24:25], v102 offset:49152
  ds_read_b64_tr_b16 a[26:27], v102 offset:50176
  ds_read_b64_tr_b16 a[28:29], v102 offset:57344
  ds_read_b64_tr_b16 a[30:31], v102 offset:58368
  ds_read_b64_tr_b16 a[88:89], v103 offset:49152
  ds_read_b64_tr_b16 a[90:91], v103 offset:50176
  ds_read_b64_tr_b16 a[92:93], v103 offset:57344
  ds_read_b64_tr_b16 a[94:95], v103 offset:58368
  s_branch L_c_tr_81
L_c_tr_82:
  s_cmp_lg_u32 s4, 1
  s_cbranch_scc1 L_c_tr_83
  ds_read_b64_tr_b16 a[8:9], v102 offset:49152
  ds_read_b64_tr_b16 a[10:11], v102 offset:50176
  ds_read_b64_tr_b16 a[12:13], v102 offset:57344
  ds_read_b64_tr_b16 a[14:15], v102 offset:58368
  ds_read_b64_tr_b16 a[72:73], v103 offset:49152
  ds_read_b64_tr_b16 a[74:75], v103 offset:50176
  ds_read_b64_tr_b16 a[76:77], v103 offset:57344
  ds_read_b64_tr_b16 a[78:79], v103 offset:58368
  s_branch L_c_tr_81
L_c_tr_83:
  s_cmp_lg_u32 s4, 2
  s_cbranch_scc1 L_c_tr_84
  ds_read_b64_tr_b16 a[56:57], v102 offset:49152
  ds_read_b64_tr_b16 a[58:59], v102 offset:50176
  ds_read_b64_tr_b16 a[60:61], v102 offset:57344
  ds_read_b64_tr_b16 a[62:63], v102 offset:58368
  ds_read_b64_tr_b16 a[120:121], v103 offset:49152
  ds_read_b64_tr_b16 a[122:123], v103 offset:50176
  ds_read_b64_tr_b16 a[124:125], v103 offset:57344
  ds_read_b64_tr_b16 a[126:127], v103 offset:58368
  s_branch L_c_tr_81
L_c_tr_84:
  ds_read_b64_tr_b16 a[40:41], v102 offset:49152
  ds_read_b64_tr_b16 a[42:43], v102 offset:50176
  ds_read_b64_tr_b16 a[44:45], v102 offset:57344
  ds_read_b64_tr_b16 a[46:47], v102 offset:58368
  ds_read_b64_tr_b16 a[104:105], v103 offset:49152
  ds_read_b64_tr_b16 a[106:107], v103 offset:50176
  ds_read_b64_tr_b16 a[108:109], v103 offset:57344
  ds_read_b64_tr_b16 a[110:111], v103 offset:58368
L_c_tr_81:
  v_lshlrev_b32 v1, 16, v160
  v_and_b32 v2, s67, v160
  v_mul_f32 v1, s66, v1
  v_mul_f32 v2, s66, v2
  v_cvt_pk_bf16_f32 v160, v1, v2
  v_lshlrev_b32 v1, 16, v161
  v_and_b32 v2, s67, v161
  v_mul_f32 v1, s66, v1
  v_mul_f32 v2, s66, v2
  v_cvt_pk_bf16_f32 v161, v1, v2
  v_lshlrev_b32 v1, 16, v162
  v_and_b32 v2, s67, v162
  v_mul_f32 v1, s66, v1
  v_mul_f32 v2, s66, v2
  v_cvt_pk_bf16_f32 v162, v1, v2
  v_lshlrev_b32 v1, 16, v163
  v_and_b32 v2, s67, v163
  v_mul_f32 v1, s66, v1
  v_mul_f32 v2, s66, v2
  v_cvt_pk_bf16_f32 v163, v1, v2
  v_lshlrev_b32 v1, 16, v164
  v_and_b32 v2, s67, v164
  v_mul_f32 v1, s66, v1
  v_mul_f32 v2, s66, v2
  v_cvt_pk_bf16_f32 v164, v1, v2
  v_lshlrev_b32 v1, 16, v165
  v_and_b32 v2, s67, v165
  v_mul_f32 v1, s66, v1
  v_mul_f32 v2, s66, v2
  v_cvt_pk_bf16_f32 v165, v1, v2
  v_lshlrev_b32 v1, 16, v166
  v_and_b32 v2, s67, v166
  v_mul_f32 v1, s66, v1
  v_mul_f32 v2, s66, v2
  v_cvt_pk_bf16_f32 v166, v1, v2
  v_lshlrev_b32 v1, 16, v167
  v_and_b32 v2, s67, v167
  v_mul_f32 v1, s66, v1
  v_mul_f32 v2, s66, v2
  v_cvt_pk_bf16_f32 v167, v1, v2
  v_lshlrev_b32 v1, 16, v168
  v_and_b32 v2, s67, v168
  v_mul_f32 v1, s66, v1
  v_mul_f32 v2, s66, v2
  v_cvt_pk_bf16_f32 v168, v1, v2
  v_lshlrev_b32 v1, 16, v169
  v_and_b32 v2, s67, v169
  v_mul_f32 v1, s66, v1
  v_mul_f32 v2, s66, v2
  v_cvt_pk_bf16_f32 v169, v1, v2
  v_lshlrev_b32 v1, 16, v170
  v_and_b32 v2, s67, v170
  v_mul_f32 v1, s66, v1
  v_mul_f32 v2, s66, v2
  v_cvt_pk_bf16_f32 v170, v1, v2
  v_lshlrev_b32 v1, 16, v171
  v_and_b32 v2, s67, v171
  v_mul_f32 v1, s66, v1
  v_mul_f32 v2, s66, v2
  v_cvt_pk_bf16_f32 v171, v1, v2
  v_lshlrev_b32 v1, 16, v172
  v_and_b32 v2, s67, v172
  v_mul_f32 v1, s66, v1
  v_mul_f32 v2, s66, v2
  v_cvt_pk_bf16_f32 v172, v1, v2
  v_lshlrev_b32 v1, 16, v173
  v_and_b32 v2, s67, v173
  v_mul_f32 v1, s66, v1
  v_mul_f32 v2, s66, v2
  v_cvt_pk_bf16_f32 v173, v1, v2
  v_lshlrev_b32 v1, 16, v174
  v_and_b32 v2, s67, v174
  v_mul_f32 v1, s66, v1
  v_mul_f32 v2, s66, v2
  v_cvt_pk_bf16_f32 v174, v1, v2
  v_lshlrev_b32 v1, 16, v175
  v_and_b32 v2, s67, v175
  v_mul_f32 v1, s66, v1
  v_mul_f32 v2, s66, v2
  v_cvt_pk_bf16_f32 v175, v1, v2
  s_waitcnt vmcnt(26) lgkmcnt(0)
  s_barrier
  s_add_u32 m0, s64, 49152
  s_mov_b32 s65, 1572864
  buffer_load_dwordx4 v100, s[24:27], s65 offen lds
  s_add_u32 m0, s64, 50176
  s_mov_b32 s65, 1605632
  buffer_load_dwordx4 v100, s[24:27], s65 offen lds
  s_add_u32 m0, s64, 51200
  s_mov_b32 s65, 1638400
  buffer_load_dwordx4 v101, s[24:27], s65 offen lds
  s_add_u32 m0, s64, 52224
  s_mov_b32 s65, 1671168
  buffer_load_dwordx4 v101, s[24:27], s65 offen lds
  s_cmp_lg_u32 s4, 0
  s_cbranch_scc1 L_c_tr_87
  ds_read_b64_tr_b16 a[32:33], v104 offset:0
  ds_read_b64_tr_b16 a[34:35], v104 offset:1024
  ds_read_b64_tr_b16 a[36:37], v104 offset:8192
  ds_read_b64_tr_b16 a[38:39], v104 offset:9216
  ds_read_b64_tr_b16 a[96:97], v105 offset:0
  ds_read_b64_tr_b16 a[98:99], v105 offset:1024
  ds_read_b64_tr_b16 a[100:101], v105 offset:8192
  ds_read_b64_tr_b16 a[102:103], v105 offset:9216
  s_branch L_c_tr_86
L_c_tr_87:
  s_cmp_lg_u32 s4, 1
  s_cbranch_scc1 L_c_tr_88
  ds_read_b64_tr_b16 a[48:49], v104 offset:0
  ds_read_b64_tr_b16 a[50:51], v104 offset:1024
  ds_read_b64_tr_b16 a[52:53], v104 offset:8192
  ds_read_b64_tr_b16 a[54:55], v104 offset:9216
  ds_read_b64_tr_b16 a[112:113], v105 offset:0
  ds_read_b64_tr_b16 a[114:115], v105 offset:1024
  ds_read_b64_tr_b16 a[116:117], v105 offset:8192
  ds_read_b64_tr_b16 a[118:119], v105 offset:9216
  s_branch L_c_tr_86
L_c_tr_88:
  s_cmp_lg_u32 s4, 2
  s_cbranch_scc1 L_c_tr_89
  ds_read_b64_tr_b16 a[0:1], v104 offset:0
  ds_read_b64_tr_b16 a[2:3], v104 offset:1024
  ds_read_b64_tr_b16 a[4:5], v104 offset:8192
  ds_read_b64_tr_b16 a[6:7], v104 offset:9216
  ds_read_b64_tr_b16 a[64:65], v105 offset:0
  ds_read_b64_tr_b16 a[66:67], v105 offset:1024
  ds_read_b64_tr_b16 a[68:69], v105 offset:8192
  ds_read_b64_tr_b16 a[70:71], v105 offset:9216
  s_branch L_c_tr_86
L_c_tr_89:
  ds_read_b64_tr_b16 a[16:17], v104 offset:0
  ds_read_b64_tr_b16 a[18:19], v104 offset:1024
  ds_read_b64_tr_b16 a[20:21], v104 offset:8192
  ds_read_b64_tr_b16 a[22:23], v104 offset:9216
  ds_read_b64_tr_b16 a[80:81], v105 offset:0
  ds_read_b64_tr_b16 a[82:83], v105 offset:1024
  ds_read_b64_tr_b16 a[84:85], v105 offset:8192
  ds_read_b64_tr_b16 a[86:87], v105 offset:9216
L_c_tr_86:
  v_lshlrev_b32 v1, 16, v176
  v_and_b32 v2, s67, v176
  v_mul_f32 v1, s66, v1
  v_mul_f32 v2, s66, v2
  v_cvt_pk_bf16_f32 v176, v1, v2
  v_lshlrev_b32 v1, 16, v177
  v_and_b32 v2, s67, v177
  v_mul_f32 v1, s66, v1
  v_mul_f32 v2, s66, v2
  v_cvt_pk_bf16_f32 v177, v1, v2
  v_lshlrev_b32 v1, 16, v178
  v_and_b32 v2, s67, v178
  v_mul_f32 v1, s66, v1
  v_mul_f32 v2, s66, v2
  v_cvt_pk_bf16_f32 v178, v1, v2
  v_lshlrev_b32 v1, 16, v179
  v_and_b32 v2, s67, v179
  v_mul_f32 v1, s66, v1
  v_mul_f32 v2, s66, v2
  v_cvt_pk_bf16_f32 v179, v1, v2
  v_lshlrev_b32 v1, 16, v180
  v_and_b32 v2, s67, v180
  v_mul_f32 v1, s66, v1
  v_mul_f32 v2, s66, v2
  v_cvt_pk_bf16_f32 v180, v1, v2
  v_lshlrev_b32 v1, 16, v181
  v_and_b32 v2, s67, v181
  v_mul_f32 v1, s66, v1
  v_mul_f32 v2, s66, v2
  v_cvt_pk_bf16_f32 v181, v1, v2
  v_lshlrev_b32 v1, 16, v182
  v_and_b32 v2, s67, v182
  v_mul_f32 v1, s66, v1
  v_mul_f32 v2, s66, v2
  v_cvt_pk_bf16_f32 v182, v1, v2
  v_lshlrev_b32 v1, 16, v183
  v_and_b32 v2, s67, v183
  v_mul_f32 v1, s66, v1
  v_mul_f32 v2, s66, v2
  v_cvt_pk_bf16_f32 v183, v1, v2
  v_lshlrev_b32 v1, 16, v184
  v_and_b32 v2, s67, v184
  v_mul_f32 v1, s66, v1
  v_mul_f32 v2, s66, v2
  v_cvt_pk_bf16_f32 v184, v1, v2
  v_lshlrev_b32 v1, 16, v185
  v_and_b32 v2, s67, v185
  v_mul_f32 v1, s66, v1
  v_mul_f32 v2, s66, v2
  v_cvt_pk_bf16_f32 v185, v1, v2
  v_lshlrev_b32 v1, 16, v186
  v_and_b32 v2, s67, v186
  v_mul_f32 v1, s66, v1
  v_mul_f32 v2, s66, v2
  v_cvt_pk_bf16_f32 v186, v1, v2
  v_lshlrev_b32 v1, 16, v187
  v_and_b32 v2, s67, v187
  v_mul_f32 v1, s66, v1
  v_mul_f32 v2, s66, v2
  v_cvt_pk_bf16_f32 v187, v1, v2
  v_lshlrev_b32 v1, 16, v188
  v_and_b32 v2, s67, v188
  v_mul_f32 v1, s66, v1
  v_mul_f32 v2, s66, v2
  v_cvt_pk_bf16_f32 v188, v1, v2
  v_lshlrev_b32 v1, 16, v189
  v_and_b32 v2, s67, v189
  v_mul_f32 v1, s66, v1
  v_mul_f32 v2, s66, v2
  v_cvt_pk_bf16_f32 v189, v1, v2
  v_lshlrev_b32 v1, 16, v190
  v_and_b32 v2, s67, v190
  v_mul_f32 v1, s66, v1
  v_mul_f32 v2, s66, v2
  v_cvt_pk_bf16_f32 v190, v1, v2
  v_lshlrev_b32 v1, 16, v191
  v_and_b32 v2, s67, v191
  v_mul_f32 v1, s66, v1
  v_mul_f32 v2, s66, v2
  v_cvt_pk_bf16_f32 v191, v1, v2
  s_waitcnt vmcnt(26) lgkmcnt(0)
  s_barrier
  s_add_u32 m0, s64, 65536
  s_mov_b32 s65, 2097152
  buffer_load_dwordx4 v100, s[24:27], s65 offen lds
  s_add_u32 m0, s64, 66560
  s_mov_b32 s65, 2129920
  buffer_load_dwordx4 v100, s[24:27], s65 offen lds
  s_add_u32 m0, s64, 67584
  s_mov_b32 s65, 2162688
  buffer_load_dwordx4 v101, s[24:27], s65 offen lds
  s_add_u32 m0, s64, 68608
  s_mov_b32 s65, 2195456
  buffer_load_dwordx4 v101, s[24:27], s65 offen lds
  s_cmp_lg_u32 s4, 0
  s_cbranch_scc1 L_c_tr_92
  ds_read_b64_tr_b16 a[40:41], v104 offset:16384
  ds_read_b64_tr_b16 a[42:43], v104 offset:17408
  ds_read_b64_tr_b16 a[44:45], v104 offset:24576
  ds_read_b64_tr_b16 a[46:47], v104 offset:25600
  ds_read_b64_tr_b16 a[104:105], v105 offset:16384
  ds_read_b64_tr_b16 a[106:107], v105 offset:17408
  ds_read_b64_tr_b16 a[108:109], v105 offset:24576
  ds_read_b64_tr_b16 a[110:111], v105 offset:25600
  s_branch L_c_tr_91
L_c_tr_92:
  s_cmp_lg_u32 s4, 1
  s_cbranch_scc1 L_c_tr_93
  ds_read_b64_tr_b16 a[56:57], v104 offset:16384
  ds_read_b64_tr_b16 a[58:59], v104 offset:17408
  ds_read_b64_tr_b16 a[60:61], v104 offset:24576
  ds_read_b64_tr_b16 a[62:63], v104 offset:25600
  ds_read_b64_tr_b16 a[120:121], v105 offset:16384
  ds_read_b64_tr_b16 a[122:123], v105 offset:17408
  ds_read_b64_tr_b16 a[124:125], v105 offset:24576
  ds_read_b64_tr_b16 a[126:127], v105 offset:25600
  s_branch L_c_tr_91
L_c_tr_93:
  s_cmp_lg_u32 s4, 2
  s_cbranch_scc1 L_c_tr_94
  ds_read_b64_tr_b16 a[8:9], v104 offset:16384
  ds_read_b64_tr_b16 a[10:11], v104 offset:17408
  ds_read_b64_tr_b16 a[12:13], v104 offset:24576
  ds_read_b64_tr_b16 a[14:15], v104 offset:25600
  ds_read_b64_tr_b16 a[72:73], v105 offset:16384
  ds_read_b64_tr_b16 a[74:75], v105 offset:17408
  ds_read_b64_tr_b16 a[76:77], v105 offset:24576
  ds_read_b64_tr_b16 a[78:79], v105 offset:25600
  s_branch L_c_tr_91
L_c_tr_94:
  ds_read_b64_tr_b16 a[24:25], v104 offset:16384
  ds_read_b64_tr_b16 a[26:27], v104 offset:17408
  ds_read_b64_tr_b16 a[28:29], v104 offset:24576
  ds_read_b64_tr_b16 a[30:31], v104 offset:25600
  ds_read_b64_tr_b16 a[88:89], v105 offset:16384
  ds_read_b64_tr_b16 a[90:91], v105 offset:17408
  ds_read_b64_tr_b16 a[92:93], v105 offset:24576
  ds_read_b64_tr_b16 a[94:95], v105 offset:25600
L_c_tr_91:
  v_lshlrev_b32 v1, 16, v192
  v_and_b32 v2, s67, v192
  v_mul_f32 v1, s66, v1
  v_mul_f32 v2, s66, v2
  v_cvt_pk_bf16_f32 v192, v1, v2
  v_lshlrev_b32 v1, 16, v193
  v_and_b32 v2, s67, v193
  v_mul_f32 v1, s66, v1
  v_mul_f32 v2, s66, v2
  v_cvt_pk_bf16_f32 v193, v1, v2
  v_lshlrev_b32 v1, 16, v194
  v_and_b32 v2, s67, v194
  v_mul_f32 v1, s66, v1
  v_mul_f32 v2, s66, v2
  v_cvt_pk_bf16_f32 v194, v1, v2
  v_lshlrev_b32 v1, 16, v195
  v_and_b32 v2, s67, v195
  v_mul_f32 v1, s66, v1
  v_mul_f32 v2, s66, v2
  v_cvt_pk_bf16_f32 v195, v1, v2
  v_lshlrev_b32 v1, 16, v196
  v_and_b32 v2, s67, v196
  v_mul_f32 v1, s66, v1
  v_mul_f32 v2, s66, v2
  v_cvt_pk_bf16_f32 v196, v1, v2
  v_lshlrev_b32 v1, 16, v197
  v_and_b32 v2, s67, v197
  v_mul_f32 v1, s66, v1
  v_mul_f32 v2, s66, v2
  v_cvt_pk_bf16_f32 v197, v1, v2
  v_lshlrev_b32 v1, 16, v198
  v_and_b32 v2, s67, v198
  v_mul_f32 v1, s66, v1
  v_mul_f32 v2, s66, v2
  v_cvt_pk_bf16_f32 v198, v1, v2
  v_lshlrev_b32 v1, 16, v199
  v_and_b32 v2, s67, v199
  v_mul_f32 v1, s66, v1
  v_mul_f32 v2, s66, v2
  v_cvt_pk_bf16_f32 v199, v1, v2
  v_lshlrev_b32 v1, 16, v200
  v_and_b32 v2, s67, v200
  v_mul_f32 v1, s66, v1
  v_mul_f32 v2, s66, v2
  v_cvt_pk_bf16_f32 v200, v1, v2
  v_lshlrev_b32 v1, 16, v201
  v_and_b32 v2, s67, v201
  v_mul_f32 v1, s66, v1
  v_mul_f32 v2, s66, v2
  v_cvt_pk_bf16_f32 v201, v1, v2
  v_lshlrev_b32 v1, 16, v202
  v_and_b32 v2, s67, v202
  v_mul_f32 v1, s66, v1
  v_mul_f32 v2, s66, v2
  v_cvt_pk_bf16_f32 v202, v1, v2
  v_lshlrev_b32 v1, 16, v203
  v_and_b32 v2, s67, v203
  v_mul_f32 v1, s66, v1
  v_mul_f32 v2, s66, v2
  v_cvt_pk_bf16_f32 v203, v1, v2
  v_lshlrev_b32 v1, 16, v204
  v_and_b32 v2, s67, v204
  v_mul_f32 v1, s66, v1
  v_mul_f32 v2, s66, v2
  v_cvt_pk_bf16_f32 v204, v1, v2
  v_lshlrev_b32 v1, 16, v205
  v_and_b32 v2, s67, v205
  v_mul_f32 v1, s66, v1
  v_mul_f32 v2, s66, v2
  v_cvt_pk_bf16_f32 v205, v1, v2
  v_lshlrev_b32 v1, 16, v206
  v_and_b32 v2, s67, v206
  v_mul_f32 v1, s66, v1
  v_mul_f32 v2, s66, v2
  v_cvt_pk_bf16_f32 v206, v1, v2
  v_lshlrev_b32 v1, 16, v207
  v_and_b32 v2, s67, v207
  v_mul_f32 v1, s66, v1
  v_mul_f32 v2, s66, v2
  v_cvt_pk_bf16_f32 v207, v1, v2
  s_waitcnt vmcnt(26) lgkmcnt(0)
  s_barrier
  s_add_u32 m0, s64, 81920
  s_mov_b32 s65, 2621440
  buffer_load_dwordx4 v100, s[24:27], s65 offen lds
  s_add_u32 m0, s64, 82944
  s_mov_b32 s65, 2654208
  buffer_load_dwordx4 v100, s[24:27], s65 offen lds
  s_add_u32 m0, s64, 83968
  s_mov_b32 s65, 2686976
  buffer_load_dwordx4 v101, s[24:27], s65 offen lds
  s_add_u32 m0, s64, 84992
  s_mov_b32 s65, 2719744
  buffer_load_dwordx4 v101, s[24:27], s65 offen lds
  s_cmp_lg_u32 s4, 0
  s_cbranch_scc1 L_c_tr_97
  ds_read_b64_tr_b16 a[48:49], v104 offset:32768
  ds_read_b64_tr_b16 a[50:51], v104 offset:33792
  ds_read_b64_tr_b16 a[52:53], v104 offset:40960
  ds_read_b64_tr_b16 a[54:55], v104 offset:41984
  ds_read_b64_tr_b16 a[112:113], v105 offset:32768
  ds_read_b64_tr_b16 a[114:115], v105 offset:33792
  ds_read_b64_tr_b16 a[116:117], v105 offset:40960
  ds_read_b64_tr_b16 a[118:119], v105 offset:41984
  s_branch L_c_tr_96
L_c_tr_97:
  s_cmp_lg_u32 s4, 1
  s_cbranch_scc1 L_c_tr_98
  ds_read_b64_tr_b16 a[32:33], v104 offset:32768
  ds_read_b64_tr_b16 a[34:35], v104 offset:33792
  ds_read_b64_tr_b16 a[36:37], v104 offset:40960
  ds_read_b64_tr_b16 a[38:39], v104 offset:41984
  ds_read_b64_tr_b16 a[96:97], v105 offset:32768
  ds_read_b64_tr_b16 a[98:99], v105 offset:33792
  ds_read_b64_tr_b16 a[100:101], v105 offset:40960
  ds_read_b64_tr_b16 a[102:103], v105 offset:41984
  s_branch L_c_tr_96
L_c_tr_98:
  s_cmp_lg_u32 s4, 2
  s_cbranch_scc1 L_c_tr_99
  ds_read_b64_tr_b16 a[16:17], v104 offset:32768
  ds_read_b64_tr_b16 a[18:19], v104 offset:33792
  ds_read_b64_tr_b16 a[20:21], v104 offset:40960
  ds_read_b64_tr_b16 a[22:23], v104 offset:41984
  ds_read_b64_tr_b16 a[80:81], v105 offset:32768
  ds_read_b64_tr_b16 a[82:83], v105 offset:33792
  ds_read_b64_tr_b16 a[84:85], v105 offset:40960
  ds_read_b64_tr_b16 a[86:87], v105 offset:41984
  s_branch L_c_tr_96
L_c_tr_99:
  ds_read_b64_tr_b16 a[0:1], v104 offset:32768
  ds_read_b64_tr_b16 a[2:3], v104 offset:33792
  ds_read_b64_tr_b16 a[4:5], v104 offset:40960
  ds_read_b64_tr_b16 a[6:7], v104 offset:41984
  ds_read_b64_tr_b16 a[64:65], v105 offset:32768
  ds_read_b64_tr_b16 a[66:67], v105 offset:33792
  ds_read_b64_tr_b16 a[68:69], v105 offset:40960
  ds_read_b64_tr_b16 a[70:71], v105 offset:41984
L_c_tr_96:
  v_lshlrev_b32 v1, 16, v52
  v_and_b32 v2, s67, v52
  v_mul_f32 v1, s66, v1
  v_mul_f32 v2, s66, v2
  v_cvt_pk_bf16_f32 v52, v1, v2
  v_lshlrev_b32 v1, 16, v53
  v_and_b32 v2, s67, v53
  v_mul_f32 v1, s66, v1
  v_mul_f32 v2, s66, v2
  v_cvt_pk_bf16_f32 v53, v1, v2
  v_lshlrev_b32 v1, 16, v54
  v_and_b32 v2, s67, v54
  v_mul_f32 v1, s66, v1
  v_mul_f32 v2, s66, v2
  v_cvt_pk_bf16_f32 v54, v1, v2
  v_lshlrev_b32 v1, 16, v55
  v_and_b32 v2, s67, v55
  v_mul_f32 v1, s66, v1
  v_mul_f32 v2, s66, v2
  v_cvt_pk_bf16_f32 v55, v1, v2
  v_lshlrev_b32 v1, 16, v56
  v_and_b32 v2, s67, v56
  v_mul_f32 v1, s66, v1
  v_mul_f32 v2, s66, v2
  v_cvt_pk_bf16_f32 v56, v1, v2
  v_lshlrev_b32 v1, 16, v57
  v_and_b32 v2, s67, v57
  v_mul_f32 v1, s66, v1
  v_mul_f32 v2, s66, v2
  v_cvt_pk_bf16_f32 v57, v1, v2
  v_lshlrev_b32 v1, 16, v58
  v_and_b32 v2, s67, v58
  v_mul_f32 v1, s66, v1
  v_mul_f32 v2, s66, v2
  v_cvt_pk_bf16_f32 v58, v1, v2
  v_lshlrev_b32 v1, 16, v59
  v_and_b32 v2, s67, v59
  v_mul_f32 v1, s66, v1
  v_mul_f32 v2, s66, v2
  v_cvt_pk_bf16_f32 v59, v1, v2
  v_lshlrev_b32 v1, 16, v60
  v_and_b32 v2, s67, v60
  v_mul_f32 v1, s66, v1
  v_mul_f32 v2, s66, v2
  v_cvt_pk_bf16_f32 v60, v1, v2
  v_lshlrev_b32 v1, 16, v61
  v_and_b32 v2, s67, v61
  v_mul_f32 v1, s66, v1
  v_mul_f32 v2, s66, v2
  v_cvt_pk_bf16_f32 v61, v1, v2
  v_lshlrev_b32 v1, 16, v62
  v_and_b32 v2, s67, v62
  v_mul_f32 v1, s66, v1
  v_mul_f32 v2, s66, v2
  v_cvt_pk_bf16_f32 v62, v1, v2
  v_lshlrev_b32 v1, 16, v63
  v_and_b32 v2, s67, v63
  v_mul_f32 v1, s66, v1
  v_mul_f32 v2, s66, v2
  v_cvt_pk_bf16_f32 v63, v1, v2
  v_lshlrev_b32 v1, 16, v64
  v_and_b32 v2, s67, v64
  v_mul_f32 v1, s66, v1
  v_mul_f32 v2, s66, v2
  v_cvt_pk_bf16_f32 v64, v1, v2
  v_lshlrev_b32 v1, 16, v65
  v_and_b32 v2, s67, v65
  v_mul_f32 v1, s66, v1
  v_mul_f32 v2, s66, v2
  v_cvt_pk_bf16_f32 v65, v1, v2
  v_lshlrev_b32 v1, 16, v66
  v_and_b32 v2, s67, v66
  v_mul_f32 v1, s66, v1
  v_mul_f32 v2, s66, v2
  v_cvt_pk_bf16_f32 v66, v1, v2
  v_lshlrev_b32 v1, 16, v67
  v_and_b32 v2, s67, v67
  v_mul_f32 v1, s66, v1
  v_mul_f32 v2, s66, v2
  v_cvt_pk_bf16_f32 v67, v1, v2
  s_mov_b32 s68, 128
  buffer_load_dwordx2 v[208:209], v107, s[28:31], s68 offen
  buffer_load_dwordx2 v[210:211], v107, s[28:31], s68 offen offset:1024
  s_mov_b32 s68, 32896
  buffer_load_dwordx2 v[212:213], v107, s[28:31], s68 offen
  buffer_load_dwordx2 v[214:215], v107, s[28:31], s68 offen offset:1024
  s_mov_b32 s68, 2176
  buffer_load_dwordx2 v[216:217], v107, s[28:31], s68 offen
  buffer_load_dwordx2 v[218:219], v107, s[28:31], s68 offen offset:1024
  s_mov_b32 s68, 34944
  buffer_load_dwordx2 v[220:221], v107, s[28:31], s68 offen
  buffer_load_dwordx2 v[222:223], v107, s[28:31], s68 offen offset:1024
  s_waitcnt vmcnt(34) lgkmcnt(0)
  s_barrier
  s_add_u32 m0, s64, 98304
  s_mov_b32 s65, 3145728
  buffer_load_dwordx4 v100, s[24:27], s65 offen lds
  s_add_u32 m0, s64, 99328
  s_mov_b32 s65, 3178496
  buffer_load_dwordx4 v100, s[24:27], s65 offen lds
  s_add_u32 m0, s64, 100352
  s_mov_b32 s65, 3211264
  buffer_load_dwordx4 v101, s[24:27], s65 offen lds
  s_add_u32 m0, s64, 101376
  s_mov_b32 s65, 3244032
  buffer_load_dwordx4 v101, s[24:27], s65 offen lds
  s_cmp_lg_u32 s4, 0
  s_cbranch_scc1 L_c_tr_102
  ds_read_b64_tr_b16 a[56:57], v104 offset:49152
  ds_read_b64_tr_b16 a[58:59], v104 offset:50176
  ds_read_b64_tr_b16 a[60:61], v104 offset:57344
  ds_read_b64_tr_b16 a[62:63], v104 offset:58368
  ds_read_b64_tr_b16 a[120:121], v105 offset:49152
  ds_read_b64_tr_b16 a[122:123], v105 offset:50176
  ds_read_b64_tr_b16 a[124:125], v105 offset:57344
  ds_read_b64_tr_b16 a[126:127], v105 offset:58368
  s_branch L_c_tr_101
L_c_tr_102:
  s_cmp_lg_u32 s4, 1
  s_cbranch_scc1 L_c_tr_103
  ds_read_b64_tr_b16 a[40:41], v104 offset:49152
  ds_read_b64_tr_b16 a[42:43], v104 offset:50176
  ds_read_b64_tr_b16 a[44:45], v104 offset:57344
  ds_read_b64_tr_b16 a[46:47], v104 offset:58368
  ds_read_b64_tr_b16 a[104:105], v105 offset:49152
  ds_read_b64_tr_b16 a[106:107], v105 offset:50176
  ds_read_b64_tr_b16 a[108:109], v105 offset:57344
  ds_read_b64_tr_b16 a[110:111], v105 offset:58368
  s_branch L_c_tr_101
L_c_tr_103:
  s_cmp_lg_u32 s4, 2
  s_cbranch_scc1 L_c_tr_104
  ds_read_b64_tr_b16 a[24:25], v104 offset:49152
  ds_read_b64_tr_b16 a[26:27], v104 offset:50176
  ds_read_b64_tr_b16 a[28:29], v104 offset:57344
  ds_read_b64_tr_b16 a[30:31], v104 offset:58368
  ds_read_b64_tr_b16 a[88:89], v105 offset:49152
  ds_read_b64_tr_b16 a[90:91], v105 offset:50176
  ds_read_b64_tr_b16 a[92:93], v105 offset:57344
  ds_read_b64_tr_b16 a[94:95], v105 offset:58368
  s_branch L_c_tr_101
L_c_tr_104:
  ds_read_b64_tr_b16 a[8:9], v104 offset:49152
  ds_read_b64_tr_b16 a[10:11], v104 offset:50176
  ds_read_b64_tr_b16 a[12:13], v104 offset:57344
  ds_read_b64_tr_b16 a[14:15], v104 offset:58368
  ds_read_b64_tr_b16 a[72:73], v105 offset:49152
  ds_read_b64_tr_b16 a[74:75], v105 offset:50176
  ds_read_b64_tr_b16 a[76:77], v105 offset:57344
  ds_read_b64_tr_b16 a[78:79], v105 offset:58368
L_c_tr_101:
  v_lshlrev_b32 v1, 16, v68
  v_and_b32 v2, s67, v68
  v_mul_f32 v1, s66, v1
  v_mul_f32 v2, s66, v2
  v_cvt_pk_bf16_f32 v68, v1, v2
  v_lshlrev_b32 v1, 16, v69
  v_and_b32 v2, s67, v69
  v_mul_f32 v1, s66, v1
  v_mul_f32 v2, s66, v2
  v_cvt_pk_bf16_f32 v69, v1, v2
  v_lshlrev_b32 v1, 16, v70
  v_and_b32 v2, s67, v70
  v_mul_f32 v1, s66, v1
  v_mul_f32 v2, s66, v2
  v_cvt_pk_bf16_f32 v70, v1, v2
  v_lshlrev_b32 v1, 16, v71
  v_and_b32 v2, s67, v71
  v_mul_f32 v1, s66, v1
  v_mul_f32 v2, s66, v2
  v_cvt_pk_bf16_f32 v71, v1, v2
  v_lshlrev_b32 v1, 16, v72
  v_and_b32 v2, s67, v72
  v_mul_f32 v1, s66, v1
  v_mul_f32 v2, s66, v2
  v_cvt_pk_bf16_f32 v72, v1, v2
  v_lshlrev_b32 v1, 16, v73
  v_and_b32 v2, s67, v73
  v_mul_f32 v1, s66, v1
  v_mul_f32 v2, s66, v2
  v_cvt_pk_bf16_f32 v73, v1, v2
  v_lshlrev_b32 v1, 16, v74
  v_and_b32 v2, s67, v74
  v_mul_f32 v1, s66, v1
  v_mul_f32 v2, s66, v2
  v_cvt_pk_bf16_f32 v74, v1, v2
  v_lshlrev_b32 v1, 16, v75
  v_and_b32 v2, s67, v75
  v_mul_f32 v1, s66, v1
  v_mul_f32 v2, s66, v2
  v_cvt_pk_bf16_f32 v75, v1, v2
  v_lshlrev_b32 v1, 16, v76
  v_and_b32 v2, s67, v76
  v_mul_f32 v1, s66, v1
  v_mul_f32 v2, s66, v2
  v_cvt_pk_bf16_f32 v76, v1, v2
  v_lshlrev_b32 v1, 16, v77
  v_and_b32 v2, s67, v77
  v_mul_f32 v1, s66, v1
  v_mul_f32 v2, s66, v2
  v_cvt_pk_bf16_f32 v77, v1, v2
  v_lshlrev_b32 v1, 16, v78
  v_and_b32 v2, s67, v78
  v_mul_f32 v1, s66, v1
  v_mul_f32 v2, s66, v2
  v_cvt_pk_bf16_f32 v78, v1, v2
  v_lshlrev_b32 v1, 16, v79
  v_and_b32 v2, s67, v79
  v_mul_f32 v1, s66, v1
  v_mul_f32 v2, s66, v2
  v_cvt_pk_bf16_f32 v79, v1, v2
  v_lshlrev_b32 v1, 16, v80
  v_and_b32 v2, s67, v80
  v_mul_f32 v1, s66, v1
  v_mul_f32 v2, s66, v2
  v_cvt_pk_bf16_f32 v80, v1, v2
  v_lshlrev_b32 v1, 16, v81
  v_and_b32 v2, s67, v81
  v_mul_f32 v1, s66, v1
  v_mul_f32 v2, s66, v2
  v_cvt_pk_bf16_f32 v81, v1, v2
  v_lshlrev_b32 v1, 16, v82
  v_and_b32 v2, s67, v82
  v_mul_f32 v1, s66, v1
  v_mul_f32 v2, s66, v2
  v_cvt_pk_bf16_f32 v82, v1, v2
  v_lshlrev_b32 v1, 16, v83
  v_and_b32 v2, s67, v83
  v_mul_f32 v1, s66, v1
  v_mul_f32 v2, s66, v2
  v_cvt_pk_bf16_f32 v83, v1, v2
  s_mov_b32 s68, 8320
  buffer_load_dwordx2 v[224:225], v107, s[28:31], s68 offen
  buffer_load_dwordx2 v[226:227], v107, s[28:31], s68 offen offset:1024
  s_mov_b32 s68, 41088
  buffer_load_dwordx2 v[228:229], v107, s[28:31], s68 offen
  buffer_load_dwordx2 v[230:231], v107, s[28:31], s68 offen offset:1024
  s_mov_b32 s68, 10368
  buffer_load_dwordx2 v[232:233], v107, s[28:31], s68 offen
  buffer_load_dwordx2 v[234:235], v107, s[28:31], s68 offen offset:1024
  s_mov_b32 s68, 43136
  buffer_load_dwordx2 v[236:237], v107, s[28:31], s68 offen
  buffer_load_dwordx2 v[238:239], v107, s[28:31], s68 offen offset:1024
  s_waitcnt vmcnt(40) lgkmcnt(0)
  s_barrier
  s_add_u32 m0, s64, 114688
  s_mov_b32 s65, 3670016
  buffer_load_dwordx4 v100, s[24:27], s65 offen lds
  s_add_u32 m0, s64, 115712
  s_mov_b32 s65, 3702784
  buffer_load_dwordx4 v100, s[24:27], s65 offen lds
  s_add_u32 m0, s64, 116736
  s_mov_b32 s65, 3735552
  buffer_load_dwordx4 v101, s[24:27], s65 offen lds
  s_add_u32 m0, s64, 117760
  s_mov_b32 s65, 3768320
  buffer_load_dwordx4 v101, s[24:27], s65 offen lds
  s_cmp_lg_u32 s4, 0
  s_cbranch_scc1 L_c_tr_107
  ds_read_b64_tr_b16 a[128:129], v102 offset:0
  ds_read_b64_tr_b16 a[130:131], v102 offset:1024
  ds_read_b64_tr_b16 a[132:133], v102 offset:8192
  ds_read_b64_tr_b16 a[134:135], v102 offset:9216
  ds_read_b64_tr_b16 a[192:193], v103 offset:0
  ds_read_b64_tr_b16 a[194:195], v103 offset:1024
  ds_read_b64_tr_b16 a[196:197], v103 offset:8192
  ds_read_b64_tr_b16 a[198:199], v103 offset:9216
  s_branch L_c_tr_106
L_c_tr_107:
  s_cmp_lg_u32 s4, 1
  s_cbranch_scc1 L_c_tr_108
  ds_read_b64_tr_b16 a[144:145], v102 offset:0
  ds_read_b64_tr_b16 a[146:147], v102 offset:1024
  ds_read_b64_tr_b16 a[148:149], v102 offset:8192
  ds_read_b64_tr_b16 a[150:151], v102 offset:9216
  ds_read_b64_tr_b16 a[208:209], v103 offset:0
  ds_read_b64_tr_b16 a[210:211], v103 offset:1024
  ds_read_b64_tr_b16 a[212:213], v103 offset:8192
  ds_read_b64_tr_b16 a[214:215], v103 offset:9216
  s_branch L_c_tr_106
L_c_tr_108:
  s_cmp_lg_u32 s4, 2
  s_cbranch_scc1 L_c_tr_109
  ds_read_b64_tr_b16 a[160:161], v102 offset:0
  ds_read_b64_tr_b16 a[162:163], v102 offset:1024
  ds_read_b64_tr_b16 a[164:165], v102 offset:8192
  ds_read_b64_tr_b16 a[166:167], v102 offset:9216
  ds_read_b64_tr_b16 a[224:225], v103 offset:0
  ds_read_b64_tr_b16 a[226:227], v103 offset:1024
  ds_read_b64_tr_b16 a[228:229], v103 offset:8192
  ds_read_b64_tr_b16 a[230:231], v103 offset:9216
  s_branch L_c_tr_106
L_c_tr_109:
  ds_read_b64_tr_b16 a[176:177], v102 offset:0
  ds_read_b64_tr_b16 a[178:179], v102 offset:1024
  ds_read_b64_tr_b16 a[180:181], v102 offset:8192
  ds_read_b64_tr_b16 a[182:183], v102 offset:9216
  ds_read_b64_tr_b16 a[240:241], v103 offset:0
  ds_read_b64_tr_b16 a[242:243], v103 offset:1024
  ds_read_b64_tr_b16 a[244:245], v103 offset:8192
  ds_read_b64_tr_b16 a[246:247], v103 offset:9216
L_c_tr_106:
  v_lshlrev_b32 v1, 16, v84
  v_and_b32 v2, s67, v84
  v_mul_f32 v1, s66, v1
  v_mul_f32 v2, s66, v2
  v_cvt_pk_bf16_f32 v84, v1, v2
  v_lshlrev_b32 v1, 16, v85
  v_and_b32 v2, s67, v85
  v_mul_f32 v1, s66, v1
  v_mul_f32 v2, s66, v2
  v_cvt_pk_bf16_f32 v85, v1, v2
  v_lshlrev_b32 v1, 16, v86
  v_and_b32 v2, s67, v86
  v_mul_f32 v1, s66, v1
  v_mul_f32 v2, s66, v2
  v_cvt_pk_bf16_f32 v86, v1, v2
  v_lshlrev_b32 v1, 16, v87
  v_and_b32 v2, s67, v87
  v_mul_f32 v1, s66, v1
  v_mul_f32 v2, s66, v2
  v_cvt_pk_bf16_f32 v87, v1, v2
  v_lshlrev_b32 v1, 16, v88
  v_and_b32 v2, s67, v88
  v_mul_f32 v1, s66, v1
  v_mul_f32 v2, s66, v2
  v_cvt_pk_bf16_f32 v88, v1, v2
  v_lshlrev_b32 v1, 16, v89
  v_and_b32 v2, s67, v89
  v_mul_f32 v1, s66, v1
  v_mul_f32 v2, s66, v2
  v_cvt_pk_bf16_f32 v89, v1, v2
  v_lshlrev_b32 v1, 16, v90
  v_and_b32 v2, s67, v90
  v_mul_f32 v1, s66, v1
  v_mul_f32 v2, s66, v2
  v_cvt_pk_bf16_f32 v90, v1, v2
  v_lshlrev_b32 v1, 16, v91
  v_and_b32 v2, s67, v91
  v_mul_f32 v1, s66, v1
  v_mul_f32 v2, s66, v2
  v_cvt_pk_bf16_f32 v91, v1, v2
  v_lshlrev_b32 v1, 16, v92
  v_and_b32 v2, s67, v92
  v_mul_f32 v1, s66, v1
  v_mul_f32 v2, s66, v2
  v_cvt_pk_bf16_f32 v92, v1, v2
  v_lshlrev_b32 v1, 16, v93
  v_and_b32 v2, s67, v93
  v_mul_f32 v1, s66, v1
  v_mul_f32 v2, s66, v2
  v_cvt_pk_bf16_f32 v93, v1, v2
  v_lshlrev_b32 v1, 16, v94
  v_and_b32 v2, s67, v94
  v_mul_f32 v1, s66, v1
  v_mul_f32 v2, s66, v2
  v_cvt_pk_bf16_f32 v94, v1, v2
  v_lshlrev_b32 v1, 16, v95
  v_and_b32 v2, s67, v95
  v_mul_f32 v1, s66, v1
  v_mul_f32 v2, s66, v2
  v_cvt_pk_bf16_f32 v95, v1, v2
  v_lshlrev_b32 v1, 16, v96
  v_and_b32 v2, s67, v96
  v_mul_f32 v1, s66, v1
  v_mul_f32 v2, s66, v2
  v_cvt_pk_bf16_f32 v96, v1, v2
  v_lshlrev_b32 v1, 16, v97
  v_and_b32 v2, s67, v97
  v_mul_f32 v1, s66, v1
  v_mul_f32 v2, s66, v2
  v_cvt_pk_bf16_f32 v97, v1, v2
  v_lshlrev_b32 v1, 16, v98
  v_and_b32 v2, s67, v98
  v_mul_f32 v1, s66, v1
  v_mul_f32 v2, s66, v2
  v_cvt_pk_bf16_f32 v98, v1, v2
  v_lshlrev_b32 v1, 16, v99
  v_and_b32 v2, s67, v99
  v_mul_f32 v1, s66, v1
  v_mul_f32 v2, s66, v2
  v_cvt_pk_bf16_f32 v99, v1, v2
  s_mov_b32 s68, 65664
  buffer_load_dwordx2 v[240:241], v107, s[28:31], s68 offen
  buffer_load_dwordx2 v[242:243], v107, s[28:31], s68 offen offset:1024
  s_mov_b32 s68, 98432
  buffer_load_dwordx2 v[244:245], v107, s[28:31], s68 offen
  buffer_load_dwordx2 v[246:247], v107, s[28:31], s68 offen offset:1024
  s_mov_b32 s68, 67712
  buffer_load_dwordx2 v[248:249], v107, s[28:31], s68 offen
  buffer_load_dwordx2 v[250:251], v107, s[28:31], s68 offen offset:1024
  s_mov_b32 s68, 100480
  buffer_load_dwordx2 v[252:253], v107, s[28:31], s68 offen
  buffer_load_dwordx2 v[254:255], v107, s[28:31], s68 offen offset:1024
  s_waitcnt vmcnt(48) lgkmcnt(0)
  s_barrier
  s_cmp_lg_u32 s4, 0
  s_cbranch_scc1 L_c_tr_112
  ds_read_b64_tr_b16 a[136:137], v102 offset:16384
  ds_read_b64_tr_b16 a[138:139], v102 offset:17408
  ds_read_b64_tr_b16 a[140:141], v102 offset:24576
  ds_read_b64_tr_b16 a[142:143], v102 offset:25600
  ds_read_b64_tr_b16 a[200:201], v103 offset:16384
  ds_read_b64_tr_b16 a[202:203], v103 offset:17408
  ds_read_b64_tr_b16 a[204:205], v103 offset:24576
  ds_read_b64_tr_b16 a[206:207], v103 offset:25600
  s_branch L_c_tr_111
L_c_tr_112:
  s_cmp_lg_u32 s4, 1
  s_cbranch_scc1 L_c_tr_113
  ds_read_b64_tr_b16 a[152:153], v102 offset:16384
  ds_read_b64_tr_b16 a[154:155], v102 offset:17408
  ds_read_b64_tr_b16 a[156:157], v102 offset:24576
  ds_read_b64_tr_b16 a[158:159], v102 offset:25600
  ds_read_b64_tr_b16 a[216:217], v103 offset:16384
  ds_read_b64_tr_b16 a[218:219], v103 offset:17408
  ds_read_b64_tr_b16 a[220:221], v103 offset:24576
  ds_read_b64_tr_b16 a[222:223], v103 offset:25600
  s_branch L_c_tr_111
L_c_tr_113:
  s_cmp_lg_u32 s4, 2
  s_cbranch_scc1 L_c_tr_114
  ds_read_b64_tr_b16 a[168:169], v102 offset:16384
  ds_read_b64_tr_b16 a[170:171], v102 offset:17408
  ds_read_b64_tr_b16 a[172:173], v102 offset:24576
  ds_read_b64_tr_b16 a[174:175], v102 offset:25600
  ds_read_b64_tr_b16 a[232:233], v103 offset:16384
  ds_read_b64_tr_b16 a[234:235], v103 offset:17408
  ds_read_b64_tr_b16 a[236:237], v103 offset:24576
  ds_read_b64_tr_b16 a[238:239], v103 offset:25600
  s_branch L_c_tr_111
L_c_tr_114:
  ds_read_b64_tr_b16 a[184:185], v102 offset:16384
  ds_read_b64_tr_b16 a[186:187], v102 offset:17408
  ds_read_b64_tr_b16 a[188:189], v102 offset:24576
  ds_read_b64_tr_b16 a[190:191], v102 offset:25600
  ds_read_b64_tr_b16 a[248:249], v103 offset:16384
  ds_read_b64_tr_b16 a[250:251], v103 offset:17408
  ds_read_b64_tr_b16 a[252:253], v103 offset:24576
  ds_read_b64_tr_b16 a[254:255], v103 offset:25600
L_c_tr_111:
  ds_write_b128 v9, v[52:55] offset:0
  ds_write_b128 v9, v[56:59] offset:1024
  ds_write_b128 v9, v[60:63] offset:2048
  ds_write_b128 v9, v[64:67] offset:3072
  s_mov_b32 s68, 0
  buffer_load_dwordx2 v[20:21], v107, s[28:31], s68 offen
  buffer_load_dwordx2 v[22:23], v107, s[28:31], s68 offen offset:1024
  s_mov_b32 s68, 32768
  buffer_load_dwordx2 v[24:25], v107, s[28:31], s68 offen
  buffer_load_dwordx2 v[26:27], v107, s[28:31], s68 offen offset:1024
  s_mov_b32 s68, 2048
  buffer_load_dwordx2 v[28:29], v107, s[28:31], s68 offen
  buffer_load_dwordx2 v[30:31], v107, s[28:31], s68 offen offset:1024
  s_mov_b32 s68, 34816
  buffer_load_dwordx2 v[32:33], v107, s[28:31], s68 offen
  buffer_load_dwordx2 v[34:35], v107, s[28:31], s68 offen offset:1024
  s_waitcnt vmcnt(52) lgkmcnt(0)
  s_barrier
  s_cmp_lg_u32 s4, 0
  s_cbranch_scc1 L_c_tr_117
  ds_read_b64_tr_b16 a[144:145], v102 offset:32768
  ds_read_b64_tr_b16 a[146:147], v102 offset:33792
  ds_read_b64_tr_b16 a[148:149], v102 offset:40960
  ds_read_b64_tr_b16 a[150:151], v102 offset:41984
  ds_read_b64_tr_b16 a[208:209], v103 offset:32768
  ds_read_b64_tr_b16 a[210:211], v103 offset:33792
  ds_read_b64_tr_b16 a[212:213], v103 offset:40960
  ds_read_b64_tr_b16 a[214:215], v103 offset:41984
  s_branch L_c_tr_116
L_c_tr_117:
  s_cmp_lg_u32 s4, 1
  s_cbranch_scc1 L_c_tr_118
  ds_read_b64_tr_b16 a[128:129], v102 offset:32768
  ds_read_b64_tr_b16 a[130:131], v102 offset:33792
  ds_read_b64_tr_b16 a[132:133], v102 offset:40960
  ds_read_b64_tr_b16 a[134:135], v102 offset:41984
  ds_read_b64_tr_b16 a[192:193], v103 offset:32768
  ds_read_b64_tr_b16 a[194:195], v103 offset:33792
  ds_read_b64_tr_b16 a[196:197], v103 offset:40960
  ds_read_b64_tr_b16 a[198:199], v103 offset:41984
  s_branch L_c_tr_116
L_c_tr_118:
  s_cmp_lg_u32 s4, 2
  s_cbranch_scc1 L_c_tr_119
  ds_read_b64_tr_b16 a[176:177], v102 offset:32768
  ds_read_b64_tr_b16 a[178:179], v102 offset:33792
  ds_read_b64_tr_b16 a[180:181], v102 offset:40960
  ds_read_b64_tr_b16 a[182:183], v102 offset:41984
  ds_read_b64_tr_b16 a[240:241], v103 offset:32768
  ds_read_b64_tr_b16 a[242:243], v103 offset:33792
  ds_read_b64_tr_b16 a[244:245], v103 offset:40960
  ds_read_b64_tr_b16 a[246:247], v103 offset:41984
  s_branch L_c_tr_116
L_c_tr_119:
  ds_read_b64_tr_b16 a[160:161], v102 offset:32768
  ds_read_b64_tr_b16 a[162:163], v102 offset:33792
  ds_read_b64_tr_b16 a[164:165], v102 offset:40960
  ds_read_b64_tr_b16 a[166:167], v102 offset:41984
  ds_read_b64_tr_b16 a[224:225], v103 offset:32768
  ds_read_b64_tr_b16 a[226:227], v103 offset:33792
  ds_read_b64_tr_b16 a[228:229], v103 offset:40960
  ds_read_b64_tr_b16 a[230:231], v103 offset:41984
L_c_tr_116:
  ds_write_b128 v9, v[68:71] offset:16384
  ds_write_b128 v9, v[72:75] offset:17408
  ds_write_b128 v9, v[76:79] offset:18432
  ds_write_b128 v9, v[80:83] offset:19456
  s_mov_b32 s68, 8192
  buffer_load_dwordx2 v[36:37], v107, s[28:31], s68 offen
  buffer_load_dwordx2 v[38:39], v107, s[28:31], s68 offen offset:1024
  s_mov_b32 s68, 40960
  buffer_load_dwordx2 v[40:41], v107, s[28:31], s68 offen
  buffer_load_dwordx2 v[42:43], v107, s[28:31], s68 offen offset:1024
  s_mov_b32 s68, 10240
  buffer_load_dwordx2 v[44:45], v107, s[28:31], s68 offen
  buffer_load_dwordx2 v[46:47], v107, s[28:31], s68 offen offset:1024
  s_mov_b32 s68, 43008
  buffer_load_dwordx2 v[48:49], v107, s[28:31], s68 offen
  buffer_load_dwordx2 v[50:51], v107, s[28:31], s68 offen offset:1024
  s_lshr_b32 s57, s4, 1
  s_lshl_b32 s57, s57, 24
  s_lshl_b32 s88, s6, 13
  s_add_u32 s88, s88, s57
  s_and_b32 s57, s4, 1
  s_lshl_b32 s57, s57, 12
  s_add_u32 s88, s88, s57
  s_add_u32 s88, s88, 33554432
  s_waitcnt vmcnt(56) lgkmcnt(0)
  s_barrier
  s_cmp_lg_u32 s4, 0
  s_cbranch_scc1 L_c_tr_122
  ds_read_b64_tr_b16 a[152:153], v102 offset:49152
  ds_read_b64_tr_b16 a[154:155], v102 offset:50176
  ds_read_b64_tr_b16 a[156:157], v102 offset:57344
  ds_read_b64_tr_b16 a[158:159], v102 offset:58368
  ds_read_b64_tr_b16 a[216:217], v103 offset:49152
  ds_read_b64_tr_b16 a[218:219], v103 offset:50176
  ds_read_b64_tr_b16 a[220:221], v103 offset:57344
  ds_read_b64_tr_b16 a[222:223], v103 offset:58368
  s_branch L_c_tr_121
L_c_tr_122:
  s_cmp_lg_u32 s4, 1
  s_cbranch_scc1 L_c_tr_123
  ds_read_b64_tr_b16 a[136:137], v102 offset:49152
  ds_read_b64_tr_b16 a[138:139], v102 offset:50176
  ds_read_b64_tr_b16 a[140:141], v102 offset:57344
  ds_read_b64_tr_b16 a[142:143], v102 offset:58368
  ds_read_b64_tr_b16 a[200:201], v103 offset:49152
  ds_read_b64_tr_b16 a[202:203], v103 offset:50176
  ds_read_b64_tr_b16 a[204:205], v103 offset:57344
  ds_read_b64_tr_b16 a[206:207], v103 offset:58368
  s_branch L_c_tr_121
L_c_tr_123:
  s_cmp_lg_u32 s4, 2
  s_cbranch_scc1 L_c_tr_124
  ds_read_b64_tr_b16 a[184:185], v102 offset:49152
  ds_read_b64_tr_b16 a[186:187], v102 offset:50176
  ds_read_b64_tr_b16 a[188:189], v102 offset:57344
  ds_read_b64_tr_b16 a[190:191], v102 offset:58368
  ds_read_b64_tr_b16 a[248:249], v103 offset:49152
  ds_read_b64_tr_b16 a[250:251], v103 offset:50176
  ds_read_b64_tr_b16 a[252:253], v103 offset:57344
  ds_read_b64_tr_b16 a[254:255], v103 offset:58368
  s_branch L_c_tr_121
L_c_tr_124:
  ds_read_b64_tr_b16 a[168:169], v102 offset:49152
  ds_read_b64_tr_b16 a[170:171], v102 offset:50176
  ds_read_b64_tr_b16 a[172:173], v102 offset:57344
  ds_read_b64_tr_b16 a[174:175], v102 offset:58368
  ds_read_b64_tr_b16 a[232:233], v103 offset:49152
  ds_read_b64_tr_b16 a[234:235], v103 offset:50176
  ds_read_b64_tr_b16 a[236:237], v103 offset:57344
  ds_read_b64_tr_b16 a[238:239], v103 offset:58368
L_c_tr_121:
  ds_write_b128 v9, v[84:87] offset:32768
  ds_write_b128 v9, v[88:91] offset:33792
  ds_write_b128 v9, v[92:95] offset:34816
  ds_write_b128 v9, v[96:99] offset:35840
  s_mov_b32 s68, 65536
  buffer_load_dwordx2 v[108:109], v107, s[28:31], s68 offen
  buffer_load_dwordx2 v[110:111], v107, s[28:31], s68 offen offset:1024
  s_mov_b32 s68, 98304
  buffer_load_dwordx2 v[112:113], v107, s[28:31], s68 offen
  buffer_load_dwordx2 v[114:115], v107, s[28:31], s68 offen offset:1024
  s_mov_b32 s68, 67584
  buffer_load_dwordx2 v[116:117], v107, s[28:31], s68 offen
  buffer_load_dwordx2 v[118:119], v107, s[28:31], s68 offen offset:1024
  s_mov_b32 s68, 100352
  buffer_load_dwordx2 v[120:121], v107, s[28:31], s68 offen
  buffer_load_dwordx2 v[122:123], v107, s[28:31], s68 offen offset:1024
  s_waitcnt vmcnt(60) lgkmcnt(0)
  s_barrier
  s_cmp_lg_u32 s4, 0
  s_cbranch_scc1 L_c_tr_127
  ds_read_b64_tr_b16 a[160:161], v104 offset:0
  ds_read_b64_tr_b16 a[162:163], v104 offset:1024
  ds_read_b64_tr_b16 a[164:165], v104 offset:8192
  ds_read_b64_tr_b16 a[166:167], v104 offset:9216
  ds_read_b64_tr_b16 a[224:225], v105 offset:0
  ds_read_b64_tr_b16 a[226:227], v105 offset:1024
  ds_read_b64_tr_b16 a[228:229], v105 offset:8192
  ds_read_b64_tr_b16 a[230:231], v105 offset:9216
  s_branch L_c_tr_126
L_c_tr_127:
  s_cmp_lg_u32 s4, 1
  s_cbranch_scc1 L_c_tr_128
  ds_read_b64_tr_b16 a[176:177], v104 offset:0
  ds_read_b64_tr_b16 a[178:179], v104 offset:1024
  ds_read_b64_tr_b16 a[180:181], v104 offset:8192
  ds_read_b64_tr_b16 a[182:183], v104 offset:9216
  ds_read_b64_tr_b16 a[240:241], v105 offset:0
  ds_read_b64_tr_b16 a[242:243], v105 offset:1024
  ds_read_b64_tr_b16 a[244:245], v105 offset:8192
  ds_read_b64_tr_b16 a[246:247], v105 offset:9216
  s_branch L_c_tr_126
L_c_tr_128:
  s_cmp_lg_u32 s4, 2
  s_cbranch_scc1 L_c_tr_129
  ds_read_b64_tr_b16 a[128:129], v104 offset:0
  ds_read_b64_tr_b16 a[130:131], v104 offset:1024
  ds_read_b64_tr_b16 a[132:133], v104 offset:8192
  ds_read_b64_tr_b16 a[134:135], v104 offset:9216
  ds_read_b64_tr_b16 a[192:193], v105 offset:0
  ds_read_b64_tr_b16 a[194:195], v105 offset:1024
  ds_read_b64_tr_b16 a[196:197], v105 offset:8192
  ds_read_b64_tr_b16 a[198:199], v105 offset:9216
  s_branch L_c_tr_126
L_c_tr_129:
  ds_read_b64_tr_b16 a[144:145], v104 offset:0
  ds_read_b64_tr_b16 a[146:147], v104 offset:1024
  ds_read_b64_tr_b16 a[148:149], v104 offset:8192
  ds_read_b64_tr_b16 a[150:151], v104 offset:9216
  ds_read_b64_tr_b16 a[208:209], v105 offset:0
  ds_read_b64_tr_b16 a[210:211], v105 offset:1024
  ds_read_b64_tr_b16 a[212:213], v105 offset:8192
  ds_read_b64_tr_b16 a[214:215], v105 offset:9216
L_c_tr_126:
  s_mov_b32 s68, 73728
  buffer_load_dwordx2 v[52:53], v107, s[28:31], s68 offen
  buffer_load_dwordx2 v[54:55], v107, s[28:31], s68 offen offset:1024
  s_mov_b32 s68, 106496
  buffer_load_dwordx2 v[56:57], v107, s[28:31], s68 offen
  buffer_load_dwordx2 v[58:59], v107, s[28:31], s68 offen offset:1024
  s_mov_b32 s68, 75776
  buffer_load_dwordx2 v[60:61], v107, s[28:31], s68 offen
  buffer_load_dwordx2 v[62:63], v107, s[28:31], s68 offen offset:1024
  s_mov_b32 s68, 108544
  buffer_load_dwordx2 v[64:65], v107, s[28:31], s68 offen
  buffer_load_dwordx2 v[66:67], v107, s[28:31], s68 offen offset:1024
  s_mov_b32 s61, 0x05040100
  s_mov_b32 s62, 0x07060302
  s_waitcnt vmcnt(56)
  v_perm_b32 v84, v210, v208, s61
  v_perm_b32 v85, v214, v212, s61
  v_perm_b32 v86, v218, v216, s61
  v_perm_b32 v87, v222, v220, s61
  ds_write_b128 v9, v[84:87] offset:49152
  v_perm_b32 v88, v210, v208, s62
  v_perm_b32 v89, v214, v212, s62
  v_perm_b32 v90, v218, v216, s62
  v_perm_b32 v91, v222, v220, s62
  ds_write_b128 v9, v[88:91] offset:50176
  v_perm_b32 v92, v211, v209, s61
  v_perm_b32 v93, v215, v213, s61
  v_perm_b32 v94, v219, v217, s61
  v_perm_b32 v95, v223, v221, s61
  ds_write_b128 v9, v[92:95] offset:51200
  v_perm_b32 v96, v211, v209, s62
  v_perm_b32 v97, v215, v213, s62
  v_perm_b32 v98, v219, v217, s62
  v_perm_b32 v99, v223, v221, s62
  ds_write_b128 v9, v[96:99] offset:52224
  s_waitcnt lgkmcnt(0)
  s_waitcnt vmcnt(63) lgkmcnt(0)
  s_barrier
  s_cmp_lg_u32 s4, 0
  s_cbranch_scc1 L_c_tr_132
  ds_read_b64_tr_b16 a[168:169], v104 offset:16384
  ds_read_b64_tr_b16 a[170:171], v104 offset:17408
  ds_read_b64_tr_b16 a[172:173], v104 offset:24576
  ds_read_b64_tr_b16 a[174:175], v104 offset:25600
  ds_read_b64_tr_b16 a[232:233], v105 offset:16384
  ds_read_b64_tr_b16 a[234:235], v105 offset:17408
  ds_read_b64_tr_b16 a[236:237], v105 offset:24576
  ds_read_b64_tr_b16 a[238:239], v105 offset:25600
  s_branch L_c_tr_131
L_c_tr_132:
  s_cmp_lg_u32 s4, 1
  s_cbranch_scc1 L_c_tr_133
  ds_read_b64_tr_b16 a[184:185], v104 offset:16384
  ds_read_b64_tr_b16 a[186:187], v104 offset:17408
  ds_read_b64_tr_b16 a[188:189], v104 offset:24576
  ds_read_b64_tr_b16 a[190:191], v104 offset:25600
  ds_read_b64_tr_b16 a[248:249], v105 offset:16384
  ds_read_b64_tr_b16 a[250:251], v105 offset:17408
  ds_read_b64_tr_b16 a[252:253], v105 offset:24576
  ds_read_b64_tr_b16 a[254:255], v105 offset:25600
  s_branch L_c_tr_131
L_c_tr_133:
  s_cmp_lg_u32 s4, 2
  s_cbranch_scc1 L_c_tr_134
  ds_read_b64_tr_b16 a[136:137], v104 offset:16384
  ds_read_b64_tr_b16 a[138:139], v104 offset:17408
  ds_read_b64_tr_b16 a[140:141], v104 offset:24576
  ds_read_b64_tr_b16 a[142:143], v104 offset:25600
  ds_read_b64_tr_b16 a[200:201], v105 offset:16384
  ds_read_b64_tr_b16 a[202:203], v105 offset:17408
  ds_read_b64_tr_b16 a[204:205], v105 offset:24576
  ds_read_b64_tr_b16 a[206:207], v105 offset:25600
  s_branch L_c_tr_131
L_c_tr_134:
  ds_read_b64_tr_b16 a[152:153], v104 offset:16384
  ds_read_b64_tr_b16 a[154:155], v104 offset:17408
  ds_read_b64_tr_b16 a[156:157], v104 offset:24576
  ds_read_b64_tr_b16 a[158:159], v104 offset:25600
  ds_read_b64_tr_b16 a[216:217], v105 offset:16384
  ds_read_b64_tr_b16 a[218:219], v105 offset:17408
  ds_read_b64_tr_b16 a[220:221], v105 offset:24576
  ds_read_b64_tr_b16 a[222:223], v105 offset:25600
L_c_tr_131:
  s_mov_b32 s68, 73856
  buffer_load_dwordx2 v[68:69], v107, s[28:31], s68 offen
  buffer_load_dwordx2 v[70:71], v107, s[28:31], s68 offen offset:1024
  s_mov_b32 s68, 106624
  buffer_load_dwordx2 v[72:73], v107, s[28:31], s68 offen
  buffer_load_dwordx2 v[74:75], v107, s[28:31], s68 offen offset:1024
  s_mov_b32 s68, 75904
  buffer_load_dwordx2 v[76:77], v107, s[28:31], s68 offen
  buffer_load_dwordx2 v[78:79], v107, s[28:31], s68 offen offset:1024
  s_mov_b32 s68, 108672
  buffer_load_dwordx2 v[80:81], v107, s[28:31], s68 offen
  buffer_load_dwordx2 v[82:83], v107, s[28:31], s68 offen offset:1024
  s_waitcnt vmcnt(52)
  v_perm_b32 v84, v226, v224, s61
  v_perm_b32 v85, v230, v228, s61
  v_perm_b32 v86, v234, v232, s61
  v_perm_b32 v87, v238, v236, s61
  ds_write_b128 v0, v[84:87] offset:0
  v_perm_b32 v88, v226, v224, s62
  v_perm_b32 v89, v230, v228, s62
  v_perm_b32 v90, v234, v232, s62
  v_perm_b32 v91, v238, v236, s62
  ds_write_b128 v0, v[88:91] offset:1024
  v_perm_b32 v92, v227, v225, s61
  v_perm_b32 v93, v231, v229, s61
  v_perm_b32 v94, v235, v233, s61
  v_perm_b32 v95, v239, v237, s61
  ds_write_b128 v0, v[92:95] offset:2048
  v_perm_b32 v96, v227, v225, s62
  v_perm_b32 v97, v231, v229, s62
  v_perm_b32 v98, v235, v233, s62
  v_perm_b32 v99, v239, v237, s62
  ds_write_b128 v0, v[96:99] offset:3072
  s_waitcnt lgkmcnt(0)
  s_waitcnt vmcnt(60) lgkmcnt(0)
  s_barrier
  s_cmp_lg_u32 s4, 0
  s_cbranch_scc1 L_c_tr_137
  ds_read_b64_tr_b16 a[176:177], v104 offset:32768
  ds_read_b64_tr_b16 a[178:179], v104 offset:33792
  ds_read_b64_tr_b16 a[180:181], v104 offset:40960
  ds_read_b64_tr_b16 a[182:183], v104 offset:41984
  ds_read_b64_tr_b16 a[240:241], v105 offset:32768
  ds_read_b64_tr_b16 a[242:243], v105 offset:33792
  ds_read_b64_tr_b16 a[244:245], v105 offset:40960
  ds_read_b64_tr_b16 a[246:247], v105 offset:41984
  s_branch L_c_tr_136
L_c_tr_137:
  s_cmp_lg_u32 s4, 1
  s_cbranch_scc1 L_c_tr_138
  ds_read_b64_tr_b16 a[160:161], v104 offset:32768
  ds_read_b64_tr_b16 a[162:163], v104 offset:33792
  ds_read_b64_tr_b16 a[164:165], v104 offset:40960
  ds_read_b64_tr_b16 a[166:167], v104 offset:41984
  ds_read_b64_tr_b16 a[224:225], v105 offset:32768
  ds_read_b64_tr_b16 a[226:227], v105 offset:33792
  ds_read_b64_tr_b16 a[228:229], v105 offset:40960
  ds_read_b64_tr_b16 a[230:231], v105 offset:41984
  s_branch L_c_tr_136
L_c_tr_138:
  s_cmp_lg_u32 s4, 2
  s_cbranch_scc1 L_c_tr_139
  ds_read_b64_tr_b16 a[144:145], v104 offset:32768
  ds_read_b64_tr_b16 a[146:147], v104 offset:33792
  ds_read_b64_tr_b16 a[148:149], v104 offset:40960
  ds_read_b64_tr_b16 a[150:151], v104 offset:41984
  ds_read_b64_tr_b16 a[208:209], v105 offset:32768
  ds_read_b64_tr_b16 a[210:211], v105 offset:33792
  ds_read_b64_tr_b16 a[212:213], v105 offset:40960
  ds_read_b64_tr_b16 a[214:215], v105 offset:41984
  s_branch L_c_tr_136
L_c_tr_139:
  ds_read_b64_tr_b16 a[128:129], v104 offset:32768
  ds_read_b64_tr_b16 a[130:131], v104 offset:33792
  ds_read_b64_tr_b16 a[132:133], v104 offset:40960
  ds_read_b64_tr_b16 a[134:135], v104 offset:41984
  ds_read_b64_tr_b16 a[192:193], v105 offset:32768
  ds_read_b64_tr_b16 a[194:195], v105 offset:33792
  ds_read_b64_tr_b16 a[196:197], v105 offset:40960
  ds_read_b64_tr_b16 a[198:199], v105 offset:41984
L_c_tr_136:
  v_readfirstlane_b32 s57, v3
  v_mov_b32 v2, 0
  s_cmp_eq_u32 s57, 0
  s_cbranch_scc1 L_c_nf
  v_mbcnt_lo_u32_b32 v1, -1, 0
  v_and_b32 v1, 1, v1
  v_lshlrev_b32 v1, 12, v1
  s_lshl_b32 s74, s6, 7
  buffer_load_dword v2, v1, s[52:55], s74 offen sc1
  buffer_load_dword v17, off, s[48:51], 0 offset:32 sc1
L_c_nf:
  s_waitcnt vmcnt(40)
  v_perm_b32 v84, v242, v240, s61
  v_perm_b32 v85, v246, v244, s61
  v_perm_b32 v86, v250, v248, s61
  v_perm_b32 v87, v254, v252, s61
  ds_write_b128 v0, v[84:87] offset:16384
  v_perm_b32 v88, v242, v240, s62
  v_perm_b32 v89, v246, v244, s62
  v_perm_b32 v90, v250, v248, s62
  v_perm_b32 v91, v254, v252, s62
  ds_write_b128 v0, v[88:91] offset:17408
  v_perm_b32 v92, v243, v241, s61
  v_perm_b32 v93, v247, v245, s61
  v_perm_b32 v94, v251, v249, s61
  v_perm_b32 v95, v255, v253, s61
  ds_write_b128 v0, v[92:95] offset:18432
  v_perm_b32 v96, v243, v241, s62
  v_perm_b32 v97, v247, v245, s62
  v_perm_b32 v98, v251, v249, s62
  v_perm_b32 v99, v255, v253, s62
  ds_write_b128 v0, v[96:99] offset:19456
  s_waitcnt lgkmcnt(0)
  s_waitcnt vmcnt(48) lgkmcnt(0)
  s_barrier
  s_cmp_lg_u32 s4, 0
  s_cbranch_scc1 L_c_tr_142
  ds_read_b64_tr_b16 a[184:185], v104 offset:49152
  ds_read_b64_tr_b16 a[186:187], v104 offset:50176
  ds_read_b64_tr_b16 a[188:189], v104 offset:57344
  ds_read_b64_tr_b16 a[190:191], v104 offset:58368
  ds_read_b64_tr_b16 a[248:249], v105 offset:49152
  ds_read_b64_tr_b16 a[250:251], v105 offset:50176
  ds_read_b64_tr_b16 a[252:253], v105 offset:57344
  ds_read_b64_tr_b16 a[254:255], v105 offset:58368
  s_branch L_c_tr_141
L_c_tr_142:
  s_cmp_lg_u32 s4, 1
  s_cbranch_scc1 L_c_tr_143
  ds_read_b64_tr_b16 a[168:169], v104 offset:49152
  ds_read_b64_tr_b16 a[170:171], v104 offset:50176
  ds_read_b64_tr_b16 a[172:173], v104 offset:57344
  ds_read_b64_tr_b16 a[174:175], v104 offset:58368
  ds_read_b64_tr_b16 a[232:233], v105 offset:49152
  ds_read_b64_tr_b16 a[234:235], v105 offset:50176
  ds_read_b64_tr_b16 a[236:237], v105 offset:57344
  ds_read_b64_tr_b16 a[238:239], v105 offset:58368
  s_branch L_c_tr_141
L_c_tr_143:
  s_cmp_lg_u32 s4, 2
  s_cbranch_scc1 L_c_tr_144
  ds_read_b64_tr_b16 a[152:153], v104 offset:49152
  ds_read_b64_tr_b16 a[154:155], v104 offset:50176
  ds_read_b64_tr_b16 a[156:157], v104 offset:57344
  ds_read_b64_tr_b16 a[158:159], v104 offset:58368
  ds_read_b64_tr_b16 a[216:217], v105 offset:49152
  ds_read_b64_tr_b16 a[218:219], v105 offset:50176
  ds_read_b64_tr_b16 a[220:221], v105 offset:57344
  ds_read_b64_tr_b16 a[222:223], v105 offset:58368
  s_branch L_c_tr_141
L_c_tr_144:
  ds_read_b64_tr_b16 a[136:137], v104 offset:49152
  ds_read_b64_tr_b16 a[138:139], v104 offset:50176
  ds_read_b64_tr_b16 a[140:141], v104 offset:57344
  ds_read_b64_tr_b16 a[142:143], v104 offset:58368
  ds_read_b64_tr_b16 a[200:201], v105 offset:49152
  ds_read_b64_tr_b16 a[202:203], v105 offset:50176
  ds_read_b64_tr_b16 a[204:205], v105 offset:57344
  ds_read_b64_tr_b16 a[206:207], v105 offset:58368
L_c_tr_141:
  s_waitcnt vmcnt(32)
  v_perm_b32 v208, v22, v20, s61
  v_perm_b32 v209, v26, v24, s61
  v_perm_b32 v210, v30, v28, s61
  v_perm_b32 v211, v34, v32, s61
  v_perm_b32 v224, v22, v20, s62
  v_perm_b32 v225, v26, v24, s62
  v_perm_b32 v226, v30, v28, s62
  v_perm_b32 v227, v34, v32, s62
  v_perm_b32 v240, v23, v21, s61
  v_perm_b32 v241, v27, v25, s61
  v_perm_b32 v242, v31, v29, s61
  v_perm_b32 v243, v35, v33, s61
  v_perm_b32 v96, v23, v21, s62
  v_perm_b32 v97, v27, v25, s62
  v_perm_b32 v98, v31, v29, s62
  v_perm_b32 v99, v35, v33, s62
  ds_write_b128 v0, v[96:99] offset:32768
  s_waitcnt lgkmcnt(0)
  s_waitcnt vmcnt(24)
  v_perm_b32 v212, v38, v36, s61
  v_perm_b32 v213, v42, v40, s61
  v_perm_b32 v214, v46, v44, s61
  v_perm_b32 v215, v50, v48, s61
  v_perm_b32 v228, v38, v36, s62
  v_perm_b32 v229, v42, v40, s62
  v_perm_b32 v230, v46, v44, s62
  v_perm_b32 v231, v50, v48, s62
  v_perm_b32 v244, v39, v37, s61
  v_perm_b32 v245, v43, v41, s61
  v_perm_b32 v246, v47, v45, s61
  v_perm_b32 v247, v51, v49, s61
  v_perm_b32 v96, v39, v37, s62
  v_perm_b32 v97, v43, v41, s62
  v_perm_b32 v98, v47, v45, s62
  v_perm_b32 v99, v51, v49, s62
  ds_write_b128 v0, v[96:99] offset:33792
  s_waitcnt lgkmcnt(0)
  s_waitcnt vmcnt(16)
  v_perm_b32 v216, v110, v108, s61
  v_perm_b32 v217, v114, v112, s61
  v_perm_b32 v218, v118, v116, s61
  v_perm_b32 v219, v122, v120, s61
  v_perm_b32 v232, v110, v108, s62
  v_perm_b32 v233, v114, v112, s62
  v_perm_b32 v234, v118, v116, s62
  v_perm_b32 v235, v122, v120, s62
  v_perm_b32 v248, v111, v109, s61
  v_perm_b32 v249, v115, v113, s61
  v_perm_b32 v250, v119, v117, s61
  v_perm_b32 v251, v123, v121, s61
  v_perm_b32 v96, v111, v109, s62
  v_perm_b32 v97, v115, v113, s62
  v_perm_b32 v98, v119, v117, s62
  v_perm_b32 v99, v123, v121, s62
  ds_write_b128 v0, v[96:99] offset:34816
  s_waitcnt lgkmcnt(0)
  s_waitcnt vmcnt(8)
  v_perm_b32 v220, v54, v52, s61
  v_perm_b32 v221, v58, v56, s61
  v_perm_b32 v222, v62, v60, s61
  v_perm_b32 v223, v66, v64, s61
  v_perm_b32 v236, v54, v52, s62
  v_perm_b32 v237, v58, v56, s62
  v_perm_b32 v238, v62, v60, s62
  v_perm_b32 v239, v66, v64, s62
  v_perm_b32 v252, v55, v53, s61
  v_perm_b32 v253, v59, v57, s61
  v_perm_b32 v254, v63, v61, s61
  v_perm_b32 v255, v67, v65, s61
  v_perm_b32 v96, v55, v53, s62
  v_perm_b32 v97, v59, v57, s62
  v_perm_b32 v98, v63, v61, s62
  v_perm_b32 v99, v67, v65, s62
  ds_write_b128 v0, v[96:99] offset:35840
  s_waitcnt lgkmcnt(0)
  s_waitcnt vmcnt(0) lgkmcnt(0)
  s_barrier
  v_perm_b32 v84, v70, v68, s61
  v_perm_b32 v85, v74, v72, s61
  v_perm_b32 v86, v78, v76, s61
  v_perm_b32 v87, v82, v80, s61
  ds_write_b128 v0, v[84:87] offset:49152
  v_perm_b32 v88, v70, v68, s62
  v_perm_b32 v89, v74, v72, s62
  v_perm_b32 v90, v78, v76, s62
  v_perm_b32 v91, v82, v80, s62
  ds_write_b128 v0, v[88:91] offset:50176
  v_perm_b32 v92, v71, v69, s61
  v_perm_b32 v93, v75, v73, s61
  v_perm_b32 v94, v79, v77, s61
  v_perm_b32 v95, v83, v81, s61
  ds_write_b128 v0, v[92:95] offset:51200
  v_perm_b32 v96, v71, v69, s62
  v_perm_b32 v97, v75, v73, s62
  v_perm_b32 v98, v79, v77, s62
  v_perm_b32 v99, v83, v81, s62
  ds_write_b128 v0, v[96:99] offset:52224
  s_waitcnt lgkmcnt(0)
  v_readfirstlane_b32 s57, v3
  s_nop 0
  s_cmp_lg_u32 s57, 0
  s_cbranch_scc1 L_c_f1
L_wd_146:
  s_sub_u32 s56, s56, 1
  s_cbranch_scc1 L_timeout
  s_mov_b64 exec, 1
  buffer_load_dword v1, off, s[48:51], 0 offset:228 sc1
  s_mov_b64 exec, -1
  s_waitcnt vmcnt(0)
  v_readfirstlane_b32 s57, v1
  s_nop 0
  s_cmp_ge_u32 s57, 1
  s_cbranch_scc1 L_wd_147
  s_sleep 8
  s_branch L_wd_146
L_wd_147:
  v_mbcnt_lo_u32_b32 v1, -1, 0
  v_and_b32 v1, 1, v1
  v_lshlrev_b32 v1, 12, v1
  s_lshl_b32 s74, s6, 7
L_c_f0:
  s_sub_u32 s56, s56, 1
  s_cbranch_scc1 L_timeout
  buffer_load_dword v2, v1, s[52:55], s74 offen sc1
  buffer_load_dword v17, off, s[48:51], 0 offset:32 sc1
  s_waitcnt vmcnt(0)
L_c_f1:
  v_cmp_gt_u32 vcc, 2, v2
  v_readfirstlane_b32 s57, v17
  s_cbranch_vccnz L_c_f0
  s_and_b32 s58, s57, 0xffff
  s_cmp_lt_u32 s58, 32
  s_cbranch_scc1 L_c_f0
  s_lshr_b32 s57, s57, 16
  s_cmp_lg_u32 s57, 0
  s_cbranch_scc1 L_c_start_s
L_c_start_f:
  s_add_u32 s84, s52, 262144
  s_addc_u32 s85, s53, 0x40000
  s_mov_b32 s86, 0x4000000
  s_mov_b32 s87, 0x20000
  s_mov_b32 s70, 0
  s_mov_b32 s71, 1572864
  s_mov_b32 s72, 1589248
  s_mov_b32 s58, 1597440
  s_mov_b32 s73, 1
  s_lshl_b32 s74, s6, 7
  s_mov_b32 s75, 0
  s_mov_b32 s79, 0x3e0293ee
  s_lshl_b32 s60, s6, 13
  s_add_u32 s60, s60, 33554432
  s_mov_b32 s61, s88
  s_mov_b32 s62, 2097152
  s_mov_b32 s63, 0x3f803f80
  s_mov_b32 s64, 32768
  s_mov_b32 s65, 2048
  s_mov_b32 s66, 4096
  s_mov_b32 s67, 6144
  s_mov_b32 s68, 8192
  s_mov_b32 s78, 262144
  s_mov_b32 s98, 0x3f803f80
  s_mov_b32 s99, 0x3f803f80
  s_mov_b32 s96, 0x30800000
  s_mov_b32 s97, 0x1e000000
  s_mov_b32 s100, 0
  s_mov_b32 s75, 1
  s_add_u32 s74, s74, 4096
  v_mov_b32 v17, 0
  s_mov_b32 m0, s69
  s_nop 0
  buffer_load_dwordx4 v8, s[52:55], s61 offen offset:0 sc1 lds
  buffer_load_dwordx4 v8, s[52:55], s61 offen offset:1024 sc1 lds
  buffer_load_dwordx4 v8, s[52:55], s61 offen offset:2048 sc1 lds
  buffer_load_dwordx4 v8, s[52:55], s61 offen offset:3072 sc1 lds
  s_add_u32 s60, s60, s78
  s_add_u32 s61, s61, s78
  ds_read_b128 v[52:55], v9 offset:0
  ds_read_b128 v[56:59], v9 offset:1024
  ds_read_b128 v[60:63], v9 offset:2048
  ds_read_b128 v[64:67], v9 offset:3072
  ds_read_b128 v[68:71], v9 offset:16384
  ds_read_b128 v[72:75], v9 offset:17408
  ds_read_b128 v[76:79], v9 offset:18432
  ds_read_b128 v[80:83], v9 offset:19456
  ds_read_b128 v[84:87], v9 offset:32768
  ds_read_b128 v[88:91], v9 offset:33792
  ds_read_b128 v[92:95], v9 offset:34816
  ds_read_b128 v[96:99], v9 offset:35840
  v_mov_b64 v[100:101], 0
  v_mov_b64 v[102:103], 0
  v_mov_b64 v[104:105], 0
  v_mov_b64 v[106:107], 0
  v_mov_b64 v[108:109], 0
  v_mov_b64 v[110:111], 0
  v_mov_b64 v[112:113], 0
  v_mov_b64 v[114:115], 0
  v_mov_b64 v[116:117], 0
  v_mov_b64 v[118:119], 0
  v_mov_b64 v[120:121], 0
  v_mov_b64 v[122:123], 0
  s_and_b32 s57, s4, 1
  s_lshl_b32 s57, s57, 3
  v_add_u32 v19, s57, v8
  s_lshl_b32 s57, s57, 9
  v_add_u32 v18, s57, v8
  v_xor_b32 v1, s65, v7
  v_xor_b32 v2, s66, v7
  v_xor_b32 v3, s67, v7
.p2alignl 6, 0xbf800000
L_c_ld_f:
  buffer_load_dwordx4 v[20:23], v7, s[52:55], s71 offen offset:0 sc1
  buffer_load_dwordx4 v[24:27], v7, s[52:55], s71 offen offset:1024 sc1
  s_nop 15
  s_nop 15
  buffer_load_dwordx4 v[48:51], v7, s[52:55], s71 offen offset:1024 sc1
  s_waitcnt vmcnt(2) lgkmcnt(0)
  ds_write_b128 v7, v[20:23] offset:0
  v_max3_u32 v40, v20, v21, v22
  v_max_u32 v40, v40, v23
  v_cmp_eq_u32_e64 vcc, -1, v40
  v_smfmac_f32_16x16x64_bf16 v[104:107], v[20:23], v[52:59], v4
  v_smfmac_f32_16x16x64_bf16 v[100:103], v[20:23], v[128:135], v4
  s_cbranch_vccnz L_c_x0_f
  s_waitcnt vmcnt(1)
  ds_write_b128 v7, v[24:27] offset:1024
  v_max3_u32 v40, v24, v25, v26
  v_max_u32 v40, v40, v27
  v_cmp_eq_u32 vcc, -1, v40
  v_smfmac_f32_16x16x64_bf16 v[112:115], v[20:23], a[64:71], v4
  v_smfmac_f32_16x16x64_bf16 v[108:111], v[20:23], a[0:7], v4
  s_cbranch_vccnz L_c_x1_f
L_c_r1_f:
  v_smfmac_f32_16x16x64_bf16 v[104:107], v[24:27], v[60:67], v4
  s_waitcnt lgkmcnt(0)
  s_barrier
  ds_read_b128 v[28:31], v1 offset:0
  v_smfmac_f32_16x16x64_bf16 v[100:103], v[24:27], v[136:143], v4
  ds_read_b128 v[32:35], v1 offset:1024
  v_smfmac_f32_16x16x64_bf16 v[112:115], v[24:27], a[72:79], v4
  ds_read_b128 v[36:39], v2 offset:0
  v_smfmac_f32_16x16x64_bf16 v[108:111], v[24:27], a[8:15], v4
  ds_read_b128 v[40:43], v2 offset:1024
  v_smfmac_f32_16x16x64_bf16 v[116:119], v[20:23], a[128:135], v4
  s_waitcnt vmcnt(0)
  ds_read_b128 v[44:47], v3 offset:0
  v_smfmac_f32_16x16x64_bf16 v[120:123], v[20:23], a[192:199], v4
  ds_read_b128 v[48:51], v3 offset:1024
  s_waitcnt lgkmcnt(4)
  v_smfmac_f32_16x16x64_bf16 v[104:107], v[28:31], v[68:75], v4
  buffer_store_dword v16, v6, s[52:55], s62 offen sc1
  v_smfmac_f32_16x16x64_bf16 v[104:107], v[32:35], v[76:83], v4
  v_mov_b64_e64 v[20:21], 0
  s_waitcnt lgkmcnt(2)
  v_smfmac_f32_16x16x64_bf16 v[104:107], v[36:39], v[84:91], v4
  buffer_load_dword v17, v8, s[84:87], s61 idxen sc1
  v_smfmac_f32_16x16x64_bf16 v[104:107], v[40:43], v[92:99], v4
  v_mov_b64 v[22:23], 0
  s_waitcnt lgkmcnt(0)
  v_smfmac_f32_16x16x64_bf16 v[104:107], v[44:47], v[192:199], v4
  ds_read_b128 v[52:55], v18 offset:16384
  v_smfmac_f32_16x16x64_bf16 v[104:107], v[48:51], v[200:207], v4
  ds_read_b128 v[56:59], v18 offset:17408
  v_smfmac_f32_16x16x64_bf16 v[100:103], v[28:31], v[144:151], v4
  ds_read_b128 v[60:63], v18 offset:18432
  v_smfmac_f32_16x16x64_bf16 v[100:103], v[32:35], v[152:159], v4
  v_add_f32_e64 v104, v104, v106
  v_smfmac_f32_16x16x64_bf16 v[100:103], v[36:39], v[160:167], v4
  v_add_f32_e64 v105, v105, v107
  v_smfmac_f32_16x16x64_bf16 v[100:103], v[40:43], v[168:175], v4
  v_cvt_pk_bf16_f32 v104, v104, v105
  v_smfmac_f32_16x16x64_bf16 v[100:103], v[44:47], v[176:183], v4
  ds_read_b128 v[64:67], v18 offset:19456
  v_smfmac_f32_16x16x64_bf16 v[100:103], v[48:51], v[184:191], v4
  ds_read_b128 v[68:71], v7 offset:24576
  v_smfmac_f32_16x16x64_bf16 v[112:115], v[28:31], a[80:87], v4
  ds_read_b128 v[72:75], v7 offset:25600
  v_smfmac_f32_16x16x64_bf16 v[112:115], v[32:35], a[88:95], v4
  v_add_f32_e64 v100, v100, v102
  v_smfmac_f32_16x16x64_bf16 v[112:115], v[36:39], a[96:103], v4
  v_add_f32_e64 v101, v101, v103
  v_smfmac_f32_16x16x64_bf16 v[112:115], v[40:43], a[104:111], v4
  v_cvt_pk_bf16_f32 v100, v100, v101
  v_smfmac_f32_16x16x64_bf16 v[112:115], v[44:47], a[112:119], v4
  ds_write2_b32 v10, v100, v104 offset1:72
  v_smfmac_f32_16x16x64_bf16 v[112:115], v[48:51], a[120:127], v4
  ds_read_b128 v[76:79], v0 offset:34816
  v_smfmac_f32_16x16x64_bf16 v[108:111], v[28:31], a[16:23], v4
  ds_read_b128 v[80:83], v0 offset:35840
  v_smfmac_f32_16x16x64_bf16 v[108:111], v[32:35], a[24:31], v4
  v_add_f32_e64 v112, v112, v114
  v_smfmac_f32_16x16x64_bf16 v[108:111], v[36:39], a[32:39], v4
  s_waitcnt lgkmcnt(2)
  s_barrier
  v_smfmac_f32_16x16x64_bf16 v[108:111], v[40:43], a[40:47], v4
  ds_read_b64_tr_b16 v[84:85], v11 offset:8192
  ds_read_b64_tr_b16 v[86:87], v11 offset:8224
  v_smfmac_f32_16x16x64_bf16 v[108:111], v[44:47], a[48:55], v4
  ds_read_b64_tr_b16 v[88:89], v11 offset:8768
  ds_read_b64_tr_b16 v[90:91], v11 offset:8800
  v_smfmac_f32_16x16x64_bf16 v[108:111], v[48:51], a[56:63], v4
  ds_read_b64_tr_b16 v[92:93], v11 offset:9344
  ds_read_b64_tr_b16 v[94:95], v11 offset:9376
  v_smfmac_f32_16x16x64_bf16 v[116:119], v[24:27], a[136:143], v4
  ds_read_b64_tr_b16 v[96:97], v11 offset:9920
  ds_read_b64_tr_b16 v[98:99], v11 offset:9952
  v_smfmac_f32_16x16x64_bf16 v[120:123], v[24:27], a[200:207], v4
  s_waitcnt lgkmcnt(4)
  v_add_f32 v113, v113, v115
  v_mfma_f32_16x16x32_bf16 v[24:27], v[52:55], v[84:87], 0
  v_add_f32 v108, v108, v110
  v_add_f32 v109, v109, v111
  v_mfma_f32_16x16x32_bf16 v[24:27], v[56:59], v[88:91], v[24:27]
  s_waitcnt lgkmcnt(0)
  v_cvt_pk_bf16_f32 v115, v112, v113
  v_cvt_pk_bf16_f32 v114, v108, v109
  v_mfma_f32_16x16x32_bf16 v[24:27], v[60:63], v[92:95], v[24:27]
  ds_write_b64 v12, v[114:115]
  v_mfma_f32_16x16x32_bf16 v[24:27], v[64:67], v[96:99], v[24:27]
  v_smfmac_f32_16x16x64_bf16 v[116:119], v[28:31], a[144:151], v4
  buffer_load_dwordx4 v8, s[52:55], s61 offen offset:0 sc1 lds
  v_smfmac_f32_16x16x64_bf16 v[120:123], v[28:31], a[208:215], v4
  v_exp_f32 v24, v24
  v_exp_f32_e64 v25, v25
  v_smfmac_f32_16x16x64_bf16 v[116:119], v[32:35], a[152:159], v4
  v_exp_f32 v26, v26
  v_exp_f32 v27, v27
  v_cvt_pk_bf16_f32 v24, v24, v25
  v_cvt_pk_bf16_f32 v25, v26, v27
  v_smfmac_f32_16x16x64_bf16 v[120:123], v[32:35], a[216:223], v4
  ds_write_b64 v19, v[24:25] offset:14848
  v_smfmac_f32_16x16x64_bf16 v[116:119], v[36:39], a[160:167], v4
  buffer_load_dword v17, off, s[52:55], s74 sc1
  v_mov_b32_e64 v57, 0
  v_smfmac_f32_16x16x64_bf16 v[120:123], v[36:39], a[224:231], v4
  buffer_load_dwordx4 v8, s[52:55], s61 offen offset:1024 sc1 lds
  v_smfmac_f32_16x16x64_bf16 v[116:119], v[40:43], a[168:175], v4
  s_waitcnt lgkmcnt(0)
  s_barrier
  v_smfmac_f32_16x16x64_bf16 v[120:123], v[40:43], a[232:239], v4
  ds_read_b64_tr_b16 v[100:101], v13 offset:10496
  ds_read_b64_tr_b16 v[102:103], v13 offset:10528
  v_smfmac_f32_16x16x64_bf16 v[116:119], v[44:47], a[176:183], v4
  ds_read_b64_tr_b16 v[104:105], v13 offset:11648
  ds_read_b64_tr_b16 v[106:107], v13 offset:11680
  v_smfmac_f32_16x16x64_bf16 v[116:119], v[48:51], a[184:191], v4
  ds_read_b128 v[52:55], v8 offset:14848
  v_smfmac_f32_16x16x64_bf16 v[120:123], v[44:47], a[240:247], v4
  ds_read_b128 v[36:39], v9 offset:49152
  v_smfmac_f32_16x16x64_bf16 v[120:123], v[48:51], a[248:255], v4
  ds_read_b128 v[40:43], v0 offset:0
  s_waitcnt lgkmcnt(3)
  v_smfmac_f32_16x16x64_bf16 v[20:23], v[100:103], v[84:91], v4
  ds_read_b128 v[44:47], v0 offset:16384
  v_smfmac_f32_16x16x64_bf16 v[20:23], v[104:107], v[92:99], v4
  ds_read_b128 v[48:51], v0 offset:49152
  s_waitcnt lgkmcnt(4)
  v_mfma_f32_16x16x32_bf16 v[60:63], v[124:127], v[52:55], 0
  v_add_f32 v116, v116, v118
  v_add_f32 v117, v117, v119
  v_mfma_f32_16x16x32_bf16 v[28:31], v[68:71], v[52:55], 0
  v_add_f32 v20, v20, v22
  v_add_f32 v21, v21, v23
  v_mfma_f32_16x16x32_bf16 v[32:35], v[72:75], v[52:55], 0
  v_exp_f32 v20, v20
  v_exp_f32 v21, v21
  v_cvt_pk_bf16_f32 v116, v116, v117
  v_cvt_pk_bf16_f32 v56, v20, v21
  v_mov_b32 v117, 0
  v_add_f32 v120, v120, v122
  v_mfma_f32_16x16x16_bf16 v[60:63], v[124:125], v[56:57], v[60:63]
  v_add_f32_e64 v121, v121, v123
  v_cvt_pk_bf16_f32 v120, v120, v121
  v_mfma_f32_16x16x16_bf16 v[28:31], v[116:117], v[56:57], v[28:31]
  v_mov_b32_e64 v121, 0
  ds_read_b128 v[84:87], v0 offset:32768
  s_nop 0
  v_mfma_f32_16x16x16_bf16 v[32:35], v[120:121], v[56:57], v[32:35]
  ds_read_b128 v[88:91], v0 offset:33792
  v_rcp_f32 v58, v62
  v_subrev_u32 v59, s96, v62
L_c_norm_f:
  s_nop 0
  v_mul_f32 v28, v28, v58
  v_mul_f32 v29, v29, v58
  v_mul_f32 v30, v30, v58
  v_mul_f32 v31, v31, v58
  v_cvt_pk_bf16_f32 v60, v28, v29
  v_cvt_pk_bf16_f32 v61, v30, v31
  v_pk_mul_f32 v[32:33], v[32:33], v[58:59] op_sel_hi:[1,0]
  v_pk_mul_f32 v[34:35], v[34:35], v[58:59] op_sel_hi:[1,0]
  v_cvt_pk_bf16_f32 v62, v32, v33
  v_cvt_pk_bf16_f32 v63, v34, v35
  ds_write_b128 v14, v[60:63] offset:12800
  v_cmp_lt_u32 vcc, s97, v59
  v_mov_b64 v[118:119], 0
  s_cbranch_vccnz L_c_slow_f
  s_nop 0
  v_mfma_f32_32x32x8_bf16 v[100:115], v[118:119], v[118:119], 0
  s_waitcnt lgkmcnt(0)
  s_barrier
  ds_read_b128 v[92:95], v15 offset:12800
  ds_read_b128 v[96:99], v15 offset:13824
  v_mfma_f32_32x32x8_bf16 v[20:35], v[118:119], v[118:119], 0
  ds_read_b128 v[52:55], v9 offset:50176
  ds_read_b128 v[56:59], v0 offset:1024
  s_waitcnt lgkmcnt(3)
  v_smfmac_f32_16x16x64_bf16 v[104:107], v[92:95], v[84:91], v4
  ds_read_b128 v[60:63], v0 offset:17408
  s_waitcnt lgkmcnt(3)
  v_smfmac_f32_16x16x64_bf16 v[104:107], v[96:99], v[76:83], v4
  ds_read_b128 v[64:67], v0 offset:50176
  v_smfmac_f32_16x16x64_bf16 v[100:103], v[92:95], v[240:247], v4
  ds_read_b128 v[68:71], v9 offset:51200
  v_smfmac_f32_16x16x64_bf16 v[100:103], v[96:99], v[248:255], v4
  ds_read_b128 v[72:75], v0 offset:2048
  v_add_f32_e64 v104, v104, v106
  v_smfmac_f32_16x16x64_bf16 v[108:111], v[92:95], v[208:215], v4
  ds_read_b128 v[116:119], v0 offset:18432
  v_add_f32_e64 v105, v105, v107
  v_smfmac_f32_16x16x64_bf16 v[108:111], v[96:99], v[216:223], v4
  v_add_f32 v100, v100, v102
  v_add_f32 v101, v101, v103
  v_smfmac_f32_16x16x64_bf16 v[112:115], v[92:95], v[224:231], v4
  v_cvt_pk_bf16_f32 v86, v100, v104
  v_cvt_pk_bf16_f32 v87, v101, v105
  v_smfmac_f32_16x16x64_bf16 v[112:115], v[96:99], v[232:239], v4
  ds_read_b128 v[120:123], v0 offset:51200
  v_add_f32 v108, v108, v110
  v_add_f32 v109, v109, v111
  v_smfmac_f32_16x16x64_bf16 v[20:23], v[92:95], v[36:43], v4
  ds_read_b128 v[76:79], v9 offset:52224
  ds_read_b128 v[80:83], v0 offset:3072
  v_smfmac_f32_16x16x64_bf16 v[20:23], v[96:99], v[44:51], v4
  ds_read_b128 v[36:39], v0 offset:19456
  ds_read_b128 v[40:43], v0 offset:52224
  v_add_f32 v112, v112, v114
  v_add_f32 v113, v113, v115
  v_cvt_pk_bf16_f32 v84, v108, v112
  v_cvt_pk_bf16_f32 v85, v109, v113
  v_bfi_b32 v84, 1, s73, v84
  buffer_store_dwordx4 v[84:87], v5, s[52:55], 0 offen
  s_waitcnt lgkmcnt(2)
  v_smfmac_f32_16x16x64_bf16 v[24:27], v[92:95], v[52:59], v4
  v_smfmac_f32_16x16x64_bf16 v[24:27], v[96:99], v[60:67], v4
  v_add_f32 v20, v20, v22
  v_smfmac_f32_16x16x64_bf16 v[28:31], v[92:95], v[68:75], v4
  v_add_f32_e64 v21, v21, v23
  v_smfmac_f32_16x16x64_bf16 v[28:31], v[96:99], v[116:123], v4
  v_add_f32_e64 v24, v24, v26
  v_smfmac_f32_16x16x64_bf16 v[32:35], v[92:95], v[76:83], v4
  v_add_f32 v25, v25, v27
  s_waitcnt lgkmcnt(0)
  v_smfmac_f32_16x16x64_bf16 v[32:35], v[96:99], v[36:43], v4
  v_cvt_pk_bf16_f32 v88, v20, v24
  v_cvt_pk_bf16_f32 v89, v21, v25
  v_bfi_b32 v88, 1, s73, v88
  v_add_f32 v28, v28, v30
  v_add_f32_e64 v29, v29, v31
  s_nop 2
  v_pk_add_f32 v[32:33], v[32:33], v[34:35]
  s_nop 0
  v_cvt_pk_bf16_f32 v90, v28, v32
  v_cvt_pk_bf16_f32 v91, v29, v33
  buffer_store_dwordx4 v[88:91], v5, s[52:55], s64 offen
  v_mov_b64 v[100:101], 0
  v_mov_b64 v[102:103], 0
  v_mov_b64 v[104:105], 0
  v_mov_b64 v[106:107], 0
  v_mov_b64 v[108:109], 0
  v_mov_b64 v[110:111], 0
  v_mov_b64 v[112:113], 0
  v_mov_b64 v[114:115], 0
  v_mov_b64 v[116:117], 0
  v_mov_b64 v[118:119], 0
  v_mov_b64 v[120:121], 0
  v_mov_b64_e64 v[122:123], 0
  s_add_u32 s71, s71, s68
  s_cmp_eq_u32 s71, s58
  s_cselect_b32 s71, 1572864, s71
  s_add_u32 s72, s72, s68
  s_cmp_eq_u32 s72, s58
  s_cselect_b32 s72, 1572864, s72
  s_add_u32 s70, s70, 1
  s_add_u32 s60, s60, s78
  s_add_u32 s62, s62, s68
  v_mov_b32 v48, -1
  ds_read_b128 v[52:55], v9 offset:0
  ds_read_b128 v[56:59], v9 offset:1024
  ds_read_b128 v[60:63], v9 offset:2048
  ds_read_b128 v[64:67], v9 offset:3072
  ds_read_b128 v[68:71], v9 offset:16384
  ds_read_b128 v[72:75], v9 offset:17408
  s_cmp_ge_u32 s4, 2
  s_cbranch_scc1 L_c_h_148
  buffer_load_dwordx4 v[36:39], v8, s[52:55], s76 offen sc1
  buffer_load_dwordx4 v[40:43], v8, s[52:55], s76 offen offset:1024 sc1
L_c_h_148:
  ds_read_b128 v[76:79], v9 offset:18432
  ds_read_b128 v[80:83], v9 offset:19456
  ds_read_b128 v[84:87], v9 offset:32768
  ds_read_b128 v[88:91], v9 offset:33792
  ds_read_b128 v[92:95], v9 offset:34816
  ds_read_b128 v[96:99], v9 offset:35840
  s_cbranch_scc0 L_c_h_149
  s_nop 11
  buffer_load_dwordx4 v[36:39], v8, s[52:55], s76 offen sc1
  buffer_load_dwordx4 v[40:43], v8, s[52:55], s76 offen offset:1024 sc1
L_c_h_149:
  s_nop 15
  s_nop 7
  buffer_load_dwordx4 v[28:31], v8, s[52:55], s76 offen sc1
  buffer_load_dwordx4 v[32:35], v8, s[52:55], s76 offen offset:1024 sc1
  s_waitcnt vmcnt(3)
  v_mfma_f32_16x16x32_bf16 v[44:47], v[124:127], v[36:39], 0
  v_xor_b32_e64 v49, s73, v36
  s_waitcnt vmcnt(2)
  v_mfma_f32_16x16x32_bf16 v[44:47], v[124:127], v[40:43], v[44:47]
  v_xor_b32 v50, s73, v40
L_c_pc_f:
  v_or_b32 v49, v49, v50
  v_and_b32 v49, 1, v49
  v_cmp_ne_u32_e64 vcc, 0, v49
  s_nop 3
  v_add_f32_dpp v44, v44, v44 row_ror:4 row_mask:0xf bank_mask:0xf
  v_add_f32_dpp v45, v45, v45 row_ror:4 row_mask:0xf bank_mask:0xf
  s_cbranch_vccnz L_c_px_f
  v_add_f32_dpp v44, v44, v44 row_ror:8 row_mask:0xf bank_mask:0xf
  v_add_f32_dpp v45, v45, v45 row_ror:8 row_mask:0xf bank_mask:0xf
  v_cvt_pk_bf16_f32 v16, v44, v45
  v_min_u32 v16, -2, v16
  buffer_store_dword v16, v6, s[52:55], s71 offen
  s_cmp_eq_u32 s70, 63
  s_cbranch_scc1 L_c_done
  buffer_load_dwordx4 v8, s[52:55], s61 offen offset:2048 sc1 lds
  buffer_load_dwordx4 v8, s[52:55], s61 offen offset:3072 sc1 lds
  s_add_u32 s61, s61, s78
  buffer_store_dword v48, v6, s[52:55], s72 offen
  s_xor_b32 s73, s73, 1
  s_mov_b32 s100, 0
L_kv_lp_151:
  v_readfirstlane_b32 s57, v17
  s_nop 0
  s_cmp_gt_u32 s57, s75
  s_cbranch_scc1 L_kv_ok_150
  s_sub_u32 s56, s56, 1
  s_cbranch_scc1 L_timeout
  buffer_load_dword v17, off, s[52:55], s74 sc1
  s_waitcnt vmcnt(0)
  s_branch L_kv_lp_151
L_kv_ok_150:
  v_mov_b32 v17, 0
  s_add_u32 s74, s74, s66
  s_bitcmp1_b32 s74, 13
  s_addc_u32 s75, s75, 0
  s_bitset0_b32 s74, 13
  s_min_u32 s75, s75, 31
  s_nop 11
  s_cmp_ge_u32 s4, 2
  s_cbranch_scc1 L_c_ld_f
  s_nop 15
  s_nop 15
  s_branch L_c_ld_f
L_c_slow_f:
  s_branch L_c_slow2_f
L_c_px_f:
  s_sub_u32 s56, s56, 1
  s_cbranch_scc1 L_timeout
  s_xor_b32 s100, s100, 1
  s_bitcmp1_b32 s100, 0
  s_cbranch_scc0 L_c_py_f
  buffer_load_dwordx4 v[36:39], v8, s[52:55], s76 offen sc1
  buffer_load_dwordx4 v[40:43], v8, s[52:55], s76 offen offset:1024 sc1
  s_waitcnt vmcnt(2)
  v_mfma_f32_16x16x32_bf16 v[44:47], v[124:127], v[28:31], 0
  v_xor_b32 v49, s73, v28
  v_mfma_f32_16x16x32_bf16 v[44:47], v[124:127], v[32:35], v[44:47]
  v_xor_b32 v50, s73, v32
  s_branch L_c_pc_f
L_c_py_f:
  buffer_load_dwordx4 v[28:31], v8, s[52:55], s76 offen sc1
  buffer_load_dwordx4 v[32:35], v8, s[52:55], s76 offen offset:1024 sc1
  s_waitcnt vmcnt(2)
  v_mfma_f32_16x16x32_bf16 v[44:47], v[124:127], v[36:39], 0
  v_xor_b32 v49, s73, v36
  v_mfma_f32_16x16x32_bf16 v[44:47], v[124:127], v[40:43], v[44:47]
  v_xor_b32 v50, s73, v40
  s_branch L_c_pc_f
L_c_x0_f:
  s_sub_u32 s56, s56, 1
  s_cbranch_scc1 L_timeout
  s_waitcnt vmcnt(0) lgkmcnt(0)
  s_nop 3
  v_mov_b64 v[100:101], 0
  v_mov_b64 v[102:103], 0
  v_mov_b64 v[104:105], 0
  v_mov_b64 v[106:107], 0
  v_mov_b64 v[108:109], 0
  v_mov_b64 v[110:111], 0
  v_mov_b64 v[112:113], 0
  v_mov_b64 v[114:115], 0
  s_branch L_c_ld_f
L_c_x1_f:
  s_sub_u32 s56, s56, 1
  s_cbranch_scc1 L_timeout
  s_xor_b32 s100, s100, 2
  s_bitcmp1_b32 s100, 1
  s_cbranch_scc0 L_c_y1_f
  buffer_load_dwordx4 v[44:47], v7, s[52:55], s71 offen offset:1024 sc1
  s_waitcnt vmcnt(1) lgkmcnt(0)
  v_max3_u32 v40, v48, v49, v50
  v_max_u32 v40, v40, v51
  v_cmp_eq_u32 vcc, -1, v40
  v_mov_b64 v[24:25], v[48:49]
  v_mov_b64 v[26:27], v[50:51]
  ds_write_b128 v7, v[24:27] offset:1024
  s_cbranch_vccnz L_c_x1_f
  s_branch L_c_r1_f
L_c_y1_f:
  buffer_load_dwordx4 v[48:51], v7, s[52:55], s71 offen offset:1024 sc1
  s_waitcnt vmcnt(1) lgkmcnt(0)
  v_max3_u32 v40, v44, v45, v46
  v_max_u32 v40, v40, v47
  v_cmp_eq_u32 vcc, -1, v40
  v_mov_b64 v[24:25], v[44:45]
  v_mov_b64 v[26:27], v[46:47]
  ds_write_b128 v7, v[24:27] offset:1024
  s_cbranch_vccnz L_c_x1_f
  s_branch L_c_r1_f
L_c_slow2_f:
  s_sub_u32 s57, s60, s78
  s_waitcnt lgkmcnt(0)
  ds_read_b64_tr_b16 v[84:85], v11 offset:8192
  ds_read_b64_tr_b16 v[86:87], v11 offset:8224
  ds_read_b64_tr_b16 v[88:89], v11 offset:8768
  ds_read_b64_tr_b16 v[90:91], v11 offset:8800
  s_waitcnt lgkmcnt(0)
  buffer_load_dwordx4 v[28:31], v8, s[52:55], s57 offen offset:0 sc1
  buffer_load_dwordx4 v[32:35], v8, s[52:55], s57 offen offset:1024 sc1
  s_waitcnt vmcnt(0)
  v_mfma_f32_16x16x32_bf16 v[24:27], v[28:31], v[84:87], 0
  v_mfma_f32_16x16x32_bf16 v[24:27], v[32:35], v[88:91], v[24:27]
  s_nop 7
  buffer_load_dwordx4 v[28:31], v8, s[52:55], s57 offen offset:2048 sc1
  buffer_load_dwordx4 v[32:35], v8, s[52:55], s57 offen offset:3072 sc1
  s_waitcnt vmcnt(0)
  v_mfma_f32_16x16x32_bf16 v[24:27], v[28:31], v[92:95], v[24:27]
  v_mfma_f32_16x16x32_bf16 v[24:27], v[32:35], v[96:99], v[24:27]
  s_nop 7
  s_add_u32 s57, s57, 4096
  buffer_load_dwordx4 v[28:31], v8, s[52:55], s57 offen offset:0 sc1
  buffer_load_dwordx4 v[32:35], v8, s[52:55], s57 offen offset:1024 sc1
  s_waitcnt vmcnt(0)
  v_mfma_f32_16x16x32_bf16 v[60:63], v[28:31], v[84:87], 0
  v_mfma_f32_16x16x32_bf16 v[60:63], v[32:35], v[88:91], v[60:63]
  s_nop 7
  buffer_load_dwordx4 v[28:31], v8, s[52:55], s57 offen offset:2048 sc1
  buffer_load_dwordx4 v[32:35], v8, s[52:55], s57 offen offset:3072 sc1
  s_waitcnt vmcnt(0)
  v_mfma_f32_16x16x32_bf16 v[60:63], v[28:31], v[92:95], v[60:63]
  v_mfma_f32_16x16x32_bf16 v[60:63], v[32:35], v[96:99], v[60:63]
  s_nop 7
  s_add_u32 s57, s57, 4096
  v_mov_b64 v[20:21], 0
  v_mov_b64 v[22:23], 0
  s_nop 1
  v_smfmac_f32_16x16x64_bf16 v[20:23], v[100:103], v[84:91], v4
  v_smfmac_f32_16x16x64_bf16 v[20:23], v[104:107], v[92:99], v4
  s_nop 7
  v_add_f32 v20, v20, v22
  v_add_f32 v21, v21, v23
  v_max_f32 v58, v20, v21
  v_max3_f32 v58, v58, v24, v25
  v_max3_f32 v58, v58, v26, v27
  v_max3_f32 v58, v58, v60, v61
  v_max3_f32 v58, v58, v62, v63
  v_mov_b32 v59, v58
  s_nop 1
  v_permlane16_swap_b32 v58, v59
  v_max_f32 v58, v58, v59
  v_mov_b32 v59, v58
  s_nop 1
  v_permlane32_swap_b32 v58, v59
  v_max_f32 v58, v58, v59
  v_sub_f32 v20, v20, v58
  v_exp_f32 v20, v20
  v_sub_f32 v21, v21, v58
  v_exp_f32 v21, v21
  v_sub_f32 v24, v24, v58
  v_exp_f32 v24, v24
  v_sub_f32 v25, v25, v58
  v_exp_f32 v25, v25
  v_sub_f32 v26, v26, v58
  v_exp_f32 v26, v26
  v_sub_f32 v27, v27, v58
  v_exp_f32 v27, v27
  v_sub_f32 v60, v60, v58
  v_exp_f32 v60, v60
  v_sub_f32 v61, v61, v58
  v_exp_f32 v61, v61
  v_sub_f32 v62, v62, v58
  v_exp_f32 v62, v62
  v_sub_f32 v63, v63, v58
  v_exp_f32 v63, v63
  v_cvt_pk_bf16_f32 v52, v24, v25
  v_cvt_pk_bf16_f32 v53, v26, v27
  v_cvt_pk_bf16_f32 v54, v60, v61
  v_cvt_pk_bf16_f32 v55, v62, v63
  v_cvt_pk_bf16_f32 v56, v20, v21
  s_nop 0
  v_mfma_f32_16x16x32_bf16 v[60:63], v[124:127], v[52:55], 0
  v_mfma_f32_16x16x32_bf16 v[28:31], v[68:71], v[52:55], 0
  v_mfma_f32_16x16x32_bf16 v[32:35], v[72:75], v[52:55], 0
  v_mfma_f32_16x16x16_bf16 v[60:63], v[124:125], v[56:57], v[60:63]
  v_mfma_f32_16x16x16_bf16 v[28:31], v[116:117], v[56:57], v[28:31]
  v_mfma_f32_16x16x16_bf16 v[32:35], v[120:121], v[56:57], v[32:35]
  ds_read_b128 v[84:87], v0 offset:32768
  ds_read_b128 v[88:91], v0 offset:33792
  v_rcp_f32 v58, v62
  v_mov_b32 v59, 0
  s_nop 7
  s_branch L_c_norm_f
L_c_start_s:
  s_add_u32 s84, s52, 262144
  s_addc_u32 s85, s53, 0x40000
  s_mov_b32 s86, 0x4000000
  s_mov_b32 s87, 0x20000
  s_mov_b32 s70, 0
  s_mov_b32 s71, 1572864
  s_mov_b32 s72, 1589248
  s_mov_b32 s58, 1597440
  s_mov_b32 s73, 1
  s_lshl_b32 s74, s6, 7
  s_mov_b32 s75, 0
  s_mov_b32 s79, 0x3e0293ee
  s_lshl_b32 s60, s6, 13
  s_add_u32 s60, s60, 33554432
  s_mov_b32 s61, s88
  s_mov_b32 s62, 2097152
  s_mov_b32 s63, 0x3f803f80
  s_mov_b32 s64, 32768
  s_mov_b32 s65, 2048
  s_mov_b32 s66, 4096
  s_mov_b32 s67, 6144
  s_mov_b32 s68, 8192
  s_mov_b32 s78, 262144
  s_mov_b32 s98, 0x3f803f80
  s_mov_b32 s99, 0x3f803f80
  s_mov_b32 s96, 0x30800000
  s_mov_b32 s97, 0x1e000000
  s_mov_b32 s100, 0
  s_mov_b32 s75, 1
  s_add_u32 s74, s74, 4096
  v_mov_b32 v17, 0
  s_mov_b32 m0, s69
  s_nop 0
  buffer_load_dwordx4 v8, s[52:55], s61 offen offset:0 sc1 lds
  buffer_load_dwordx4 v8, s[52:55], s61 offen offset:1024 sc1 lds
  buffer_load_dwordx4 v8, s[52:55], s61 offen offset:2048 sc1 lds
  buffer_load_dwordx4 v8, s[52:55], s61 offen offset:3072 sc1 lds
  s_add_u32 s60, s60, s78
  s_add_u32 s61, s61, s78
  ds_read_b128 v[52:55], v9 offset:0
  ds_read_b128 v[56:59], v9 offset:1024
  ds_read_b128 v[60:63], v9 offset:2048
  ds_read_b128 v[64:67], v9 offset:3072
  ds_read_b128 v[68:71], v9 offset:16384
  ds_read_b128 v[72:75], v9 offset:17408
  ds_read_b128 v[76:79], v9 offset:18432
  ds_read_b128 v[80:83], v9 offset:19456
  ds_read_b128 v[84:87], v9 offset:32768
  ds_read_b128 v[88:91], v9 offset:33792
  ds_read_b128 v[92:95], v9 offset:34816
  ds_read_b128 v[96:99], v9 offset:35840
  v_mov_b64 v[100:101], 0
  v_mov_b64 v[102:103], 0
  v_mov_b64 v[104:105], 0
  v_mov_b64 v[106:107], 0
  v_mov_b64 v[108:109], 0
  v_mov_b64 v[110:111], 0
  v_mov_b64 v[112:113], 0
  v_mov_b64 v[114:115], 0
  v_mov_b64 v[116:117], 0
  v_mov_b64 v[118:119], 0
  v_mov_b64 v[120:121], 0
  v_mov_b64 v[122:123], 0
  s_and_b32 s57, s4, 1
  s_lshl_b32 s57, s57, 3
  v_add_u32 v19, s57, v8
  s_lshl_b32 s57, s57, 9
  v_add_u32 v18, s57, v8
  v_xor_b32 v1, s65, v7
  v_xor_b32 v2, s66, v7
  v_xor_b32 v3, s67, v7
.p2alignl 6, 0xbf800000
L_c_ld_s:
  buffer_load_dwordx4 v[20:23], v7, s[52:55], s71 offen offset:0 sc1
  buffer_load_dwordx4 v[24:27], v7, s[52:55], s71 offen offset:1024 sc1
  s_nop 15
  s_nop 15
  buffer_load_dwordx4 v[48:51], v7, s[52:55], s71 offen offset:1024 sc1
  s_waitcnt vmcnt(2) lgkmcnt(0)
  ds_write_b128 v7, v[20:23] offset:0
  v_max3_u32 v40, v20, v21, v22
  v_max_u32 v40, v40, v23
  v_cmp_eq_u32 vcc, -1, v40
  v_smfmac_f32_16x16x64_bf16 v[104:107], v[20:23], v[52:59], v4
  v_smfmac_f32_16x16x64_bf16 v[100:103], v[20:23], v[128:135], v4
  s_cbranch_vccnz L_c_x0_s
  s_waitcnt vmcnt(1)
  ds_write_b128 v7, v[24:27] offset:1024
  v_max3_u32 v40, v24, v25, v26
  v_max_u32 v40, v40, v27
  v_cmp_eq_u32 vcc, -1, v40
  v_smfmac_f32_16x16x64_bf16 v[112:115], v[20:23], a[64:71], v4
  v_smfmac_f32_16x16x64_bf16 v[108:111], v[20:23], a[0:7], v4
  s_cbranch_vccnz L_c_x1_s
L_c_r1_s:
  v_smfmac_f32_16x16x64_bf16 v[104:107], v[24:27], v[60:67], v4
  s_waitcnt lgkmcnt(0)
  s_barrier
  ds_read_b128 v[28:31], v1 offset:0
  v_smfmac_f32_16x16x64_bf16 v[100:103], v[24:27], v[136:143], v4
  ds_read_b128 v[32:35], v1 offset:1024
  v_smfmac_f32_16x16x64_bf16 v[112:115], v[24:27], a[72:79], v4
  ds_read_b128 v[36:39], v2 offset:0
  v_smfmac_f32_16x16x64_bf16 v[108:111], v[24:27], a[8:15], v4
  ds_read_b128 v[40:43], v2 offset:1024
  v_smfmac_f32_16x16x64_bf16 v[116:119], v[20:23], a[128:135], v4
  s_waitcnt vmcnt(0)
  ds_read_b128 v[44:47], v3 offset:0
  v_smfmac_f32_16x16x64_bf16 v[120:123], v[20:23], a[192:199], v4
  ds_read_b128 v[48:51], v3 offset:1024
  s_waitcnt lgkmcnt(4)
  v_smfmac_f32_16x16x64_bf16 v[104:107], v[28:31], v[68:75], v4
  buffer_store_dword v16, v6, s[52:55], s62 offen sc1
  v_smfmac_f32_16x16x64_bf16 v[104:107], v[32:35], v[76:83], v4
  v_mov_b64 v[20:21], 0
  s_waitcnt lgkmcnt(2)
  v_smfmac_f32_16x16x64_bf16 v[104:107], v[36:39], v[84:91], v4
  buffer_load_dword v17, v8, s[84:87], s61 idxen sc1
  v_smfmac_f32_16x16x64_bf16 v[104:107], v[40:43], v[92:99], v4
  v_mov_b64 v[22:23], 0
  s_waitcnt lgkmcnt(0)
  v_smfmac_f32_16x16x64_bf16 v[104:107], v[44:47], v[192:199], v4
  ds_read_b128 v[52:55], v18 offset:16384
  v_smfmac_f32_16x16x64_bf16 v[104:107], v[48:51], v[200:207], v4
  ds_read_b128 v[56:59], v18 offset:17408
  v_smfmac_f32_16x16x64_bf16 v[100:103], v[28:31], v[144:151], v4
  ds_read_b128 v[60:63], v18 offset:18432
  v_smfmac_f32_16x16x64_bf16 v[100:103], v[32:35], v[152:159], v4
  v_add_f32 v104, v104, v106
  v_smfmac_f32_16x16x64_bf16 v[100:103], v[36:39], v[160:167], v4
  v_add_f32 v105, v105, v107
  v_smfmac_f32_16x16x64_bf16 v[100:103], v[40:43], v[168:175], v4
  v_cvt_pk_bf16_f32 v104, v104, v105
  v_smfmac_f32_16x16x64_bf16 v[100:103], v[44:47], v[176:183], v4
  ds_read_b128 v[64:67], v18 offset:19456
  v_smfmac_f32_16x16x64_bf16 v[100:103], v[48:51], v[184:191], v4
  ds_read_b128 v[68:71], v7 offset:24576
  v_smfmac_f32_16x16x64_bf16 v[112:115], v[28:31], a[80:87], v4
  ds_read_b128 v[72:75], v7 offset:25600
  v_smfmac_f32_16x16x64_bf16 v[112:115], v[32:35], a[88:95], v4
  v_add_f32 v100, v100, v102
  v_smfmac_f32_16x16x64_bf16 v[112:115], v[36:39], a[96:103], v4
  v_add_f32 v101, v101, v103
  v_smfmac_f32_16x16x64_bf16 v[112:115], v[40:43], a[104:111], v4
  v_cvt_pk_bf16_f32 v100, v100, v101
  v_smfmac_f32_16x16x64_bf16 v[112:115], v[44:47], a[112:119], v4
  ds_write2_b32 v10, v100, v104 offset1:72
  v_smfmac_f32_16x16x64_bf16 v[112:115], v[48:51], a[120:127], v4
  ds_read_b128 v[76:79], v0 offset:34816
  v_smfmac_f32_16x16x64_bf16 v[108:111], v[28:31], a[16:23], v4
  ds_read_b128 v[80:83], v0 offset:35840
  v_smfmac_f32_16x16x64_bf16 v[108:111], v[32:35], a[24:31], v4
  v_add_f32 v112, v112, v114
  v_smfmac_f32_16x16x64_bf16 v[108:111], v[36:39], a[32:39], v4
  s_waitcnt lgkmcnt(2)
  s_barrier
  v_smfmac_f32_16x16x64_bf16 v[108:111], v[40:43], a[40:47], v4
  ds_read_b64_tr_b16 v[84:85], v11 offset:8192
  ds_read_b64_tr_b16 v[86:87], v11 offset:8224
  v_smfmac_f32_16x16x64_bf16 v[108:111], v[44:47], a[48:55], v4
  ds_read_b64_tr_b16 v[88:89], v11 offset:8768
  ds_read_b64_tr_b16 v[90:91], v11 offset:8800
  v_smfmac_f32_16x16x64_bf16 v[108:111], v[48:51], a[56:63], v4
  ds_read_b64_tr_b16 v[92:93], v11 offset:9344
  ds_read_b64_tr_b16 v[94:95], v11 offset:9376
  v_smfmac_f32_16x16x64_bf16 v[116:119], v[24:27], a[136:143], v4
  ds_read_b64_tr_b16 v[96:97], v11 offset:9920
  ds_read_b64_tr_b16 v[98:99], v11 offset:9952
  v_smfmac_f32_16x16x64_bf16 v[120:123], v[24:27], a[200:207], v4
  s_waitcnt lgkmcnt(4)
  v_add_f32 v113, v113, v115
  v_mfma_f32_16x16x32_bf16 v[24:27], v[52:55], v[84:87], 0
  v_add_f32 v108, v108, v110
  v_add_f32 v109, v109, v111
  v_mfma_f32_16x16x32_bf16 v[24:27], v[56:59], v[88:91], v[24:27]
  s_waitcnt lgkmcnt(0)
  v_cvt_pk_bf16_f32 v115, v112, v113
  v_cvt_pk_bf16_f32 v114, v108, v109
  v_mfma_f32_16x16x32_bf16 v[24:27], v[60:63], v[92:95], v[24:27]
  ds_write_b64 v12, v[114:115]
  v_mfma_f32_16x16x32_bf16 v[24:27], v[64:67], v[96:99], v[24:27]
  v_smfmac_f32_16x16x64_bf16 v[116:119], v[28:31], a[144:151], v4
  buffer_load_dwordx4 v8, s[52:55], s61 offen offset:0 sc1 lds
  v_smfmac_f32_16x16x64_bf16 v[120:123], v[28:31], a[208:215], v4
  v_exp_f32 v24, v24
  v_exp_f32 v25, v25
  v_smfmac_f32_16x16x64_bf16 v[116:119], v[32:35], a[152:159], v4
  v_exp_f32 v26, v26
  v_exp_f32 v27, v27
  v_cvt_pk_bf16_f32 v24, v24, v25
  v_cvt_pk_bf16_f32 v25, v26, v27
  v_smfmac_f32_16x16x64_bf16 v[120:123], v[32:35], a[216:223], v4
  ds_write_b64 v19, v[24:25] offset:14848
  v_smfmac_f32_16x16x64_bf16 v[116:119], v[36:39], a[160:167], v4
  buffer_load_dword v17, off, s[52:55], s74 sc1
  v_mov_b32 v57, 0
  v_smfmac_f32_16x16x64_bf16 v[120:123], v[36:39], a[224:231], v4
  buffer_load_dwordx4 v8, s[52:55], s61 offen offset:1024 sc1 lds
  v_smfmac_f32_16x16x64_bf16 v[116:119], v[40:43], a[168:175], v4
  s_waitcnt lgkmcnt(0)
  s_barrier
  v_smfmac_f32_16x16x64_bf16 v[120:123], v[40:43], a[232:239], v4
  ds_read_b64_tr_b16 v[100:101], v13 offset:10496
  ds_read_b64_tr_b16 v[102:103], v13 offset:10528
  v_smfmac_f32_16x16x64_bf16 v[116:119], v[44:47], a[176:183], v4
  ds_read_b64_tr_b16 v[104:105], v13 offset:11648
  ds_read_b64_tr_b16 v[106:107], v13 offset:11680
  v_smfmac_f32_16x16x64_bf16 v[116:119], v[48:51], a[184:191], v4
  ds_read_b128 v[52:55], v8 offset:14848
  v_smfmac_f32_16x16x64_bf16 v[120:123], v[44:47], a[240:247], v4
  ds_read_b128 v[36:39], v9 offset:49152
  v_smfmac_f32_16x16x64_bf16 v[120:123], v[48:51], a[248:255], v4
  ds_read_b128 v[40:43], v0 offset:0
  s_waitcnt lgkmcnt(3)
  v_smfmac_f32_16x16x64_bf16 v[20:23], v[100:103], v[84:91], v4
  ds_read_b128 v[44:47], v0 offset:16384
  v_smfmac_f32_16x16x64_bf16 v[20:23], v[104:107], v[92:99], v4
  ds_read_b128 v[48:51], v0 offset:49152
  s_waitcnt lgkmcnt(4)
  v_mfma_f32_16x16x32_bf16 v[60:63], v[124:127], v[52:55], 0
  v_add_f32 v116, v116, v118
  v_add_f32 v117, v117, v119
  v_mfma_f32_16x16x32_bf16 v[28:31], v[68:71], v[52:55], 0
  v_add_f32 v20, v20, v22
  v_add_f32 v21, v21, v23
  v_mfma_f32_16x16x32_bf16 v[32:35], v[72:75], v[52:55], 0
  v_exp_f32 v20, v20
  v_exp_f32 v21, v21
  v_cvt_pk_bf16_f32 v116, v116, v117
  v_cvt_pk_bf16_f32 v56, v20, v21
  v_mov_b32 v117, 0
  v_add_f32 v120, v120, v122
  v_mfma_f32_16x16x16_bf16 v[60:63], v[124:125], v[56:57], v[60:63]
  v_add_f32 v121, v121, v123
  v_cvt_pk_bf16_f32 v120, v120, v121
  v_mfma_f32_16x16x16_bf16 v[28:31], v[116:117], v[56:57], v[28:31]
  v_mov_b32 v121, 0
  ds_read_b128 v[84:87], v0 offset:32768
  s_nop 0
  v_mfma_f32_16x16x16_bf16 v[32:35], v[120:121], v[56:57], v[32:35]
  ds_read_b128 v[88:91], v0 offset:33792
  v_rcp_f32 v58, v62
  v_subrev_u32 v59, s96, v62
L_c_norm_s:
  s_nop 0
  v_mul_f32 v28, v28, v58
  v_mul_f32 v29, v29, v58
  v_mul_f32 v30, v30, v58
  v_mul_f32 v31, v31, v58
  v_cvt_pk_bf16_f32 v60, v28, v29
  v_cvt_pk_bf16_f32 v61, v30, v31
  v_pk_mul_f32 v[32:33], v[32:33], v[58:59] op_sel_hi:[1,0]
  v_pk_mul_f32 v[34:35], v[34:35], v[58:59] op_sel_hi:[1,0]
  v_cvt_pk_bf16_f32 v62, v32, v33
  v_cvt_pk_bf16_f32 v63, v34, v35
  ds_write_b128 v14, v[60:63] offset:12800
  v_cmp_lt_u32 vcc, s97, v59
  v_mov_b64 v[118:119], 0
  s_cbranch_vccnz L_c_slow_s
  s_nop 0
  v_mfma_f32_32x32x8_bf16 v[100:115], v[118:119], v[118:119], 0
  s_waitcnt lgkmcnt(0)
  s_barrier
  ds_read_b128 v[92:95], v15 offset:12800
  ds_read_b128 v[96:99], v15 offset:13824
  v_mfma_f32_32x32x8_bf16 v[20:35], v[118:119], v[118:119], 0
  ds_read_b128 v[52:55], v9 offset:50176
  ds_read_b128 v[56:59], v0 offset:1024
  s_waitcnt lgkmcnt(3)
  v_smfmac_f32_16x16x64_bf16 v[104:107], v[92:95], v[84:91], v4
  ds_read_b128 v[60:63], v0 offset:17408
  s_waitcnt lgkmcnt(3)
  v_smfmac_f32_16x16x64_bf16 v[104:107], v[96:99], v[76:83], v4
  ds_read_b128 v[64:67], v0 offset:50176
  v_smfmac_f32_16x16x64_bf16 v[100:103], v[92:95], v[240:247], v4
  ds_read_b128 v[68:71], v9 offset:51200
  v_smfmac_f32_16x16x64_bf16 v[100:103], v[96:99], v[248:255], v4
  ds_read_b128 v[72:75], v0 offset:2048
  v_add_f32 v104, v104, v106
  v_smfmac_f32_16x16x64_bf16 v[108:111], v[92:95], v[208:215], v4
  ds_read_b128 v[116:119], v0 offset:18432
  v_add_f32 v105, v105, v107
  v_smfmac_f32_16x16x64_bf16 v[108:111], v[96:99], v[216:223], v4
  v_add_f32 v100, v100, v102
  v_add_f32 v101, v101, v103
  v_smfmac_f32_16x16x64_bf16 v[112:115], v[92:95], v[224:231], v4
  v_cvt_pk_bf16_f32 v86, v100, v104
  v_cvt_pk_bf16_f32 v87, v101, v105
  v_smfmac_f32_16x16x64_bf16 v[112:115], v[96:99], v[232:239], v4
  ds_read_b128 v[120:123], v0 offset:51200
  v_add_f32 v108, v108, v110
  v_add_f32 v109, v109, v111
  v_smfmac_f32_16x16x64_bf16 v[20:23], v[92:95], v[36:43], v4
  ds_read_b128 v[76:79], v9 offset:52224
  ds_read_b128 v[80:83], v0 offset:3072
  v_smfmac_f32_16x16x64_bf16 v[20:23], v[96:99], v[44:51], v4
  ds_read_b128 v[36:39], v0 offset:19456
  ds_read_b128 v[40:43], v0 offset:52224
  v_add_f32 v112, v112, v114
  v_add_f32 v113, v113, v115
  v_cvt_pk_bf16_f32 v84, v108, v112
  v_cvt_pk_bf16_f32 v85, v109, v113
  v_bfi_b32 v84, 1, s73, v84
  v_bfi_b32 v85, 1, s73, v85
  v_bfi_b32 v86, 1, s73, v86
  v_bfi_b32 v87, 1, s73, v87
  buffer_store_dwordx4 v[84:87], v5, s[52:55], 0 offen sc1
  s_waitcnt lgkmcnt(2)
  v_smfmac_f32_16x16x64_bf16 v[24:27], v[92:95], v[52:59], v4
  v_smfmac_f32_16x16x64_bf16 v[24:27], v[96:99], v[60:67], v4
  v_add_f32 v20, v20, v22
  v_smfmac_f32_16x16x64_bf16 v[28:31], v[92:95], v[68:75], v4
  v_add_f32 v21, v21, v23
  v_smfmac_f32_16x16x64_bf16 v[28:31], v[96:99], v[116:123], v4
  v_add_f32 v24, v24, v26
  v_smfmac_f32_16x16x64_bf16 v[32:35], v[92:95], v[76:83], v4
  v_add_f32 v25, v25, v27
  s_waitcnt lgkmcnt(0)
  v_smfmac_f32_16x16x64_bf16 v[32:35], v[96:99], v[36:43], v4
  v_cvt_pk_bf16_f32 v88, v20, v24
  v_cvt_pk_bf16_f32 v89, v21, v25
  v_bfi_b32 v88, 1, s73, v88
  v_add_f32 v28, v28, v30
  v_add_f32 v29, v29, v31
  s_nop 2
  v_pk_add_f32 v[32:33], v[32:33], v[34:35]
  s_nop 0
  v_cvt_pk_bf16_f32 v90, v28, v32
  v_cvt_pk_bf16_f32 v91, v29, v33
  v_bfi_b32 v89, 1, s73, v89
  v_bfi_b32 v90, 1, s73, v90
  v_bfi_b32 v91, 1, s73, v91
  buffer_store_dwordx4 v[88:91], v5, s[52:55], s64 offen sc1
  v_mov_b64 v[100:101], 0
  v_mov_b64 v[102:103], 0
  v_mov_b64 v[104:105], 0
  v_mov_b64 v[106:107], 0
  v_mov_b64 v[108:109], 0
  v_mov_b64 v[110:111], 0
  v_mov_b64 v[112:113], 0
  v_mov_b64 v[114:115], 0
  v_mov_b64 v[116:117], 0
  v_mov_b64 v[118:119], 0
  v_mov_b64 v[120:121], 0
  v_mov_b64 v[122:123], 0
  s_add_u32 s71, s71, s68
  s_cmp_eq_u32 s71, s58
  s_cselect_b32 s71, 1572864, s71
  s_add_u32 s72, s72, s68
  s_cmp_eq_u32 s72, s58
  s_cselect_b32 s72, 1572864, s72
  s_add_u32 s70, s70, 1
  s_add_u32 s60, s60, s78
  s_add_u32 s62, s62, s68
  v_mov_b32 v48, -1
  ds_read_b128 v[52:55], v9 offset:0
  ds_read_b128 v[56:59], v9 offset:1024
  ds_read_b128 v[60:63], v9 offset:2048
  ds_read_b128 v[64:67], v9 offset:3072
  ds_read_b128 v[68:71], v9 offset:16384
  ds_read_b128 v[72:75], v9 offset:17408
  s_cmp_ge_u32 s4, 2
  s_cbranch_scc1 L_c_h_152
  buffer_load_dwordx4 v[36:39], v8, s[52:55], s76 offen sc1
  buffer_load_dwordx4 v[40:43], v8, s[52:55], s76 offen offset:1024 sc1
L_c_h_152:
  ds_read_b128 v[76:79], v9 offset:18432
  ds_read_b128 v[80:83], v9 offset:19456
  ds_read_b128 v[84:87], v9 offset:32768
  ds_read_b128 v[88:91], v9 offset:33792
  ds_read_b128 v[92:95], v9 offset:34816
  ds_read_b128 v[96:99], v9 offset:35840
  s_cbranch_scc0 L_c_h_153
  s_nop 11
  buffer_load_dwordx4 v[36:39], v8, s[52:55], s76 offen sc1
  buffer_load_dwordx4 v[40:43], v8, s[52:55], s76 offen offset:1024 sc1
L_c_h_153:
  s_nop 15
  s_nop 7
  buffer_load_dwordx4 v[28:31], v8, s[52:55], s76 offen sc1
  buffer_load_dwordx4 v[32:35], v8, s[52:55], s76 offen offset:1024 sc1
  s_waitcnt vmcnt(3)
  v_mfma_f32_16x16x32_bf16 v[44:47], v[124:127], v[36:39], 0
  v_xor_b32 v49, s73, v36
  v_xor_b32 v51, s73, v37
  v_or_b32 v49, v49, v51
  v_xor_b32 v51, s73, v38
  v_or_b32 v49, v49, v51
  v_xor_b32 v51, s73, v39
  v_or_b32 v49, v49, v51
  s_waitcnt vmcnt(2)
  v_mfma_f32_16x16x32_bf16 v[44:47], v[124:127], v[40:43], v[44:47]
  v_xor_b32 v50, s73, v40
  v_xor_b32 v51, s73, v41
  v_or_b32 v50, v50, v51
  v_xor_b32 v51, s73, v42
  v_or_b32 v50, v50, v51
  v_xor_b32 v51, s73, v43
  v_or_b32 v50, v50, v51
L_c_pc_s:
  v_or_b32 v49, v49, v50
  v_and_b32 v49, 1, v49
  v_cmp_ne_u32 vcc, 0, v49
  v_add_f32_dpp v44, v44, v44 row_ror:4 row_mask:0xf bank_mask:0xf
  v_add_f32_dpp v45, v45, v45 row_ror:4 row_mask:0xf bank_mask:0xf
  s_cbranch_vccnz L_c_px_s
  v_add_f32_dpp v44, v44, v44 row_ror:8 row_mask:0xf bank_mask:0xf
  v_add_f32_dpp v45, v45, v45 row_ror:8 row_mask:0xf bank_mask:0xf
  v_cvt_pk_bf16_f32 v16, v44, v45
  v_min_u32 v16, -2, v16
  buffer_store_dword v16, v6, s[52:55], s71 offen sc1
  s_cmp_eq_u32 s70, 63
  s_cbranch_scc1 L_c_done
  buffer_load_dwordx4 v8, s[52:55], s61 offen offset:2048 sc1 lds
  buffer_load_dwordx4 v8, s[52:55], s61 offen offset:3072 sc1 lds
  s_add_u32 s61, s61, s78
  buffer_store_dword v48, v6, s[52:55], s72 offen sc1
  s_xor_b32 s73, s73, 1
  s_mov_b32 s100, 0
L_kv_lp_155:
  v_readfirstlane_b32 s57, v17
  s_nop 0
  s_cmp_gt_u32 s57, s75
  s_cbranch_scc1 L_kv_ok_154
  s_sub_u32 s56, s56, 1
  s_cbranch_scc1 L_timeout
  buffer_load_dword v17, off, s[52:55], s74 sc1
  s_waitcnt vmcnt(0)
  s_branch L_kv_lp_155
L_kv_ok_154:
  v_mov_b32 v17, 0
  s_add_u32 s74, s74, s66
  s_bitcmp1_b32 s74, 13
  s_addc_u32 s75, s75, 0
  s_bitset0_b32 s74, 13
  s_min_u32 s75, s75, 31
  s_nop 11
  s_cmp_ge_u32 s4, 2
  s_cbranch_scc1 L_c_ld_s
  s_nop 15
  s_nop 15
  s_branch L_c_ld_s
L_c_slow_s:
  s_branch L_c_slow2_s
L_c_px_s:
  s_sub_u32 s56, s56, 1
  s_cbranch_scc1 L_timeout
  s_xor_b32 s100, s100, 1
  s_bitcmp1_b32 s100, 0
  s_cbranch_scc0 L_c_py_s
  buffer_load_dwordx4 v[36:39], v8, s[52:55], s76 offen sc1
  buffer_load_dwordx4 v[40:43], v8, s[52:55], s76 offen offset:1024 sc1
  s_waitcnt vmcnt(2)
  v_mfma_f32_16x16x32_bf16 v[44:47], v[124:127], v[28:31], 0
  v_xor_b32 v49, s73, v28
  v_xor_b32 v51, s73, v29
  v_or_b32 v49, v49, v51
  v_xor_b32 v51, s73, v30
  v_or_b32 v49, v49, v51
  v_xor_b32 v51, s73, v31
  v_or_b32 v49, v49, v51
  v_mfma_f32_16x16x32_bf16 v[44:47], v[124:127], v[32:35], v[44:47]
  v_xor_b32 v50, s73, v32
  v_xor_b32 v51, s73, v33
  v_or_b32 v50, v50, v51
  v_xor_b32 v51, s73, v34
  v_or_b32 v50, v50, v51
  v_xor_b32 v51, s73, v35
  v_or_b32 v50, v50, v51
  s_branch L_c_pc_s
L_c_py_s:
  buffer_load_dwordx4 v[28:31], v8, s[52:55], s76 offen sc1
  buffer_load_dwordx4 v[32:35], v8, s[52:55], s76 offen offset:1024 sc1
  s_waitcnt vmcnt(2)
  v_mfma_f32_16x16x32_bf16 v[44:47], v[124:127], v[36:39], 0
  v_xor_b32 v49, s73, v36
  v_xor_b32 v51, s73, v37
  v_or_b32 v49, v49, v51
  v_xor_b32 v51, s73, v38
  v_or_b32 v49, v49, v51
  v_xor_b32 v51, s73, v39
  v_or_b32 v49, v49, v51
  v_mfma_f32_16x16x32_bf16 v[44:47], v[124:127], v[40:43], v[44:47]
  v_xor_b32 v50, s73, v40
  v_xor_b32 v51, s73, v41
  v_or_b32 v50, v50, v51
  v_xor_b32 v51, s73, v42
  v_or_b32 v50, v50, v51
  v_xor_b32 v51, s73, v43
  v_or_b32 v50, v50, v51
  s_branch L_c_pc_s
L_c_x0_s:
  s_sub_u32 s56, s56, 1
  s_cbranch_scc1 L_timeout
  s_waitcnt vmcnt(0) lgkmcnt(0)
  s_nop 3
  v_mov_b64 v[100:101], 0
  v_mov_b64 v[102:103], 0
  v_mov_b64 v[104:105], 0
  v_mov_b64 v[106:107], 0
  v_mov_b64 v[108:109], 0
  v_mov_b64 v[110:111], 0
  v_mov_b64 v[112:113], 0
  v_mov_b64 v[114:115], 0
  s_branch L_c_ld_s
L_c_x1_s:
  s_sub_u32 s56, s56, 1
  s_cbranch_scc1 L_timeout
  s_xor_b32 s100, s100, 2
  s_bitcmp1_b32 s100, 1
  s_cbranch_scc0 L_c_y1_s
  buffer_load_dwordx4 v[44:47], v7, s[52:55], s71 offen offset:1024 sc1
  s_waitcnt vmcnt(1) lgkmcnt(0)
  v_max3_u32 v40, v48, v49, v50
  v_max_u32 v40, v40, v51
  v_cmp_eq_u32 vcc, -1, v40
  v_mov_b64 v[24:25], v[48:49]
  v_mov_b64 v[26:27], v[50:51]
  ds_write_b128 v7, v[24:27] offset:1024
  s_cbranch_vccnz L_c_x1_s
  s_branch L_c_r1_s
L_c_y1_s:
  buffer_load_dwordx4 v[48:51], v7, s[52:55], s71 offen offset:1024 sc1
  s_waitcnt vmcnt(1) lgkmcnt(0)
  v_max3_u32 v40, v44, v45, v46
  v_max_u32 v40, v40, v47
  v_cmp_eq_u32 vcc, -1, v40
  v_mov_b64 v[24:25], v[44:45]
  v_mov_b64 v[26:27], v[46:47]
  ds_write_b128 v7, v[24:27] offset:1024
  s_cbranch_vccnz L_c_x1_s
  s_branch L_c_r1_s
L_c_slow2_s:
  s_sub_u32 s57, s60, s78
  s_waitcnt lgkmcnt(0)
  ds_read_b64_tr_b16 v[84:85], v11 offset:8192
  ds_read_b64_tr_b16 v[86:87], v11 offset:8224
  ds_read_b64_tr_b16 v[88:89], v11 offset:8768
  ds_read_b64_tr_b16 v[90:91], v11 offset:8800
  s_waitcnt lgkmcnt(0)
  buffer_load_dwordx4 v[28:31], v8, s[52:55], s57 offen offset:0 sc1
  buffer_load_dwordx4 v[32:35], v8, s[52:55], s57 offen offset:1024 sc1
  s_waitcnt vmcnt(0)
  v_mfma_f32_16x16x32_bf16 v[24:27], v[28:31], v[84:87], 0
  v_mfma_f32_16x16x32_bf16 v[24:27], v[32:35], v[88:91], v[24:27]
  s_nop 7
  buffer_load_dwordx4 v[28:31], v8, s[52:55], s57 offen offset:2048 sc1
  buffer_load_dwordx4 v[32:35], v8, s[52:55], s57 offen offset:3072 sc1
  s_waitcnt vmcnt(0)
  v_mfma_f32_16x16x32_bf16 v[24:27], v[28:31], v[92:95], v[24:27]
  v_mfma_f32_16x16x32_bf16 v[24:27], v[32:35], v[96:99], v[24:27]
  s_nop 7
  s_add_u32 s57, s57, 4096
  buffer_load_dwordx4 v[28:31], v8, s[52:55], s57 offen offset:0 sc1
  buffer_load_dwordx4 v[32:35], v8, s[52:55], s57 offen offset:1024 sc1
  s_waitcnt vmcnt(0)
  v_mfma_f32_16x16x32_bf16 v[60:63], v[28:31], v[84:87], 0
  v_mfma_f32_16x16x32_bf16 v[60:63], v[32:35], v[88:91], v[60:63]
  s_nop 7
  buffer_load_dwordx4 v[28:31], v8, s[52:55], s57 offen offset:2048 sc1
  buffer_load_dwordx4 v[32:35], v8, s[52:55], s57 offen offset:3072 sc1
  s_waitcnt vmcnt(0)
  v_mfma_f32_16x16x32_bf16 v[60:63], v[28:31], v[92:95], v[60:63]
  v_mfma_f32_16x16x32_bf16 v[60:63], v[32:35], v[96:99], v[60:63]
  s_nop 7
  s_add_u32 s57, s57, 4096
  v_mov_b64 v[20:21], 0
  v_mov_b64 v[22:23], 0
  s_nop 1
  v_smfmac_f32_16x16x64_bf16 v[20:23], v[100:103], v[84:91], v4
  v_smfmac_f32_16x16x64_bf16 v[20:23], v[104:107], v[92:99], v4
  s_nop 7
  v_add_f32 v20, v20, v22
  v_add_f32 v21, v21, v23
  v_max_f32 v58, v20, v21
  v_max3_f32 v58, v58, v24, v25
  v_max3_f32 v58, v58, v26, v27
  v_max3_f32 v58, v58, v60, v61
  v_max3_f32 v58, v58, v62, v63
  v_mov_b32 v59, v58
  s_nop 1
  v_permlane16_swap_b32 v58, v59
  v_max_f32 v58, v58, v59
  v_mov_b32 v59, v58
  s_nop 1
  v_permlane32_swap_b32 v58, v59
  v_max_f32 v58, v58, v59
  v_sub_f32 v20, v20, v58
  v_exp_f32 v20, v20
  v_sub_f32 v21, v21, v58
  v_exp_f32 v21, v21
  v_sub_f32 v24, v24, v58
  v_exp_f32 v24, v24
  v_sub_f32 v25, v25, v58
  v_exp_f32 v25, v25
  v_sub_f32 v26, v26, v58
  v_exp_f32 v26, v26
  v_sub_f32 v27, v27, v58
  v_exp_f32 v27, v27
  v_sub_f32 v60, v60, v58
  v_exp_f32 v60, v60
  v_sub_f32 v61, v61, v58
  v_exp_f32 v61, v61
  v_sub_f32 v62, v62, v58
  v_exp_f32 v62, v62
  v_sub_f32 v63, v63, v58
  v_exp_f32 v63, v63
  v_cvt_pk_bf16_f32 v52, v24, v25
  v_cvt_pk_bf16_f32 v53, v26, v27
  v_cvt_pk_bf16_f32 v54, v60, v61
  v_cvt_pk_bf16_f32 v55, v62, v63
  v_cvt_pk_bf16_f32 v56, v20, v21
  s_nop 0
  v_mfma_f32_16x16x32_bf16 v[60:63], v[124:127], v[52:55], 0
  v_mfma_f32_16x16x32_bf16 v[28:31], v[68:71], v[52:55], 0
  v_mfma_f32_16x16x32_bf16 v[32:35], v[72:75], v[52:55], 0
  v_mfma_f32_16x16x16_bf16 v[60:63], v[124:125], v[56:57], v[60:63]
  v_mfma_f32_16x16x16_bf16 v[28:31], v[116:117], v[56:57], v[28:31]
  v_mfma_f32_16x16x16_bf16 v[32:35], v[120:121], v[56:57], v[32:35]
  ds_read_b128 v[84:87], v0 offset:32768
  ds_read_b128 v[88:91], v0 offset:33792
  v_rcp_f32 v58, v62
  v_mov_b32 v59, 0
  s_nop 7
  s_branch L_c_norm_s
L_c_done:
  buffer_store_dword v16, v6, s[52:55], s62 offen sc1
  s_endpgm
L_bworker:
  s_sub_u32 s60, s5, 5
  s_lshl_b32 s70, s60, 2
  s_add_u32 s70, s70, s4
  s_mov_b32 s96, 0xffff0000
  s_mov_b32 s97, 0xffff0000
  v_lshrrev_b32 v1, 1, v0
  v_mul_u32_u24 v1, 3072, v1
  v_and_b32 v2, 1, v0
  v_lshl_add_u32 v1, v2, 4, v1
  s_lshl_b32 s61, s6, 5
  s_mul_i32 s62, s4, 393216
  s_add_u32 s61, s61, s62
  v_add_u32 v1, s61, v1
  s_lshl_b32 s63, s4, 12
  s_add_u32 m0, s63, 0
  s_mov_b32 s61, 0
  buffer_load_dwordx4 v1, s[36:39], s61 offen lds
  s_add_u32 m0, s63, 1024
  s_mov_b32 s61, 98304
  buffer_load_dwordx4 v1, s[36:39], s61 offen lds
  s_add_u32 m0, s63, 2048
  s_mov_b32 s61, 196608
  buffer_load_dwordx4 v1, s[36:39], s61 offen lds
  s_add_u32 m0, s63, 3072
  s_mov_b32 s61, 294912
  buffer_load_dwordx4 v1, s[36:39], s61 offen lds
  s_add_u32 m0, s63, 16512
  s_mov_b32 s61, 1024
  buffer_load_dwordx4 v1, s[36:39], s61 offen lds
  s_add_u32 m0, s63, 17536
  s_mov_b32 s61, 99328
  buffer_load_dwordx4 v1, s[36:39], s61 offen lds
  s_add_u32 m0, s63, 18560
  s_mov_b32 s61, 197632
  buffer_load_dwordx4 v1, s[36:39], s61 offen lds
  s_add_u32 m0, s63, 19584
  s_mov_b32 s61, 295936
  buffer_load_dwordx4 v1, s[36:39], s61 offen lds
  s_add_u32 m0, s63, 33024
  s_mov_b32 s61, 2048
  buffer_load_dwordx4 v1, s[36:39], s61 offen lds
  s_add_u32 m0, s63, 34048
  s_mov_b32 s61, 100352
  buffer_load_dwordx4 v1, s[36:39], s61 offen lds
  s_add_u32 m0, s63, 35072
  s_mov_b32 s61, 198656
  buffer_load_dwordx4 v1, s[36:39], s61 offen lds
  s_add_u32 m0, s63, 36096
  s_mov_b32 s61, 296960
  buffer_load_dwordx4 v1, s[36:39], s61 offen lds
  v_lshrrev_b32 v1, 2, v0
  v_lshlrev_b32 v1, 10, v1
  v_and_b32 v2, 3, v0
  v_lshl_add_u32 v1, v2, 4, v1
  s_and_b32 s61, s6, 15
  s_lshl_b32 s61, s61, 6
  s_lshl_b32 s62, s4, 17
  s_add_u32 s61, s61, s62
  v_add_u32 v1, s61, v1
  s_lshl_b32 s63, s4, 13
  s_add_u32 m0, s63, 131072
  s_mov_b32 s61, 0
  buffer_load_dwordx4 v1, s[40:43], s61 offen lds
  s_add_u32 m0, s63, 132096
  s_mov_b32 s61, 16384
  buffer_load_dwordx4 v1, s[40:43], s61 offen lds
  s_add_u32 m0, s63, 133120
  s_mov_b32 s61, 32768
  buffer_load_dwordx4 v1, s[40:43], s61 offen lds
  s_add_u32 m0, s63, 134144
  s_mov_b32 s61, 49152
  buffer_load_dwordx4 v1, s[40:43], s61 offen lds
  s_add_u32 m0, s63, 135168
  s_mov_b32 s61, 65536
  buffer_load_dwordx4 v1, s[40:43], s61 offen lds
  s_add_u32 m0, s63, 136192
  s_mov_b32 s61, 81920
  buffer_load_dwordx4 v1, s[40:43], s61 offen lds
  s_add_u32 m0, s63, 137216
  s_mov_b32 s61, 98304
  buffer_load_dwordx4 v1, s[40:43], s61 offen lds
  s_add_u32 m0, s63, 138240
  s_mov_b32 s61, 114688
  buffer_load_dwordx4 v1, s[40:43], s61 offen lds
  v_lshlrev_b32 v4, 4, v0
  v_and_b32 v1, 31, v0
  v_lshrrev_b32 v2, 5, v0
  v_lshlrev_b32 v3, 10, v1
  v_lshl_add_u32 v5, v2, 4, v3
  v_bfe_u32 v3, v0, 2, 2
  v_lshl_add_u32 v3, v2, 3, v3
  v_lshlrev_b32 v3, 5, v3
  v_and_b32 v15, 3, v0
  v_lshl_add_u32 v3, v15, 3, v3
  v_add_u32 v7, 33024, v3
  v_bfe_u32 v16, v0, 4, 1
  v_mul_u32_u24 v17, 16512, v16
  v_add_u32 v6, v17, v3
  v_bfe_u32 v3, v0, 2, 2
  v_lshl_add_u32 v3, v2, 2, v3
  v_lshlrev_b32 v3, 6, v3
  v_and_b32 v17, 1, v0
  v_lshl_add_u32 v3, v17, 5, v3
  v_lshl_add_u32 v3, v16, 4, v3
  v_bfe_u32 v17, v0, 1, 1
  v_lshl_add_u32 v3, v17, 3, v3
  v_add_u32 v13, 131072, v3
  s_lshl_b32 s61, s6, 16
  v_add_u32 v8, s61, v4
  v_and_b32 v3, 15, v0
  v_lshl_add_u32 v3, v2, 5, v3
  v_lshlrev_b32 v3, 4, v3
  v_add_u32 v9, 65536, v3
  s_lshl_b32 s61, s6, 10
  v_add_u32 v11, s61, v4
  v_lshlrev_b32 v3, 11, v1
  v_lshl_add_u32 v3, v2, 5, v3
  s_and_b32 s61, s6, 15
  s_lshl_b32 s61, s61, 6
  s_add_u32 s61, s61, 1024
  v_add_u32 v12, s61, v3
  v_mov_b32 v14, 0x3f803f80
  s_mov_b32 s79, 0x3eb8aa3b
  s_waitcnt vmcnt(0)
  s_barrier
  ds_read_b64_tr_b16 a[0:1], v6 offset:0
  ds_read_b64_tr_b16 a[128:129], v7 offset:0
  ds_read_b64_tr_b16 a[2:3], v6 offset:128
  ds_read_b64_tr_b16 a[130:131], v7 offset:128
  ds_read_b64_tr_b16 a[4:5], v6 offset:512
  ds_read_b64_tr_b16 a[132:133], v7 offset:512
  ds_read_b64_tr_b16 a[6:7], v6 offset:640
  ds_read_b64_tr_b16 a[134:135], v7 offset:640
  s_waitcnt lgkmcnt(0)
  ds_read_b64_tr_b16 a[8:9], v6 offset:1024
  ds_read_b64_tr_b16 a[136:137], v7 offset:1024
  ds_read_b64_tr_b16 a[10:11], v6 offset:1152
  ds_read_b64_tr_b16 a[138:139], v7 offset:1152
  ds_read_b64_tr_b16 a[12:13], v6 offset:1536
  ds_read_b64_tr_b16 a[140:141], v7 offset:1536
  ds_read_b64_tr_b16 a[14:15], v6 offset:1664
  ds_read_b64_tr_b16 a[142:143], v7 offset:1664
  s_waitcnt lgkmcnt(0)
  ds_read_b64_tr_b16 a[16:17], v6 offset:2048
  ds_read_b64_tr_b16 a[144:145], v7 offset:2048
  ds_read_b64_tr_b16 a[18:19], v6 offset:2176
  ds_read_b64_tr_b16 a[146:147], v7 offset:2176
  ds_read_b64_tr_b16 a[20:21], v6 offset:2560
  ds_read_b64_tr_b16 a[148:149], v7 offset:2560
  ds_read_b64_tr_b16 a[22:23], v6 offset:2688
  ds_read_b64_tr_b16 a[150:151], v7 offset:2688
  s_waitcnt lgkmcnt(0)
  ds_read_b64_tr_b16 a[24:25], v6 offset:3072
  ds_read_b64_tr_b16 a[152:153], v7 offset:3072
  ds_read_b64_tr_b16 a[26:27], v6 offset:3200
  ds_read_b64_tr_b16 a[154:155], v7 offset:3200
  ds_read_b64_tr_b16 a[28:29], v6 offset:3584
  ds_read_b64_tr_b16 a[156:157], v7 offset:3584
  ds_read_b64_tr_b16 a[30:31], v6 offset:3712
  ds_read_b64_tr_b16 a[158:159], v7 offset:3712
  s_waitcnt lgkmcnt(0)
  ds_read_b64_tr_b16 a[32:33], v6 offset:4096
  ds_read_b64_tr_b16 a[160:161], v7 offset:4096
  ds_read_b64_tr_b16 a[34:35], v6 offset:4224
  ds_read_b64_tr_b16 a[162:163], v7 offset:4224
  ds_read_b64_tr_b16 a[36:37], v6 offset:4608
  ds_read_b64_tr_b16 a[164:165], v7 offset:4608
  ds_read_b64_tr_b16 a[38:39], v6 offset:4736
  ds_read_b64_tr_b16 a[166:167], v7 offset:4736
  s_waitcnt lgkmcnt(0)
  ds_read_b64_tr_b16 a[40:41], v6 offset:5120
  ds_read_b64_tr_b16 a[168:169], v7 offset:5120
  ds_read_b64_tr_b16 a[42:43], v6 offset:5248
  ds_read_b64_tr_b16 a[170:171], v7 offset:5248
  ds_read_b64_tr_b16 a[44:45], v6 offset:5632
  ds_read_b64_tr_b16 a[172:173], v7 offset:5632
  ds_read_b64_tr_b16 a[46:47], v6 offset:5760
  ds_read_b64_tr_b16 a[174:175], v7 offset:5760
  s_waitcnt lgkmcnt(0)
  ds_read_b64_tr_b16 a[48:49], v6 offset:6144
  ds_read_b64_tr_b16 a[176:177], v7 offset:6144
  ds_read_b64_tr_b16 a[50:51], v6 offset:6272
  ds_read_b64_tr_b16 a[178:179], v7 offset:6272
  ds_read_b64_tr_b16 a[52:53], v6 offset:6656
  ds_read_b64_tr_b16 a[180:181], v7 offset:6656
  ds_read_b64_tr_b16 a[54:55], v6 offset:6784
  ds_read_b64_tr_b16 a[182:183], v7 offset:6784
  s_waitcnt lgkmcnt(0)
  ds_read_b64_tr_b16 a[56:57], v6 offset:7168
  ds_read_b64_tr_b16 a[184:185], v7 offset:7168
  ds_read_b64_tr_b16 a[58:59], v6 offset:7296
  ds_read_b64_tr_b16 a[186:187], v7 offset:7296
  ds_read_b64_tr_b16 a[60:61], v6 offset:7680
  ds_read_b64_tr_b16 a[188:189], v7 offset:7680
  ds_read_b64_tr_b16 a[62:63], v6 offset:7808
  ds_read_b64_tr_b16 a[190:191], v7 offset:7808
  s_waitcnt lgkmcnt(0)
  ds_read_b64_tr_b16 a[64:65], v6 offset:8192
  ds_read_b64_tr_b16 a[192:193], v7 offset:8192
  ds_read_b64_tr_b16 a[66:67], v6 offset:8320
  ds_read_b64_tr_b16 a[194:195], v7 offset:8320
  ds_read_b64_tr_b16 a[68:69], v6 offset:8704
  ds_read_b64_tr_b16 a[196:197], v7 offset:8704
  ds_read_b64_tr_b16 a[70:71], v6 offset:8832
  ds_read_b64_tr_b16 a[198:199], v7 offset:8832
  s_waitcnt lgkmcnt(0)
  ds_read_b64_tr_b16 a[72:73], v6 offset:9216
  ds_read_b64_tr_b16 a[200:201], v7 offset:9216
  ds_read_b64_tr_b16 a[74:75], v6 offset:9344
  ds_read_b64_tr_b16 a[202:203], v7 offset:9344
  ds_read_b64_tr_b16 a[76:77], v6 offset:9728
  ds_read_b64_tr_b16 a[204:205], v7 offset:9728
  ds_read_b64_tr_b16 a[78:79], v6 offset:9856
  ds_read_b64_tr_b16 a[206:207], v7 offset:9856
  s_waitcnt lgkmcnt(0)
  ds_read_b64_tr_b16 a[80:81], v6 offset:10240
  ds_read_b64_tr_b16 a[208:209], v7 offset:10240
  ds_read_b64_tr_b16 a[82:83], v6 offset:10368
  ds_read_b64_tr_b16 a[210:211], v7 offset:10368
  ds_read_b64_tr_b16 a[84:85], v6 offset:10752
  ds_read_b64_tr_b16 a[212:213], v7 offset:10752
  ds_read_b64_tr_b16 a[86:87], v6 offset:10880
  ds_read_b64_tr_b16 a[214:215], v7 offset:10880
  s_waitcnt lgkmcnt(0)
  ds_read_b64_tr_b16 a[88:89], v6 offset:11264
  ds_read_b64_tr_b16 a[216:217], v7 offset:11264
  ds_read_b64_tr_b16 a[90:91], v6 offset:11392
  ds_read_b64_tr_b16 a[218:219], v7 offset:11392
  ds_read_b64_tr_b16 a[92:93], v6 offset:11776
  ds_read_b64_tr_b16 a[220:221], v7 offset:11776
  ds_read_b64_tr_b16 a[94:95], v6 offset:11904
  ds_read_b64_tr_b16 a[222:223], v7 offset:11904
  s_waitcnt lgkmcnt(0)
  ds_read_b64_tr_b16 a[96:97], v6 offset:12288
  ds_read_b64_tr_b16 a[224:225], v7 offset:12288
  ds_read_b64_tr_b16 a[98:99], v6 offset:12416
  ds_read_b64_tr_b16 a[226:227], v7 offset:12416
  ds_read_b64_tr_b16 a[100:101], v6 offset:12800
  ds_read_b64_tr_b16 a[228:229], v7 offset:12800
  ds_read_b64_tr_b16 a[102:103], v6 offset:12928
  ds_read_b64_tr_b16 a[230:231], v7 offset:12928
  s_waitcnt lgkmcnt(0)
  ds_read_b64_tr_b16 a[104:105], v6 offset:13312
  ds_read_b64_tr_b16 a[232:233], v7 offset:13312
  ds_read_b64_tr_b16 a[106:107], v6 offset:13440
  ds_read_b64_tr_b16 a[234:235], v7 offset:13440
  ds_read_b64_tr_b16 a[108:109], v6 offset:13824
  ds_read_b64_tr_b16 a[236:237], v7 offset:13824
  ds_read_b64_tr_b16 a[110:111], v6 offset:13952
  ds_read_b64_tr_b16 a[238:239], v7 offset:13952
  s_waitcnt lgkmcnt(0)
  ds_read_b64_tr_b16 a[112:113], v6 offset:14336
  ds_read_b64_tr_b16 a[240:241], v7 offset:14336
  ds_read_b64_tr_b16 a[114:115], v6 offset:14464
  ds_read_b64_tr_b16 a[242:243], v7 offset:14464
  ds_read_b64_tr_b16 a[116:117], v6 offset:14848
  ds_read_b64_tr_b16 a[244:245], v7 offset:14848
  ds_read_b64_tr_b16 a[118:119], v6 offset:14976
  ds_read_b64_tr_b16 a[246:247], v7 offset:14976
  s_waitcnt lgkmcnt(0)
  ds_read_b64_tr_b16 a[120:121], v6 offset:15360
  ds_read_b64_tr_b16 a[248:249], v7 offset:15360
  ds_read_b64_tr_b16 a[122:123], v6 offset:15488
  ds_read_b64_tr_b16 a[250:251], v7 offset:15488
  ds_read_b64_tr_b16 a[124:125], v6 offset:15872
  ds_read_b64_tr_b16 a[252:253], v7 offset:15872
  ds_read_b64_tr_b16 a[126:127], v6 offset:16000
  ds_read_b64_tr_b16 a[254:255], v7 offset:16000
  s_waitcnt lgkmcnt(0)
  v_and_b32 v1, 31, v0
  v_lshrrev_b32 v2, 5, v0
  v_xor_b32 v3, v1, v2
  v_lshlrev_b32 v3, 4, v3
  v_lshl_add_u32 v96, v2, 10, v3
  v_xor_b32 v97, 32, v96
  v_xor_b32 v98, 64, v96
  v_xor_b32 v99, 96, v96
  v_xor_b32 v100, 128, v96
  v_xor_b32 v101, 160, v96
  v_xor_b32 v102, 192, v96
  v_xor_b32 v103, 224, v96
  v_and_b32 v3, 15, v0
  v_xor_b32 v3, v3, v2
  v_lshlrev_b32 v3, 4, v3
  v_lshl_add_u32 v3, v1, 9, v3
  s_lshl_b32 s74, s4, 15
  v_add_u32 v104, s74, v3
  v_xor_b32 v105, 32, v104
  v_xor_b32 v106, 64, v104
  v_xor_b32 v107, 96, v104
  v_xor_b32 v108, 128, v104
  v_xor_b32 v109, 160, v104
  v_xor_b32 v110, 192, v104
  v_xor_b32 v111, 224, v104
  s_waitcnt lgkmcnt(0)
  s_barrier
  s_mov_b32 s72, s70
  s_add_u32 s75, s70, 0
  s_min_u32 s75, s75, 63
  s_lshl_b32 s75, s75, 15
  s_add_u32 m0, s74, 0
  s_add_u32 s61, s75, 0
  buffer_load_dwordx4 v96, s[32:35], s61 offen lds
  s_add_u32 m0, s74, 1024
  s_add_u32 s61, s75, 2048
  buffer_load_dwordx4 v97, s[32:35], s61 offen lds
  s_add_u32 m0, s74, 2048
  s_add_u32 s61, s75, 4096
  buffer_load_dwordx4 v98, s[32:35], s61 offen lds
  s_add_u32 m0, s74, 3072
  s_add_u32 s61, s75, 6144
  buffer_load_dwordx4 v99, s[32:35], s61 offen lds
  s_add_u32 m0, s74, 4096
  s_add_u32 s61, s75, 8192
  buffer_load_dwordx4 v100, s[32:35], s61 offen lds
  s_add_u32 m0, s74, 5120
  s_add_u32 s61, s75, 10240
  buffer_load_dwordx4 v101, s[32:35], s61 offen lds
  s_add_u32 m0, s74, 6144
  s_add_u32 s61, s75, 12288
  buffer_load_dwordx4 v102, s[32:35], s61 offen lds
  s_add_u32 m0, s74, 7168
  s_add_u32 s61, s75, 14336
  buffer_load_dwordx4 v103, s[32:35], s61 offen lds
  s_add_u32 m0, s74, 8192
  s_add_u32 s61, s75, 16384
  buffer_load_dwordx4 v96, s[32:35], s61 offen lds
  s_add_u32 m0, s74, 9216
  s_add_u32 s61, s75, 18432
  buffer_load_dwordx4 v97, s[32:35], s61 offen lds
  s_add_u32 m0, s74, 10240
  s_add_u32 s61, s75, 20480
  buffer_load_dwordx4 v98, s[32:35], s61 offen lds
  s_add_u32 m0, s74, 11264
  s_add_u32 s61, s75, 22528
  buffer_load_dwordx4 v99, s[32:35], s61 offen lds
  s_add_u32 m0, s74, 12288
  s_add_u32 s61, s75, 24576
  buffer_load_dwordx4 v100, s[32:35], s61 offen lds
  s_add_u32 m0, s74, 13312
  s_add_u32 s61, s75, 26624
  buffer_load_dwordx4 v101, s[32:35], s61 offen lds
  s_add_u32 m0, s74, 14336
  s_add_u32 s61, s75, 28672
  buffer_load_dwordx4 v102, s[32:35], s61 offen lds
  s_add_u32 m0, s74, 15360
  s_add_u32 s61, s75, 30720
  buffer_load_dwordx4 v103, s[32:35], s61 offen lds
  s_min_u32 s73, s72, 63
  s_waitcnt vmcnt(0)
  ds_read_b128 v[128:131], v104 offset:0
  ds_read_b128 v[132:135], v105 offset:0
  ds_read_b128 v[136:139], v106 offset:0
  s_add_u32 s75, s70, 0
  s_min_u32 s75, s75, 63
  s_lshl_b32 s75, s75, 15
  s_waitcnt lgkmcnt(2)
  v_mfma_f32_32x32x16_bf16 v[64:79], a[0:3], v[128:131], 0
  ds_read_b128 v[140:143], v107 offset:0
  s_add_u32 m0, s74, 16384
  s_add_u32 s61, s75, 512
  buffer_load_dwordx4 v96, s[32:35], s61 offen lds
  v_mfma_f32_32x32x16_bf16 v[80:95], v[128:131], a[128:131], 0
  s_waitcnt lgkmcnt(2)
  v_mfma_f32_32x32x16_bf16 v[64:79], a[4:7], v[132:135], v[64:79]
  ds_read_b128 v[128:131], v108 offset:0
  s_add_u32 m0, s74, 17408
  s_add_u32 s61, s75, 2560
  buffer_load_dwordx4 v97, s[32:35], s61 offen lds
  v_mfma_f32_32x32x16_bf16 v[80:95], v[132:135], a[132:135], v[80:95]
  s_waitcnt lgkmcnt(2)
  v_mfma_f32_32x32x16_bf16 v[64:79], a[8:11], v[136:139], v[64:79]
  ds_read_b128 v[132:135], v109 offset:0
  s_add_u32 m0, s74, 18432
  s_add_u32 s61, s75, 4608
  buffer_load_dwordx4 v98, s[32:35], s61 offen lds
  v_mfma_f32_32x32x16_bf16 v[80:95], v[136:139], a[136:139], v[80:95]
  s_waitcnt lgkmcnt(2)
  v_mfma_f32_32x32x16_bf16 v[64:79], a[12:15], v[140:143], v[64:79]
  ds_read_b128 v[136:139], v110 offset:0
  s_add_u32 m0, s74, 19456
  s_add_u32 s61, s75, 6656
  buffer_load_dwordx4 v99, s[32:35], s61 offen lds
  v_mfma_f32_32x32x16_bf16 v[80:95], v[140:143], a[140:143], v[80:95]
  s_waitcnt lgkmcnt(2)
  v_mfma_f32_32x32x16_bf16 v[64:79], a[16:19], v[128:131], v[64:79]
  ds_read_b128 v[140:143], v111 offset:0
  s_add_u32 m0, s74, 20480
  s_add_u32 s61, s75, 8704
  buffer_load_dwordx4 v100, s[32:35], s61 offen lds
  v_mfma_f32_32x32x16_bf16 v[80:95], v[128:131], a[144:147], v[80:95]
  s_waitcnt lgkmcnt(2)
  v_mfma_f32_32x32x16_bf16 v[64:79], a[20:23], v[132:135], v[64:79]
  ds_read_b128 v[128:131], v104 offset:256
  s_add_u32 m0, s74, 21504
  s_add_u32 s61, s75, 10752
  buffer_load_dwordx4 v101, s[32:35], s61 offen lds
  v_mfma_f32_32x32x16_bf16 v[80:95], v[132:135], a[148:151], v[80:95]
  s_waitcnt lgkmcnt(2)
  v_mfma_f32_32x32x16_bf16 v[64:79], a[24:27], v[136:139], v[64:79]
  ds_read_b128 v[132:135], v105 offset:256
  s_add_u32 m0, s74, 22528
  s_add_u32 s61, s75, 12800
  buffer_load_dwordx4 v102, s[32:35], s61 offen lds
  v_mfma_f32_32x32x16_bf16 v[80:95], v[136:139], a[152:155], v[80:95]
  s_waitcnt lgkmcnt(2)
  v_mfma_f32_32x32x16_bf16 v[64:79], a[28:31], v[140:143], v[64:79]
  ds_read_b128 v[136:139], v106 offset:256
  s_add_u32 m0, s74, 23552
  s_add_u32 s61, s75, 14848
  buffer_load_dwordx4 v103, s[32:35], s61 offen lds
  v_mfma_f32_32x32x16_bf16 v[80:95], v[140:143], a[156:159], v[80:95]
  s_waitcnt lgkmcnt(2)
  v_mfma_f32_32x32x16_bf16 v[64:79], a[32:35], v[128:131], v[64:79]
  ds_read_b128 v[140:143], v107 offset:256
  s_add_u32 m0, s74, 24576
  s_add_u32 s61, s75, 16896
  buffer_load_dwordx4 v96, s[32:35], s61 offen lds
  v_mfma_f32_32x32x16_bf16 v[80:95], v[128:131], a[160:163], v[80:95]
  s_waitcnt lgkmcnt(2)
  v_mfma_f32_32x32x16_bf16 v[64:79], a[36:39], v[132:135], v[64:79]
  ds_read_b128 v[128:131], v108 offset:256
  s_add_u32 m0, s74, 25600
  s_add_u32 s61, s75, 18944
  buffer_load_dwordx4 v97, s[32:35], s61 offen lds
  v_mfma_f32_32x32x16_bf16 v[80:95], v[132:135], a[164:167], v[80:95]
  s_waitcnt lgkmcnt(2)
  v_mfma_f32_32x32x16_bf16 v[64:79], a[40:43], v[136:139], v[64:79]
  ds_read_b128 v[132:135], v109 offset:256
  s_add_u32 m0, s74, 26624
  s_add_u32 s61, s75, 20992
  buffer_load_dwordx4 v98, s[32:35], s61 offen lds
  v_mfma_f32_32x32x16_bf16 v[80:95], v[136:139], a[168:171], v[80:95]
  s_waitcnt lgkmcnt(2)
  v_mfma_f32_32x32x16_bf16 v[64:79], a[44:47], v[140:143], v[64:79]
  ds_read_b128 v[136:139], v110 offset:256
  s_add_u32 m0, s74, 27648
  s_add_u32 s61, s75, 23040
  buffer_load_dwordx4 v99, s[32:35], s61 offen lds
  v_mfma_f32_32x32x16_bf16 v[80:95], v[140:143], a[172:175], v[80:95]
  s_waitcnt lgkmcnt(2)
  v_mfma_f32_32x32x16_bf16 v[64:79], a[48:51], v[128:131], v[64:79]
  ds_read_b128 v[140:143], v111 offset:256
  s_add_u32 m0, s74, 28672
  s_add_u32 s61, s75, 25088
  buffer_load_dwordx4 v100, s[32:35], s61 offen lds
  v_mfma_f32_32x32x16_bf16 v[80:95], v[128:131], a[176:179], v[80:95]
  s_waitcnt lgkmcnt(2)
  v_mfma_f32_32x32x16_bf16 v[64:79], a[52:55], v[132:135], v[64:79]
  s_add_u32 m0, s74, 29696
  s_add_u32 s61, s75, 27136
  buffer_load_dwordx4 v101, s[32:35], s61 offen lds
  v_mfma_f32_32x32x16_bf16 v[80:95], v[132:135], a[180:183], v[80:95]
  s_waitcnt lgkmcnt(1)
  v_mfma_f32_32x32x16_bf16 v[64:79], a[56:59], v[136:139], v[64:79]
  s_add_u32 m0, s74, 30720
  s_add_u32 s61, s75, 29184
  buffer_load_dwordx4 v102, s[32:35], s61 offen lds
  v_mfma_f32_32x32x16_bf16 v[80:95], v[136:139], a[184:187], v[80:95]
  s_waitcnt lgkmcnt(0)
  v_mfma_f32_32x32x16_bf16 v[64:79], a[60:63], v[140:143], v[64:79]
  s_add_u32 m0, s74, 31744
  s_add_u32 s61, s75, 31232
  buffer_load_dwordx4 v103, s[32:35], s61 offen lds
  v_mfma_f32_32x32x16_bf16 v[80:95], v[140:143], a[188:191], v[80:95]
  s_waitcnt vmcnt(0)
  ds_read_b128 v[128:131], v104 offset:16384
  ds_read_b128 v[132:135], v105 offset:16384
  ds_read_b128 v[136:139], v106 offset:16384
  s_add_u32 s75, s70, 12
  s_min_u32 s75, s75, 63
  s_lshl_b32 s75, s75, 15
  s_waitcnt lgkmcnt(2)
  v_mfma_f32_32x32x16_bf16 v[64:79], a[64:67], v[128:131], v[64:79]
  ds_read_b128 v[140:143], v107 offset:16384
  s_add_u32 m0, s74, 0
  s_add_u32 s61, s75, 0
  buffer_load_dwordx4 v96, s[32:35], s61 offen lds
  v_mfma_f32_32x32x16_bf16 v[80:95], v[128:131], a[192:195], v[80:95]
  s_waitcnt lgkmcnt(2)
  v_mfma_f32_32x32x16_bf16 v[64:79], a[68:71], v[132:135], v[64:79]
  ds_read_b128 v[128:131], v108 offset:16384
  s_add_u32 m0, s74, 1024
  s_add_u32 s61, s75, 2048
  buffer_load_dwordx4 v97, s[32:35], s61 offen lds
  v_mfma_f32_32x32x16_bf16 v[80:95], v[132:135], a[196:199], v[80:95]
  s_waitcnt lgkmcnt(2)
  v_mfma_f32_32x32x16_bf16 v[64:79], a[72:75], v[136:139], v[64:79]
  ds_read_b128 v[132:135], v109 offset:16384
  s_add_u32 m0, s74, 2048
  s_add_u32 s61, s75, 4096
  buffer_load_dwordx4 v98, s[32:35], s61 offen lds
  v_mfma_f32_32x32x16_bf16 v[80:95], v[136:139], a[200:203], v[80:95]
  s_waitcnt lgkmcnt(2)
  v_mfma_f32_32x32x16_bf16 v[64:79], a[76:79], v[140:143], v[64:79]
  ds_read_b128 v[136:139], v110 offset:16384
  s_add_u32 m0, s74, 3072
  s_add_u32 s61, s75, 6144
  buffer_load_dwordx4 v99, s[32:35], s61 offen lds
  v_mfma_f32_32x32x16_bf16 v[80:95], v[140:143], a[204:207], v[80:95]
  s_waitcnt lgkmcnt(2)
  v_mfma_f32_32x32x16_bf16 v[64:79], a[80:83], v[128:131], v[64:79]
  ds_read_b128 v[140:143], v111 offset:16384
  s_add_u32 m0, s74, 4096
  s_add_u32 s61, s75, 8192
  buffer_load_dwordx4 v100, s[32:35], s61 offen lds
  v_mfma_f32_32x32x16_bf16 v[80:95], v[128:131], a[208:211], v[80:95]
  s_waitcnt lgkmcnt(2)
  v_mfma_f32_32x32x16_bf16 v[64:79], a[84:87], v[132:135], v[64:79]
  ds_read_b128 v[128:131], v104 offset:16640
  s_add_u32 m0, s74, 5120
  s_add_u32 s61, s75, 10240
  buffer_load_dwordx4 v101, s[32:35], s61 offen lds
  v_mfma_f32_32x32x16_bf16 v[80:95], v[132:135], a[212:215], v[80:95]
  s_waitcnt lgkmcnt(2)
  v_mfma_f32_32x32x16_bf16 v[64:79], a[88:91], v[136:139], v[64:79]
  ds_read_b128 v[132:135], v105 offset:16640
  s_add_u32 m0, s74, 6144
  s_add_u32 s61, s75, 12288
  buffer_load_dwordx4 v102, s[32:35], s61 offen lds
  v_mfma_f32_32x32x16_bf16 v[80:95], v[136:139], a[216:219], v[80:95]
  s_waitcnt lgkmcnt(2)
  v_mfma_f32_32x32x16_bf16 v[64:79], a[92:95], v[140:143], v[64:79]
  ds_read_b128 v[136:139], v106 offset:16640
  s_add_u32 m0, s74, 7168
  s_add_u32 s61, s75, 14336
  buffer_load_dwordx4 v103, s[32:35], s61 offen lds
  v_mfma_f32_32x32x16_bf16 v[80:95], v[140:143], a[220:223], v[80:95]
  s_waitcnt lgkmcnt(2)
  v_mfma_f32_32x32x16_bf16 v[64:79], a[96:99], v[128:131], v[64:79]
  ds_read_b128 v[140:143], v107 offset:16640
  s_add_u32 m0, s74, 8192
  s_add_u32 s61, s75, 16384
  buffer_load_dwordx4 v96, s[32:35], s61 offen lds
  v_mfma_f32_32x32x16_bf16 v[80:95], v[128:131], a[224:227], v[80:95]
  s_waitcnt lgkmcnt(2)
  v_mfma_f32_32x32x16_bf16 v[64:79], a[100:103], v[132:135], v[64:79]
  ds_read_b128 v[128:131], v108 offset:16640
  s_add_u32 m0, s74, 9216
  s_add_u32 s61, s75, 18432
  buffer_load_dwordx4 v97, s[32:35], s61 offen lds
  v_mfma_f32_32x32x16_bf16 v[80:95], v[132:135], a[228:231], v[80:95]
  s_waitcnt lgkmcnt(2)
  v_mfma_f32_32x32x16_bf16 v[64:79], a[104:107], v[136:139], v[64:79]
  ds_read_b128 v[132:135], v109 offset:16640
  s_add_u32 m0, s74, 10240
  s_add_u32 s61, s75, 20480
  buffer_load_dwordx4 v98, s[32:35], s61 offen lds
  v_mfma_f32_32x32x16_bf16 v[80:95], v[136:139], a[232:235], v[80:95]
  s_waitcnt lgkmcnt(2)
  v_mfma_f32_32x32x16_bf16 v[64:79], a[108:111], v[140:143], v[64:79]
  ds_read_b128 v[136:139], v110 offset:16640
  s_add_u32 m0, s74, 11264
  s_add_u32 s61, s75, 22528
  buffer_load_dwordx4 v99, s[32:35], s61 offen lds
  v_mfma_f32_32x32x16_bf16 v[80:95], v[140:143], a[236:239], v[80:95]
  s_waitcnt lgkmcnt(2)
  v_mfma_f32_32x32x16_bf16 v[64:79], a[112:115], v[128:131], v[64:79]
  ds_read_b128 v[140:143], v111 offset:16640
  s_add_u32 m0, s74, 12288
  s_add_u32 s61, s75, 24576
  buffer_load_dwordx4 v100, s[32:35], s61 offen lds
  v_mfma_f32_32x32x16_bf16 v[80:95], v[128:131], a[240:243], v[80:95]
  s_waitcnt lgkmcnt(2)
  v_mfma_f32_32x32x16_bf16 v[64:79], a[116:119], v[132:135], v[64:79]
  s_add_u32 m0, s74, 13312
  s_add_u32 s61, s75, 26624
  buffer_load_dwordx4 v101, s[32:35], s61 offen lds
  v_mfma_f32_32x32x16_bf16 v[80:95], v[132:135], a[244:247], v[80:95]
  s_waitcnt lgkmcnt(1)
  v_mfma_f32_32x32x16_bf16 v[64:79], a[120:123], v[136:139], v[64:79]
  s_add_u32 m0, s74, 14336
  s_add_u32 s61, s75, 28672
  buffer_load_dwordx4 v102, s[32:35], s61 offen lds
  v_mfma_f32_32x32x16_bf16 v[80:95], v[136:139], a[248:251], v[80:95]
  s_waitcnt lgkmcnt(0)
  v_mfma_f32_32x32x16_bf16 v[64:79], a[124:127], v[140:143], v[64:79]
  s_add_u32 m0, s74, 15360
  s_add_u32 s61, s75, 30720
  buffer_load_dwordx4 v103, s[32:35], s61 offen lds
  v_mfma_f32_32x32x16_bf16 v[80:95], v[140:143], a[252:255], v[80:95]
  s_nop 3
  v_mul_f32 v64, s79, v64
  v_mul_f32 v65, s79, v65
  v_mul_f32 v66, s79, v66
  v_mul_f32 v67, s79, v67
  v_mul_f32 v68, s79, v68
  v_mul_f32 v69, s79, v69
  v_mul_f32 v70, s79, v70
  v_mul_f32 v71, s79, v71
  v_cvt_pk_bf16_f32 v24, v64, v65
  v_cvt_pk_bf16_f32 v48, v72, v73
  v_cvt_pk_bf16_f32 v25, v66, v67
  v_cvt_pk_bf16_f32 v49, v74, v75
  v_cvt_pk_bf16_f32 v26, v68, v69
  v_cvt_pk_bf16_f32 v50, v76, v77
  v_cvt_pk_bf16_f32 v27, v70, v71
  v_cvt_pk_bf16_f32 v51, v78, v79
  v_cvt_pk_bf16_f32 v52, v80, v81
  v_cvt_pk_bf16_f32 v53, v82, v83
  v_cvt_pk_bf16_f32 v54, v84, v85
  v_cvt_pk_bf16_f32 v55, v86, v87
  v_cvt_pk_bf16_f32 v56, v88, v89
  v_cvt_pk_bf16_f32 v57, v90, v91
  v_cvt_pk_bf16_f32 v58, v92, v93
  v_cvt_pk_bf16_f32 v59, v94, v95
  v_cndmask_b32 v52, v52, v56, s[96:97]
  v_cndmask_b32 v53, v53, v57, s[96:97]
  v_cndmask_b32 v54, v54, v58, s[96:97]
  v_cndmask_b32 v55, v55, v59, s[96:97]
  s_lshl_b32 s61, s73, 10
  s_add_u32 s62, s61, 134217728
  buffer_store_dwordx4 v[48:51], v8, s[52:55], s62 offen sc1
  s_add_u32 s62, s61, 136314880
  buffer_store_dwordx4 v[52:55], v8, s[52:55], s62 offen sc1
  s_add_u32 s72, s72, 12
  s_min_u32 s73, s72, 63
  s_waitcnt vmcnt(2)
  ds_read_b128 v[128:131], v104 offset:0
  ds_read_b128 v[132:135], v105 offset:0
  ds_read_b128 v[136:139], v106 offset:0
  s_add_u32 s75, s70, 12
  s_min_u32 s75, s75, 63
  s_lshl_b32 s75, s75, 15
  s_waitcnt lgkmcnt(2)
  v_mfma_f32_32x32x16_bf16 v[64:79], a[0:3], v[128:131], 0
  ds_read_b128 v[140:143], v107 offset:0
  s_add_u32 m0, s74, 16384
  s_add_u32 s61, s75, 512
  buffer_load_dwordx4 v96, s[32:35], s61 offen lds
  v_mfma_f32_32x32x16_bf16 v[80:95], v[128:131], a[128:131], 0
  s_waitcnt lgkmcnt(2)
  v_mfma_f32_32x32x16_bf16 v[64:79], a[4:7], v[132:135], v[64:79]
  ds_read_b128 v[128:131], v108 offset:0
  s_add_u32 m0, s74, 17408
  s_add_u32 s61, s75, 2560
  buffer_load_dwordx4 v97, s[32:35], s61 offen lds
  v_mfma_f32_32x32x16_bf16 v[80:95], v[132:135], a[132:135], v[80:95]
  s_waitcnt lgkmcnt(2)
  v_mfma_f32_32x32x16_bf16 v[64:79], a[8:11], v[136:139], v[64:79]
  ds_read_b128 v[132:135], v109 offset:0
  s_add_u32 m0, s74, 18432
  s_add_u32 s61, s75, 4608
  buffer_load_dwordx4 v98, s[32:35], s61 offen lds
  v_mfma_f32_32x32x16_bf16 v[80:95], v[136:139], a[136:139], v[80:95]
  s_waitcnt lgkmcnt(2)
  v_mfma_f32_32x32x16_bf16 v[64:79], a[12:15], v[140:143], v[64:79]
  ds_read_b128 v[136:139], v110 offset:0
  s_add_u32 m0, s74, 19456
  s_add_u32 s61, s75, 6656
  buffer_load_dwordx4 v99, s[32:35], s61 offen lds
  v_mfma_f32_32x32x16_bf16 v[80:95], v[140:143], a[140:143], v[80:95]
  s_waitcnt lgkmcnt(2)
  v_mfma_f32_32x32x16_bf16 v[64:79], a[16:19], v[128:131], v[64:79]
  ds_read_b128 v[140:143], v111 offset:0
  s_add_u32 m0, s74, 20480
  s_add_u32 s61, s75, 8704
  buffer_load_dwordx4 v100, s[32:35], s61 offen lds
  v_mfma_f32_32x32x16_bf16 v[80:95], v[128:131], a[144:147], v[80:95]
  s_waitcnt lgkmcnt(2)
  v_mfma_f32_32x32x16_bf16 v[64:79], a[20:23], v[132:135], v[64:79]
  ds_read_b128 v[128:131], v104 offset:256
  s_add_u32 m0, s74, 21504
  s_add_u32 s61, s75, 10752
  buffer_load_dwordx4 v101, s[32:35], s61 offen lds
  v_mfma_f32_32x32x16_bf16 v[80:95], v[132:135], a[148:151], v[80:95]
  s_waitcnt lgkmcnt(2)
  v_mfma_f32_32x32x16_bf16 v[64:79], a[24:27], v[136:139], v[64:79]
  ds_read_b128 v[132:135], v105 offset:256
  s_add_u32 m0, s74, 22528
  s_add_u32 s61, s75, 12800
  buffer_load_dwordx4 v102, s[32:35], s61 offen lds
  v_mfma_f32_32x32x16_bf16 v[80:95], v[136:139], a[152:155], v[80:95]
  s_waitcnt lgkmcnt(2)
  v_mfma_f32_32x32x16_bf16 v[64:79], a[28:31], v[140:143], v[64:79]
  ds_read_b128 v[136:139], v106 offset:256
  s_add_u32 m0, s74, 23552
  s_add_u32 s61, s75, 14848
  buffer_load_dwordx4 v103, s[32:35], s61 offen lds
  v_mfma_f32_32x32x16_bf16 v[80:95], v[140:143], a[156:159], v[80:95]
  s_waitcnt lgkmcnt(2)
  v_mfma_f32_32x32x16_bf16 v[64:79], a[32:35], v[128:131], v[64:79]
  ds_read_b128 v[140:143], v107 offset:256
  s_add_u32 m0, s74, 24576
  s_add_u32 s61, s75, 16896
  buffer_load_dwordx4 v96, s[32:35], s61 offen lds
  v_mfma_f32_32x32x16_bf16 v[80:95], v[128:131], a[160:163], v[80:95]
  s_waitcnt lgkmcnt(2)
  v_mfma_f32_32x32x16_bf16 v[64:79], a[36:39], v[132:135], v[64:79]
  ds_read_b128 v[128:131], v108 offset:256
  s_add_u32 m0, s74, 25600
  s_add_u32 s61, s75, 18944
  buffer_load_dwordx4 v97, s[32:35], s61 offen lds
  v_mfma_f32_32x32x16_bf16 v[80:95], v[132:135], a[164:167], v[80:95]
  s_waitcnt lgkmcnt(2)
  v_mfma_f32_32x32x16_bf16 v[64:79], a[40:43], v[136:139], v[64:79]
  ds_read_b128 v[132:135], v109 offset:256
  s_add_u32 m0, s74, 26624
  s_add_u32 s61, s75, 20992
  buffer_load_dwordx4 v98, s[32:35], s61 offen lds
  v_mfma_f32_32x32x16_bf16 v[80:95], v[136:139], a[168:171], v[80:95]
  s_waitcnt lgkmcnt(2)
  v_mfma_f32_32x32x16_bf16 v[64:79], a[44:47], v[140:143], v[64:79]
  ds_read_b128 v[136:139], v110 offset:256
  s_add_u32 m0, s74, 27648
  s_add_u32 s61, s75, 23040
  buffer_load_dwordx4 v99, s[32:35], s61 offen lds
  v_mfma_f32_32x32x16_bf16 v[80:95], v[140:143], a[172:175], v[80:95]
  s_waitcnt lgkmcnt(2)
  v_mfma_f32_32x32x16_bf16 v[64:79], a[48:51], v[128:131], v[64:79]
  ds_read_b128 v[140:143], v111 offset:256
  s_add_u32 m0, s74, 28672
  s_add_u32 s61, s75, 25088
  buffer_load_dwordx4 v100, s[32:35], s61 offen lds
  v_mfma_f32_32x32x16_bf16 v[80:95], v[128:131], a[176:179], v[80:95]
  s_waitcnt lgkmcnt(2)
  v_mfma_f32_32x32x16_bf16 v[64:79], a[52:55], v[132:135], v[64:79]
  s_add_u32 m0, s74, 29696
  s_add_u32 s61, s75, 27136
  buffer_load_dwordx4 v101, s[32:35], s61 offen lds
  v_mfma_f32_32x32x16_bf16 v[80:95], v[132:135], a[180:183], v[80:95]
  s_waitcnt lgkmcnt(1)
  v_mfma_f32_32x32x16_bf16 v[64:79], a[56:59], v[136:139], v[64:79]
  s_add_u32 m0, s74, 30720
  s_add_u32 s61, s75, 29184
  buffer_load_dwordx4 v102, s[32:35], s61 offen lds
  v_mfma_f32_32x32x16_bf16 v[80:95], v[136:139], a[184:187], v[80:95]
  s_waitcnt lgkmcnt(0)
  v_mfma_f32_32x32x16_bf16 v[64:79], a[60:63], v[140:143], v[64:79]
  s_add_u32 m0, s74, 31744
  s_add_u32 s61, s75, 31232
  buffer_load_dwordx4 v103, s[32:35], s61 offen lds
  v_mfma_f32_32x32x16_bf16 v[80:95], v[140:143], a[188:191], v[80:95]
  s_waitcnt vmcnt(0)
  ds_read_b128 v[128:131], v104 offset:16384
  ds_read_b128 v[132:135], v105 offset:16384
  ds_read_b128 v[136:139], v106 offset:16384
  s_add_u32 s75, s70, 24
  s_min_u32 s75, s75, 63
  s_lshl_b32 s75, s75, 15
  s_waitcnt lgkmcnt(2)
  v_mfma_f32_32x32x16_bf16 v[64:79], a[64:67], v[128:131], v[64:79]
  ds_read_b128 v[140:143], v107 offset:16384
  s_add_u32 m0, s74, 0
  s_add_u32 s61, s75, 0
  buffer_load_dwordx4 v96, s[32:35], s61 offen lds
  v_mfma_f32_32x32x16_bf16 v[80:95], v[128:131], a[192:195], v[80:95]
  s_waitcnt lgkmcnt(2)
  v_mfma_f32_32x32x16_bf16 v[64:79], a[68:71], v[132:135], v[64:79]
  ds_read_b128 v[128:131], v108 offset:16384
  s_add_u32 m0, s74, 1024
  s_add_u32 s61, s75, 2048
  buffer_load_dwordx4 v97, s[32:35], s61 offen lds
  v_mfma_f32_32x32x16_bf16 v[80:95], v[132:135], a[196:199], v[80:95]
  s_waitcnt lgkmcnt(2)
  v_mfma_f32_32x32x16_bf16 v[64:79], a[72:75], v[136:139], v[64:79]
  ds_read_b128 v[132:135], v109 offset:16384
  s_add_u32 m0, s74, 2048
  s_add_u32 s61, s75, 4096
  buffer_load_dwordx4 v98, s[32:35], s61 offen lds
  v_mfma_f32_32x32x16_bf16 v[80:95], v[136:139], a[200:203], v[80:95]
  s_waitcnt lgkmcnt(2)
  v_mfma_f32_32x32x16_bf16 v[64:79], a[76:79], v[140:143], v[64:79]
  ds_read_b128 v[136:139], v110 offset:16384
  s_add_u32 m0, s74, 3072
  s_add_u32 s61, s75, 6144
  buffer_load_dwordx4 v99, s[32:35], s61 offen lds
  v_mfma_f32_32x32x16_bf16 v[80:95], v[140:143], a[204:207], v[80:95]
  s_waitcnt lgkmcnt(2)
  v_mfma_f32_32x32x16_bf16 v[64:79], a[80:83], v[128:131], v[64:79]
  ds_read_b128 v[140:143], v111 offset:16384
  s_add_u32 m0, s74, 4096
  s_add_u32 s61, s75, 8192
  buffer_load_dwordx4 v100, s[32:35], s61 offen lds
  v_mfma_f32_32x32x16_bf16 v[80:95], v[128:131], a[208:211], v[80:95]
  s_waitcnt lgkmcnt(2)
  v_mfma_f32_32x32x16_bf16 v[64:79], a[84:87], v[132:135], v[64:79]
  ds_read_b128 v[128:131], v104 offset:16640
  s_add_u32 m0, s74, 5120
  s_add_u32 s61, s75, 10240
  buffer_load_dwordx4 v101, s[32:35], s61 offen lds
  v_mfma_f32_32x32x16_bf16 v[80:95], v[132:135], a[212:215], v[80:95]
  s_waitcnt lgkmcnt(2)
  v_mfma_f32_32x32x16_bf16 v[64:79], a[88:91], v[136:139], v[64:79]
  ds_read_b128 v[132:135], v105 offset:16640
  s_add_u32 m0, s74, 6144
  s_add_u32 s61, s75, 12288
  buffer_load_dwordx4 v102, s[32:35], s61 offen lds
  v_mfma_f32_32x32x16_bf16 v[80:95], v[136:139], a[216:219], v[80:95]
  s_waitcnt lgkmcnt(2)
  v_mfma_f32_32x32x16_bf16 v[64:79], a[92:95], v[140:143], v[64:79]
  ds_read_b128 v[136:139], v106 offset:16640
  s_add_u32 m0, s74, 7168
  s_add_u32 s61, s75, 14336
  buffer_load_dwordx4 v103, s[32:35], s61 offen lds
  v_mfma_f32_32x32x16_bf16 v[80:95], v[140:143], a[220:223], v[80:95]
  s_waitcnt lgkmcnt(2)
  v_mfma_f32_32x32x16_bf16 v[64:79], a[96:99], v[128:131], v[64:79]
  ds_read_b128 v[140:143], v107 offset:16640
  s_add_u32 m0, s74, 8192
  s_add_u32 s61, s75, 16384
  buffer_load_dwordx4 v96, s[32:35], s61 offen lds
  v_mfma_f32_32x32x16_bf16 v[80:95], v[128:131], a[224:227], v[80:95]
  s_waitcnt lgkmcnt(2)
  v_mfma_f32_32x32x16_bf16 v[64:79], a[100:103], v[132:135], v[64:79]
  ds_read_b128 v[128:131], v108 offset:16640
  s_add_u32 m0, s74, 9216
  s_add_u32 s61, s75, 18432
  buffer_load_dwordx4 v97, s[32:35], s61 offen lds
  v_mfma_f32_32x32x16_bf16 v[80:95], v[132:135], a[228:231], v[80:95]
  s_waitcnt lgkmcnt(2)
  v_mfma_f32_32x32x16_bf16 v[64:79], a[104:107], v[136:139], v[64:79]
  ds_read_b128 v[132:135], v109 offset:16640
  s_add_u32 m0, s74, 10240
  s_add_u32 s61, s75, 20480
  buffer_load_dwordx4 v98, s[32:35], s61 offen lds
  v_mfma_f32_32x32x16_bf16 v[80:95], v[136:139], a[232:235], v[80:95]
  s_waitcnt lgkmcnt(2)
  v_mfma_f32_32x32x16_bf16 v[64:79], a[108:111], v[140:143], v[64:79]
  ds_read_b128 v[136:139], v110 offset:16640
  s_add_u32 m0, s74, 11264
  s_add_u32 s61, s75, 22528
  buffer_load_dwordx4 v99, s[32:35], s61 offen lds
  v_mfma_f32_32x32x16_bf16 v[80:95], v[140:143], a[236:239], v[80:95]
  s_waitcnt lgkmcnt(2)
  v_mfma_f32_32x32x16_bf16 v[64:79], a[112:115], v[128:131], v[64:79]
  ds_read_b128 v[140:143], v111 offset:16640
  s_add_u32 m0, s74, 12288
  s_add_u32 s61, s75, 24576
  buffer_load_dwordx4 v100, s[32:35], s61 offen lds
  v_mfma_f32_32x32x16_bf16 v[80:95], v[128:131], a[240:243], v[80:95]
  s_waitcnt lgkmcnt(2)
  v_mfma_f32_32x32x16_bf16 v[64:79], a[116:119], v[132:135], v[64:79]
  s_add_u32 m0, s74, 13312
  s_add_u32 s61, s75, 26624
  buffer_load_dwordx4 v101, s[32:35], s61 offen lds
  v_mfma_f32_32x32x16_bf16 v[80:95], v[132:135], a[244:247], v[80:95]
  s_waitcnt lgkmcnt(1)
  v_mfma_f32_32x32x16_bf16 v[64:79], a[120:123], v[136:139], v[64:79]
  s_add_u32 m0, s74, 14336
  s_add_u32 s61, s75, 28672
  buffer_load_dwordx4 v102, s[32:35], s61 offen lds
  v_mfma_f32_32x32x16_bf16 v[80:95], v[136:139], a[248:251], v[80:95]
  s_waitcnt lgkmcnt(0)
  v_mfma_f32_32x32x16_bf16 v[64:79], a[124:127], v[140:143], v[64:79]
  s_add_u32 m0, s74, 15360
  s_add_u32 s61, s75, 30720
  buffer_load_dwordx4 v103, s[32:35], s61 offen lds
  v_mfma_f32_32x32x16_bf16 v[80:95], v[140:143], a[252:255], v[80:95]
  s_nop 3
  v_mul_f32 v64, s79, v64
  v_mul_f32 v65, s79, v65
  v_mul_f32 v66, s79, v66
  v_mul_f32 v67, s79, v67
  v_mul_f32 v68, s79, v68
  v_mul_f32 v69, s79, v69
  v_mul_f32 v70, s79, v70
  v_mul_f32 v71, s79, v71
  v_cvt_pk_bf16_f32 v28, v64, v65
  v_cvt_pk_bf16_f32 v48, v72, v73
  v_cvt_pk_bf16_f32 v29, v66, v67
  v_cvt_pk_bf16_f32 v49, v74, v75
  v_cvt_pk_bf16_f32 v30, v68, v69
  v_cvt_pk_bf16_f32 v50, v76, v77
  v_cvt_pk_bf16_f32 v31, v70, v71
  v_cvt_pk_bf16_f32 v51, v78, v79
  v_cvt_pk_bf16_f32 v52, v80, v81
  v_cvt_pk_bf16_f32 v53, v82, v83
  v_cvt_pk_bf16_f32 v54, v84, v85
  v_cvt_pk_bf16_f32 v55, v86, v87
  v_cvt_pk_bf16_f32 v56, v88, v89
  v_cvt_pk_bf16_f32 v57, v90, v91
  v_cvt_pk_bf16_f32 v58, v92, v93
  v_cvt_pk_bf16_f32 v59, v94, v95
  v_cndmask_b32 v52, v52, v56, s[96:97]
  v_cndmask_b32 v53, v53, v57, s[96:97]
  v_cndmask_b32 v54, v54, v58, s[96:97]
  v_cndmask_b32 v55, v55, v59, s[96:97]
  s_lshl_b32 s61, s73, 10
  s_add_u32 s62, s61, 134217728
  buffer_store_dwordx4 v[48:51], v8, s[52:55], s62 offen sc1
  s_add_u32 s62, s61, 136314880
  buffer_store_dwordx4 v[52:55], v8, s[52:55], s62 offen sc1
  s_add_u32 s72, s72, 12
  s_min_u32 s73, s72, 63
  s_waitcnt vmcnt(2)
  ds_read_b128 v[128:131], v104 offset:0
  ds_read_b128 v[132:135], v105 offset:0
  ds_read_b128 v[136:139], v106 offset:0
  s_add_u32 s75, s70, 24
  s_min_u32 s75, s75, 63
  s_lshl_b32 s75, s75, 15
  s_waitcnt lgkmcnt(2)
  v_mfma_f32_32x32x16_bf16 v[64:79], a[0:3], v[128:131], 0
  ds_read_b128 v[140:143], v107 offset:0
  s_add_u32 m0, s74, 16384
  s_add_u32 s61, s75, 512
  buffer_load_dwordx4 v96, s[32:35], s61 offen lds
  v_mfma_f32_32x32x16_bf16 v[80:95], v[128:131], a[128:131], 0
  s_waitcnt lgkmcnt(2)
  v_mfma_f32_32x32x16_bf16 v[64:79], a[4:7], v[132:135], v[64:79]
  ds_read_b128 v[128:131], v108 offset:0
  s_add_u32 m0, s74, 17408
  s_add_u32 s61, s75, 2560
  buffer_load_dwordx4 v97, s[32:35], s61 offen lds
  v_mfma_f32_32x32x16_bf16 v[80:95], v[132:135], a[132:135], v[80:95]
  s_waitcnt lgkmcnt(2)
  v_mfma_f32_32x32x16_bf16 v[64:79], a[8:11], v[136:139], v[64:79]
  ds_read_b128 v[132:135], v109 offset:0
  s_add_u32 m0, s74, 18432
  s_add_u32 s61, s75, 4608
  buffer_load_dwordx4 v98, s[32:35], s61 offen lds
  v_mfma_f32_32x32x16_bf16 v[80:95], v[136:139], a[136:139], v[80:95]
  s_waitcnt lgkmcnt(2)
  v_mfma_f32_32x32x16_bf16 v[64:79], a[12:15], v[140:143], v[64:79]
  ds_read_b128 v[136:139], v110 offset:0
  s_add_u32 m0, s74, 19456
  s_add_u32 s61, s75, 6656
  buffer_load_dwordx4 v99, s[32:35], s61 offen lds
  v_mfma_f32_32x32x16_bf16 v[80:95], v[140:143], a[140:143], v[80:95]
  s_waitcnt lgkmcnt(2)
  v_mfma_f32_32x32x16_bf16 v[64:79], a[16:19], v[128:131], v[64:79]
  ds_read_b128 v[140:143], v111 offset:0
  s_add_u32 m0, s74, 20480
  s_add_u32 s61, s75, 8704
  buffer_load_dwordx4 v100, s[32:35], s61 offen lds
  v_mfma_f32_32x32x16_bf16 v[80:95], v[128:131], a[144:147], v[80:95]
  s_waitcnt lgkmcnt(2)
  v_mfma_f32_32x32x16_bf16 v[64:79], a[20:23], v[132:135], v[64:79]
  ds_read_b128 v[128:131], v104 offset:256
  s_add_u32 m0, s74, 21504
  s_add_u32 s61, s75, 10752
  buffer_load_dwordx4 v101, s[32:35], s61 offen lds
  v_mfma_f32_32x32x16_bf16 v[80:95], v[132:135], a[148:151], v[80:95]
  s_waitcnt lgkmcnt(2)
  v_mfma_f32_32x32x16_bf16 v[64:79], a[24:27], v[136:139], v[64:79]
  ds_read_b128 v[132:135], v105 offset:256
  s_add_u32 m0, s74, 22528
  s_add_u32 s61, s75, 12800
  buffer_load_dwordx4 v102, s[32:35], s61 offen lds
  v_mfma_f32_32x32x16_bf16 v[80:95], v[136:139], a[152:155], v[80:95]
  s_waitcnt lgkmcnt(2)
  v_mfma_f32_32x32x16_bf16 v[64:79], a[28:31], v[140:143], v[64:79]
  ds_read_b128 v[136:139], v106 offset:256
  s_add_u32 m0, s74, 23552
  s_add_u32 s61, s75, 14848
  buffer_load_dwordx4 v103, s[32:35], s61 offen lds
  v_mfma_f32_32x32x16_bf16 v[80:95], v[140:143], a[156:159], v[80:95]
  s_waitcnt lgkmcnt(2)
  v_mfma_f32_32x32x16_bf16 v[64:79], a[32:35], v[128:131], v[64:79]
  ds_read_b128 v[140:143], v107 offset:256
  s_add_u32 m0, s74, 24576
  s_add_u32 s61, s75, 16896
  buffer_load_dwordx4 v96, s[32:35], s61 offen lds
  v_mfma_f32_32x32x16_bf16 v[80:95], v[128:131], a[160:163], v[80:95]
  s_waitcnt lgkmcnt(2)
  v_mfma_f32_32x32x16_bf16 v[64:79], a[36:39], v[132:135], v[64:79]
  ds_read_b128 v[128:131], v108 offset:256
  s_add_u32 m0, s74, 25600
  s_add_u32 s61, s75, 18944
  buffer_load_dwordx4 v97, s[32:35], s61 offen lds
  v_mfma_f32_32x32x16_bf16 v[80:95], v[132:135], a[164:167], v[80:95]
  s_waitcnt lgkmcnt(2)
  v_mfma_f32_32x32x16_bf16 v[64:79], a[40:43], v[136:139], v[64:79]
  ds_read_b128 v[132:135], v109 offset:256
  s_add_u32 m0, s74, 26624
  s_add_u32 s61, s75, 20992
  buffer_load_dwordx4 v98, s[32:35], s61 offen lds
  v_mfma_f32_32x32x16_bf16 v[80:95], v[136:139], a[168:171], v[80:95]
  s_waitcnt lgkmcnt(2)
  v_mfma_f32_32x32x16_bf16 v[64:79], a[44:47], v[140:143], v[64:79]
  ds_read_b128 v[136:139], v110 offset:256
  s_add_u32 m0, s74, 27648
  s_add_u32 s61, s75, 23040
  buffer_load_dwordx4 v99, s[32:35], s61 offen lds
  v_mfma_f32_32x32x16_bf16 v[80:95], v[140:143], a[172:175], v[80:95]
  s_waitcnt lgkmcnt(2)
  v_mfma_f32_32x32x16_bf16 v[64:79], a[48:51], v[128:131], v[64:79]
  ds_read_b128 v[140:143], v111 offset:256
  s_add_u32 m0, s74, 28672
  s_add_u32 s61, s75, 25088
  buffer_load_dwordx4 v100, s[32:35], s61 offen lds
  v_mfma_f32_32x32x16_bf16 v[80:95], v[128:131], a[176:179], v[80:95]
  s_waitcnt lgkmcnt(2)
  v_mfma_f32_32x32x16_bf16 v[64:79], a[52:55], v[132:135], v[64:79]
  s_add_u32 m0, s74, 29696
  s_add_u32 s61, s75, 27136
  buffer_load_dwordx4 v101, s[32:35], s61 offen lds
  v_mfma_f32_32x32x16_bf16 v[80:95], v[132:135], a[180:183], v[80:95]
  s_waitcnt lgkmcnt(1)
  v_mfma_f32_32x32x16_bf16 v[64:79], a[56:59], v[136:139], v[64:79]
  s_add_u32 m0, s74, 30720
  s_add_u32 s61, s75, 29184
  buffer_load_dwordx4 v102, s[32:35], s61 offen lds
  v_mfma_f32_32x32x16_bf16 v[80:95], v[136:139], a[184:187], v[80:95]
  s_waitcnt lgkmcnt(0)
  v_mfma_f32_32x32x16_bf16 v[64:79], a[60:63], v[140:143], v[64:79]
  s_add_u32 m0, s74, 31744
  s_add_u32 s61, s75, 31232
  buffer_load_dwordx4 v103, s[32:35], s61 offen lds
  v_mfma_f32_32x32x16_bf16 v[80:95], v[140:143], a[188:191], v[80:95]
  s_waitcnt vmcnt(0)
  ds_read_b128 v[128:131], v104 offset:16384
  ds_read_b128 v[132:135], v105 offset:16384
  ds_read_b128 v[136:139], v106 offset:16384
  s_add_u32 s75, s70, 36
  s_min_u32 s75, s75, 63
  s_lshl_b32 s75, s75, 15
  s_waitcnt lgkmcnt(2)
  v_mfma_f32_32x32x16_bf16 v[64:79], a[64:67], v[128:131], v[64:79]
  ds_read_b128 v[140:143], v107 offset:16384
  s_add_u32 m0, s74, 0
  s_add_u32 s61, s75, 0
  buffer_load_dwordx4 v96, s[32:35], s61 offen lds
  v_mfma_f32_32x32x16_bf16 v[80:95], v[128:131], a[192:195], v[80:95]
  s_waitcnt lgkmcnt(2)
  v_mfma_f32_32x32x16_bf16 v[64:79], a[68:71], v[132:135], v[64:79]
  ds_read_b128 v[128:131], v108 offset:16384
  s_add_u32 m0, s74, 1024
  s_add_u32 s61, s75, 2048
  buffer_load_dwordx4 v97, s[32:35], s61 offen lds
  v_mfma_f32_32x32x16_bf16 v[80:95], v[132:135], a[196:199], v[80:95]
  s_waitcnt lgkmcnt(2)
  v_mfma_f32_32x32x16_bf16 v[64:79], a[72:75], v[136:139], v[64:79]
  ds_read_b128 v[132:135], v109 offset:16384
  s_add_u32 m0, s74, 2048
  s_add_u32 s61, s75, 4096
  buffer_load_dwordx4 v98, s[32:35], s61 offen lds
  v_mfma_f32_32x32x16_bf16 v[80:95], v[136:139], a[200:203], v[80:95]
  s_waitcnt lgkmcnt(2)
  v_mfma_f32_32x32x16_bf16 v[64:79], a[76:79], v[140:143], v[64:79]
  ds_read_b128 v[136:139], v110 offset:16384
  s_add_u32 m0, s74, 3072
  s_add_u32 s61, s75, 6144
  buffer_load_dwordx4 v99, s[32:35], s61 offen lds
  v_mfma_f32_32x32x16_bf16 v[80:95], v[140:143], a[204:207], v[80:95]
  s_waitcnt lgkmcnt(2)
  v_mfma_f32_32x32x16_bf16 v[64:79], a[80:83], v[128:131], v[64:79]
  ds_read_b128 v[140:143], v111 offset:16384
  s_add_u32 m0, s74, 4096
  s_add_u32 s61, s75, 8192
  buffer_load_dwordx4 v100, s[32:35], s61 offen lds
  v_mfma_f32_32x32x16_bf16 v[80:95], v[128:131], a[208:211], v[80:95]
  s_waitcnt lgkmcnt(2)
  v_mfma_f32_32x32x16_bf16 v[64:79], a[84:87], v[132:135], v[64:79]
  ds_read_b128 v[128:131], v104 offset:16640
  s_add_u32 m0, s74, 5120
  s_add_u32 s61, s75, 10240
  buffer_load_dwordx4 v101, s[32:35], s61 offen lds
  v_mfma_f32_32x32x16_bf16 v[80:95], v[132:135], a[212:215], v[80:95]
  s_waitcnt lgkmcnt(2)
  v_mfma_f32_32x32x16_bf16 v[64:79], a[88:91], v[136:139], v[64:79]
  ds_read_b128 v[132:135], v105 offset:16640
  s_add_u32 m0, s74, 6144
  s_add_u32 s61, s75, 12288
  buffer_load_dwordx4 v102, s[32:35], s61 offen lds
  v_mfma_f32_32x32x16_bf16 v[80:95], v[136:139], a[216:219], v[80:95]
  s_waitcnt lgkmcnt(2)
  v_mfma_f32_32x32x16_bf16 v[64:79], a[92:95], v[140:143], v[64:79]
  ds_read_b128 v[136:139], v106 offset:16640
  s_add_u32 m0, s74, 7168
  s_add_u32 s61, s75, 14336
  buffer_load_dwordx4 v103, s[32:35], s61 offen lds
  v_mfma_f32_32x32x16_bf16 v[80:95], v[140:143], a[220:223], v[80:95]
  s_waitcnt lgkmcnt(2)
  v_mfma_f32_32x32x16_bf16 v[64:79], a[96:99], v[128:131], v[64:79]
  ds_read_b128 v[140:143], v107 offset:16640
  s_add_u32 m0, s74, 8192
  s_add_u32 s61, s75, 16384
  buffer_load_dwordx4 v96, s[32:35], s61 offen lds
  v_mfma_f32_32x32x16_bf16 v[80:95], v[128:131], a[224:227], v[80:95]
  s_waitcnt lgkmcnt(2)
  v_mfma_f32_32x32x16_bf16 v[64:79], a[100:103], v[132:135], v[64:79]
  ds_read_b128 v[128:131], v108 offset:16640
  s_add_u32 m0, s74, 9216
  s_add_u32 s61, s75, 18432
  buffer_load_dwordx4 v97, s[32:35], s61 offen lds
  v_mfma_f32_32x32x16_bf16 v[80:95], v[132:135], a[228:231], v[80:95]
  s_waitcnt lgkmcnt(2)
  v_mfma_f32_32x32x16_bf16 v[64:79], a[104:107], v[136:139], v[64:79]
  ds_read_b128 v[132:135], v109 offset:16640
  s_add_u32 m0, s74, 10240
  s_add_u32 s61, s75, 20480
  buffer_load_dwordx4 v98, s[32:35], s61 offen lds
  v_mfma_f32_32x32x16_bf16 v[80:95], v[136:139], a[232:235], v[80:95]
  s_waitcnt lgkmcnt(2)
  v_mfma_f32_32x32x16_bf16 v[64:79], a[108:111], v[140:143], v[64:79]
  ds_read_b128 v[136:139], v110 offset:16640
  s_add_u32 m0, s74, 11264
  s_add_u32 s61, s75, 22528
  buffer_load_dwordx4 v99, s[32:35], s61 offen lds
  v_mfma_f32_32x32x16_bf16 v[80:95], v[140:143], a[236:239], v[80:95]
  s_waitcnt lgkmcnt(2)
  v_mfma_f32_32x32x16_bf16 v[64:79], a[112:115], v[128:131], v[64:79]
  ds_read_b128 v[140:143], v111 offset:16640
  s_add_u32 m0, s74, 12288
  s_add_u32 s61, s75, 24576
  buffer_load_dwordx4 v100, s[32:35], s61 offen lds
  v_mfma_f32_32x32x16_bf16 v[80:95], v[128:131], a[240:243], v[80:95]
  s_waitcnt lgkmcnt(2)
  v_mfma_f32_32x32x16_bf16 v[64:79], a[116:119], v[132:135], v[64:79]
  s_add_u32 m0, s74, 13312
  s_add_u32 s61, s75, 26624
  buffer_load_dwordx4 v101, s[32:35], s61 offen lds
  v_mfma_f32_32x32x16_bf16 v[80:95], v[132:135], a[244:247], v[80:95]
  s_waitcnt lgkmcnt(1)
  v_mfma_f32_32x32x16_bf16 v[64:79], a[120:123], v[136:139], v[64:79]
  s_add_u32 m0, s74, 14336
  s_add_u32 s61, s75, 28672
  buffer_load_dwordx4 v102, s[32:35], s61 offen lds
  v_mfma_f32_32x32x16_bf16 v[80:95], v[136:139], a[248:251], v[80:95]
  s_waitcnt lgkmcnt(0)
  v_mfma_f32_32x32x16_bf16 v[64:79], a[124:127], v[140:143], v[64:79]
  s_add_u32 m0, s74, 15360
  s_add_u32 s61, s75, 30720
  buffer_load_dwordx4 v103, s[32:35], s61 offen lds
  v_mfma_f32_32x32x16_bf16 v[80:95], v[140:143], a[252:255], v[80:95]
  s_nop 3
  v_mul_f32 v64, s79, v64
  v_mul_f32 v65, s79, v65
  v_mul_f32 v66, s79, v66
  v_mul_f32 v67, s79, v67
  v_mul_f32 v68, s79, v68
  v_mul_f32 v69, s79, v69
  v_mul_f32 v70, s79, v70
  v_mul_f32 v71, s79, v71
  v_cvt_pk_bf16_f32 v32, v64, v65
  v_cvt_pk_bf16_f32 v48, v72, v73
  v_cvt_pk_bf16_f32 v33, v66, v67
  v_cvt_pk_bf16_f32 v49, v74, v75
  v_cvt_pk_bf16_f32 v34, v68, v69
  v_cvt_pk_bf16_f32 v50, v76, v77
  v_cvt_pk_bf16_f32 v35, v70, v71
  v_cvt_pk_bf16_f32 v51, v78, v79
  v_cvt_pk_bf16_f32 v52, v80, v81
  v_cvt_pk_bf16_f32 v53, v82, v83
  v_cvt_pk_bf16_f32 v54, v84, v85
  v_cvt_pk_bf16_f32 v55, v86, v87
  v_cvt_pk_bf16_f32 v56, v88, v89
  v_cvt_pk_bf16_f32 v57, v90, v91
  v_cvt_pk_bf16_f32 v58, v92, v93
  v_cvt_pk_bf16_f32 v59, v94, v95
  v_cndmask_b32 v52, v52, v56, s[96:97]
  v_cndmask_b32 v53, v53, v57, s[96:97]
  v_cndmask_b32 v54, v54, v58, s[96:97]
  v_cndmask_b32 v55, v55, v59, s[96:97]
  s_lshl_b32 s61, s73, 10
  s_add_u32 s62, s61, 134217728
  buffer_store_dwordx4 v[48:51], v8, s[52:55], s62 offen sc1
  s_add_u32 s62, s61, 136314880
  buffer_store_dwordx4 v[52:55], v8, s[52:55], s62 offen sc1
  s_add_u32 s72, s72, 12
  s_min_u32 s73, s72, 63
  s_waitcnt vmcnt(2)
  ds_read_b128 v[128:131], v104 offset:0
  ds_read_b128 v[132:135], v105 offset:0
  ds_read_b128 v[136:139], v106 offset:0
  s_add_u32 s75, s70, 36
  s_min_u32 s75, s75, 63
  s_lshl_b32 s75, s75, 15
  s_waitcnt lgkmcnt(2)
  v_mfma_f32_32x32x16_bf16 v[64:79], a[0:3], v[128:131], 0
  ds_read_b128 v[140:143], v107 offset:0
  s_add_u32 m0, s74, 16384
  s_add_u32 s61, s75, 512
  buffer_load_dwordx4 v96, s[32:35], s61 offen lds
  v_mfma_f32_32x32x16_bf16 v[80:95], v[128:131], a[128:131], 0
  s_waitcnt lgkmcnt(2)
  v_mfma_f32_32x32x16_bf16 v[64:79], a[4:7], v[132:135], v[64:79]
  ds_read_b128 v[128:131], v108 offset:0
  s_add_u32 m0, s74, 17408
  s_add_u32 s61, s75, 2560
  buffer_load_dwordx4 v97, s[32:35], s61 offen lds
  v_mfma_f32_32x32x16_bf16 v[80:95], v[132:135], a[132:135], v[80:95]
  s_waitcnt lgkmcnt(2)
  v_mfma_f32_32x32x16_bf16 v[64:79], a[8:11], v[136:139], v[64:79]
  ds_read_b128 v[132:135], v109 offset:0
  s_add_u32 m0, s74, 18432
  s_add_u32 s61, s75, 4608
  buffer_load_dwordx4 v98, s[32:35], s61 offen lds
  v_mfma_f32_32x32x16_bf16 v[80:95], v[136:139], a[136:139], v[80:95]
  s_waitcnt lgkmcnt(2)
  v_mfma_f32_32x32x16_bf16 v[64:79], a[12:15], v[140:143], v[64:79]
  ds_read_b128 v[136:139], v110 offset:0
  s_add_u32 m0, s74, 19456
  s_add_u32 s61, s75, 6656
  buffer_load_dwordx4 v99, s[32:35], s61 offen lds
  v_mfma_f32_32x32x16_bf16 v[80:95], v[140:143], a[140:143], v[80:95]
  s_waitcnt lgkmcnt(2)
  v_mfma_f32_32x32x16_bf16 v[64:79], a[16:19], v[128:131], v[64:79]
  ds_read_b128 v[140:143], v111 offset:0
  s_add_u32 m0, s74, 20480
  s_add_u32 s61, s75, 8704
  buffer_load_dwordx4 v100, s[32:35], s61 offen lds
  v_mfma_f32_32x32x16_bf16 v[80:95], v[128:131], a[144:147], v[80:95]
  s_waitcnt lgkmcnt(2)
  v_mfma_f32_32x32x16_bf16 v[64:79], a[20:23], v[132:135], v[64:79]
  ds_read_b128 v[128:131], v104 offset:256
  s_add_u32 m0, s74, 21504
  s_add_u32 s61, s75, 10752
  buffer_load_dwordx4 v101, s[32:35], s61 offen lds
  v_mfma_f32_32x32x16_bf16 v[80:95], v[132:135], a[148:151], v[80:95]
  s_waitcnt lgkmcnt(2)
  v_mfma_f32_32x32x16_bf16 v[64:79], a[24:27], v[136:139], v[64:79]
  ds_read_b128 v[132:135], v105 offset:256
  s_add_u32 m0, s74, 22528
  s_add_u32 s61, s75, 12800
  buffer_load_dwordx4 v102, s[32:35], s61 offen lds
  v_mfma_f32_32x32x16_bf16 v[80:95], v[136:139], a[152:155], v[80:95]
  s_waitcnt lgkmcnt(2)
  v_mfma_f32_32x32x16_bf16 v[64:79], a[28:31], v[140:143], v[64:79]
  ds_read_b128 v[136:139], v106 offset:256
  s_add_u32 m0, s74, 23552
  s_add_u32 s61, s75, 14848
  buffer_load_dwordx4 v103, s[32:35], s61 offen lds
  v_mfma_f32_32x32x16_bf16 v[80:95], v[140:143], a[156:159], v[80:95]
  s_waitcnt lgkmcnt(2)
  v_mfma_f32_32x32x16_bf16 v[64:79], a[32:35], v[128:131], v[64:79]
  ds_read_b128 v[140:143], v107 offset:256
  s_add_u32 m0, s74, 24576
  s_add_u32 s61, s75, 16896
  buffer_load_dwordx4 v96, s[32:35], s61 offen lds
  v_mfma_f32_32x32x16_bf16 v[80:95], v[128:131], a[160:163], v[80:95]
  s_waitcnt lgkmcnt(2)
  v_mfma_f32_32x32x16_bf16 v[64:79], a[36:39], v[132:135], v[64:79]
  ds_read_b128 v[128:131], v108 offset:256
  s_add_u32 m0, s74, 25600
  s_add_u32 s61, s75, 18944
  buffer_load_dwordx4 v97, s[32:35], s61 offen lds
  v_mfma_f32_32x32x16_bf16 v[80:95], v[132:135], a[164:167], v[80:95]
  s_waitcnt lgkmcnt(2)
  v_mfma_f32_32x32x16_bf16 v[64:79], a[40:43], v[136:139], v[64:79]
  ds_read_b128 v[132:135], v109 offset:256
  s_add_u32 m0, s74, 26624
  s_add_u32 s61, s75, 20992
  buffer_load_dwordx4 v98, s[32:35], s61 offen lds
  v_mfma_f32_32x32x16_bf16 v[80:95], v[136:139], a[168:171], v[80:95]
  s_waitcnt lgkmcnt(2)
  v_mfma_f32_32x32x16_bf16 v[64:79], a[44:47], v[140:143], v[64:79]
  ds_read_b128 v[136:139], v110 offset:256
  s_add_u32 m0, s74, 27648
  s_add_u32 s61, s75, 23040
  buffer_load_dwordx4 v99, s[32:35], s61 offen lds
  v_mfma_f32_32x32x16_bf16 v[80:95], v[140:143], a[172:175], v[80:95]
  s_waitcnt lgkmcnt(2)
  v_mfma_f32_32x32x16_bf16 v[64:79], a[48:51], v[128:131], v[64:79]
  ds_read_b128 v[140:143], v111 offset:256
  s_add_u32 m0, s74, 28672
  s_add_u32 s61, s75, 25088
  buffer_load_dwordx4 v100, s[32:35], s61 offen lds
  v_mfma_f32_32x32x16_bf16 v[80:95], v[128:131], a[176:179], v[80:95]
  s_waitcnt lgkmcnt(2)
  v_mfma_f32_32x32x16_bf16 v[64:79], a[52:55], v[132:135], v[64:79]
  s_add_u32 m0, s74, 29696
  s_add_u32 s61, s75, 27136
  buffer_load_dwordx4 v101, s[32:35], s61 offen lds
  v_mfma_f32_32x32x16_bf16 v[80:95], v[132:135], a[180:183], v[80:95]
  s_waitcnt lgkmcnt(1)
  v_mfma_f32_32x32x16_bf16 v[64:79], a[56:59], v[136:139], v[64:79]
  s_add_u32 m0, s74, 30720
  s_add_u32 s61, s75, 29184
  buffer_load_dwordx4 v102, s[32:35], s61 offen lds
  v_mfma_f32_32x32x16_bf16 v[80:95], v[136:139], a[184:187], v[80:95]
  s_waitcnt lgkmcnt(0)
  v_mfma_f32_32x32x16_bf16 v[64:79], a[60:63], v[140:143], v[64:79]
  s_add_u32 m0, s74, 31744
  s_add_u32 s61, s75, 31232
  buffer_load_dwordx4 v103, s[32:35], s61 offen lds
  v_mfma_f32_32x32x16_bf16 v[80:95], v[140:143], a[188:191], v[80:95]
  s_waitcnt vmcnt(0)
  ds_read_b128 v[128:131], v104 offset:16384
  ds_read_b128 v[132:135], v105 offset:16384
  ds_read_b128 v[136:139], v106 offset:16384
  s_add_u32 s75, s70, 48
  s_min_u32 s75, s75, 63
  s_lshl_b32 s75, s75, 15
  s_waitcnt lgkmcnt(2)
  v_mfma_f32_32x32x16_bf16 v[64:79], a[64:67], v[128:131], v[64:79]
  ds_read_b128 v[140:143], v107 offset:16384
  s_add_u32 m0, s74, 0
  s_add_u32 s61, s75, 0
  buffer_load_dwordx4 v96, s[32:35], s61 offen lds
  v_mfma_f32_32x32x16_bf16 v[80:95], v[128:131], a[192:195], v[80:95]
  s_waitcnt lgkmcnt(2)
  v_mfma_f32_32x32x16_bf16 v[64:79], a[68:71], v[132:135], v[64:79]
  ds_read_b128 v[128:131], v108 offset:16384
  s_add_u32 m0, s74, 1024
  s_add_u32 s61, s75, 2048
  buffer_load_dwordx4 v97, s[32:35], s61 offen lds
  v_mfma_f32_32x32x16_bf16 v[80:95], v[132:135], a[196:199], v[80:95]
  s_waitcnt lgkmcnt(2)
  v_mfma_f32_32x32x16_bf16 v[64:79], a[72:75], v[136:139], v[64:79]
  ds_read_b128 v[132:135], v109 offset:16384
  s_add_u32 m0, s74, 2048
  s_add_u32 s61, s75, 4096
  buffer_load_dwordx4 v98, s[32:35], s61 offen lds
  v_mfma_f32_32x32x16_bf16 v[80:95], v[136:139], a[200:203], v[80:95]
  s_waitcnt lgkmcnt(2)
  v_mfma_f32_32x32x16_bf16 v[64:79], a[76:79], v[140:143], v[64:79]
  ds_read_b128 v[136:139], v110 offset:16384
  s_add_u32 m0, s74, 3072
  s_add_u32 s61, s75, 6144
  buffer_load_dwordx4 v99, s[32:35], s61 offen lds
  v_mfma_f32_32x32x16_bf16 v[80:95], v[140:143], a[204:207], v[80:95]
  s_waitcnt lgkmcnt(2)
  v_mfma_f32_32x32x16_bf16 v[64:79], a[80:83], v[128:131], v[64:79]
  ds_read_b128 v[140:143], v111 offset:16384
  s_add_u32 m0, s74, 4096
  s_add_u32 s61, s75, 8192
  buffer_load_dwordx4 v100, s[32:35], s61 offen lds
  v_mfma_f32_32x32x16_bf16 v[80:95], v[128:131], a[208:211], v[80:95]
  s_waitcnt lgkmcnt(2)
  v_mfma_f32_32x32x16_bf16 v[64:79], a[84:87], v[132:135], v[64:79]
  ds_read_b128 v[128:131], v104 offset:16640
  s_add_u32 m0, s74, 5120
  s_add_u32 s61, s75, 10240
  buffer_load_dwordx4 v101, s[32:35], s61 offen lds
  v_mfma_f32_32x32x16_bf16 v[80:95], v[132:135], a[212:215], v[80:95]
  s_waitcnt lgkmcnt(2)
  v_mfma_f32_32x32x16_bf16 v[64:79], a[88:91], v[136:139], v[64:79]
  ds_read_b128 v[132:135], v105 offset:16640
  s_add_u32 m0, s74, 6144
  s_add_u32 s61, s75, 12288
  buffer_load_dwordx4 v102, s[32:35], s61 offen lds
  v_mfma_f32_32x32x16_bf16 v[80:95], v[136:139], a[216:219], v[80:95]
  s_waitcnt lgkmcnt(2)
  v_mfma_f32_32x32x16_bf16 v[64:79], a[92:95], v[140:143], v[64:79]
  ds_read_b128 v[136:139], v106 offset:16640
  s_add_u32 m0, s74, 7168
  s_add_u32 s61, s75, 14336
  buffer_load_dwordx4 v103, s[32:35], s61 offen lds
  v_mfma_f32_32x32x16_bf16 v[80:95], v[140:143], a[220:223], v[80:95]
  s_waitcnt lgkmcnt(2)
  v_mfma_f32_32x32x16_bf16 v[64:79], a[96:99], v[128:131], v[64:79]
  ds_read_b128 v[140:143], v107 offset:16640
  s_add_u32 m0, s74, 8192
  s_add_u32 s61, s75, 16384
  buffer_load_dwordx4 v96, s[32:35], s61 offen lds
  v_mfma_f32_32x32x16_bf16 v[80:95], v[128:131], a[224:227], v[80:95]
  s_waitcnt lgkmcnt(2)
  v_mfma_f32_32x32x16_bf16 v[64:79], a[100:103], v[132:135], v[64:79]
  ds_read_b128 v[128:131], v108 offset:16640
  s_add_u32 m0, s74, 9216
  s_add_u32 s61, s75, 18432
  buffer_load_dwordx4 v97, s[32:35], s61 offen lds
  v_mfma_f32_32x32x16_bf16 v[80:95], v[132:135], a[228:231], v[80:95]
  s_waitcnt lgkmcnt(2)
  v_mfma_f32_32x32x16_bf16 v[64:79], a[104:107], v[136:139], v[64:79]
  ds_read_b128 v[132:135], v109 offset:16640
  s_add_u32 m0, s74, 10240
  s_add_u32 s61, s75, 20480
  buffer_load_dwordx4 v98, s[32:35], s61 offen lds
  v_mfma_f32_32x32x16_bf16 v[80:95], v[136:139], a[232:235], v[80:95]
  s_waitcnt lgkmcnt(2)
  v_mfma_f32_32x32x16_bf16 v[64:79], a[108:111], v[140:143], v[64:79]
  ds_read_b128 v[136:139], v110 offset:16640
  s_add_u32 m0, s74, 11264
  s_add_u32 s61, s75, 22528
  buffer_load_dwordx4 v99, s[32:35], s61 offen lds
  v_mfma_f32_32x32x16_bf16 v[80:95], v[140:143], a[236:239], v[80:95]
  s_waitcnt lgkmcnt(2)
  v_mfma_f32_32x32x16_bf16 v[64:79], a[112:115], v[128:131], v[64:79]
  ds_read_b128 v[140:143], v111 offset:16640
  s_add_u32 m0, s74, 12288
  s_add_u32 s61, s75, 24576
  buffer_load_dwordx4 v100, s[32:35], s61 offen lds
  v_mfma_f32_32x32x16_bf16 v[80:95], v[128:131], a[240:243], v[80:95]
  s_waitcnt lgkmcnt(2)
  v_mfma_f32_32x32x16_bf16 v[64:79], a[116:119], v[132:135], v[64:79]
  s_add_u32 m0, s74, 13312
  s_add_u32 s61, s75, 26624
  buffer_load_dwordx4 v101, s[32:35], s61 offen lds
  v_mfma_f32_32x32x16_bf16 v[80:95], v[132:135], a[244:247], v[80:95]
  s_waitcnt lgkmcnt(1)
  v_mfma_f32_32x32x16_bf16 v[64:79], a[120:123], v[136:139], v[64:79]
  s_add_u32 m0, s74, 14336
  s_add_u32 s61, s75, 28672
  buffer_load_dwordx4 v102, s[32:35], s61 offen lds
  v_mfma_f32_32x32x16_bf16 v[80:95], v[136:139], a[248:251], v[80:95]
  s_waitcnt lgkmcnt(0)
  v_mfma_f32_32x32x16_bf16 v[64:79], a[124:127], v[140:143], v[64:79]
  s_add_u32 m0, s74, 15360
  s_add_u32 s61, s75, 30720
  buffer_load_dwordx4 v103, s[32:35], s61 offen lds
  v_mfma_f32_32x32x16_bf16 v[80:95], v[140:143], a[252:255], v[80:95]
  s_nop 3
  v_mul_f32 v64, s79, v64
  v_mul_f32 v65, s79, v65
  v_mul_f32 v66, s79, v66
  v_mul_f32 v67, s79, v67
  v_mul_f32 v68, s79, v68
  v_mul_f32 v69, s79, v69
  v_mul_f32 v70, s79, v70
  v_mul_f32 v71, s79, v71
  v_cvt_pk_bf16_f32 v36, v64, v65
  v_cvt_pk_bf16_f32 v48, v72, v73
  v_cvt_pk_bf16_f32 v37, v66, v67
  v_cvt_pk_bf16_f32 v49, v74, v75
  v_cvt_pk_bf16_f32 v38, v68, v69
  v_cvt_pk_bf16_f32 v50, v76, v77
  v_cvt_pk_bf16_f32 v39, v70, v71
  v_cvt_pk_bf16_f32 v51, v78, v79
  v_cvt_pk_bf16_f32 v52, v80, v81
  v_cvt_pk_bf16_f32 v53, v82, v83
  v_cvt_pk_bf16_f32 v54, v84, v85
  v_cvt_pk_bf16_f32 v55, v86, v87
  v_cvt_pk_bf16_f32 v56, v88, v89
  v_cvt_pk_bf16_f32 v57, v90, v91
  v_cvt_pk_bf16_f32 v58, v92, v93
  v_cvt_pk_bf16_f32 v59, v94, v95
  v_cndmask_b32 v52, v52, v56, s[96:97]
  v_cndmask_b32 v53, v53, v57, s[96:97]
  v_cndmask_b32 v54, v54, v58, s[96:97]
  v_cndmask_b32 v55, v55, v59, s[96:97]
  s_lshl_b32 s61, s73, 10
  s_add_u32 s62, s61, 134217728
  buffer_store_dwordx4 v[48:51], v8, s[52:55], s62 offen sc1
  s_add_u32 s62, s61, 136314880
  buffer_store_dwordx4 v[52:55], v8, s[52:55], s62 offen sc1
  s_add_u32 s72, s72, 12
  s_min_u32 s73, s72, 63
  s_waitcnt vmcnt(2)
  ds_read_b128 v[128:131], v104 offset:0
  ds_read_b128 v[132:135], v105 offset:0
  ds_read_b128 v[136:139], v106 offset:0
  s_add_u32 s75, s70, 48
  s_min_u32 s75, s75, 63
  s_lshl_b32 s75, s75, 15
  s_waitcnt lgkmcnt(2)
  v_mfma_f32_32x32x16_bf16 v[64:79], a[0:3], v[128:131], 0
  ds_read_b128 v[140:143], v107 offset:0
  s_add_u32 m0, s74, 16384
  s_add_u32 s61, s75, 512
  buffer_load_dwordx4 v96, s[32:35], s61 offen lds
  v_mfma_f32_32x32x16_bf16 v[80:95], v[128:131], a[128:131], 0
  s_waitcnt lgkmcnt(2)
  v_mfma_f32_32x32x16_bf16 v[64:79], a[4:7], v[132:135], v[64:79]
  ds_read_b128 v[128:131], v108 offset:0
  s_add_u32 m0, s74, 17408
  s_add_u32 s61, s75, 2560
  buffer_load_dwordx4 v97, s[32:35], s61 offen lds
  v_mfma_f32_32x32x16_bf16 v[80:95], v[132:135], a[132:135], v[80:95]
  s_waitcnt lgkmcnt(2)
  v_mfma_f32_32x32x16_bf16 v[64:79], a[8:11], v[136:139], v[64:79]
  ds_read_b128 v[132:135], v109 offset:0
  s_add_u32 m0, s74, 18432
  s_add_u32 s61, s75, 4608
  buffer_load_dwordx4 v98, s[32:35], s61 offen lds
  v_mfma_f32_32x32x16_bf16 v[80:95], v[136:139], a[136:139], v[80:95]
  s_waitcnt lgkmcnt(2)
  v_mfma_f32_32x32x16_bf16 v[64:79], a[12:15], v[140:143], v[64:79]
  ds_read_b128 v[136:139], v110 offset:0
  s_add_u32 m0, s74, 19456
  s_add_u32 s61, s75, 6656
  buffer_load_dwordx4 v99, s[32:35], s61 offen lds
  v_mfma_f32_32x32x16_bf16 v[80:95], v[140:143], a[140:143], v[80:95]
  s_waitcnt lgkmcnt(2)
  v_mfma_f32_32x32x16_bf16 v[64:79], a[16:19], v[128:131], v[64:79]
  ds_read_b128 v[140:143], v111 offset:0
  s_add_u32 m0, s74, 20480
  s_add_u32 s61, s75, 8704
  buffer_load_dwordx4 v100, s[32:35], s61 offen lds
  v_mfma_f32_32x32x16_bf16 v[80:95], v[128:131], a[144:147], v[80:95]
  s_waitcnt lgkmcnt(2)
  v_mfma_f32_32x32x16_bf16 v[64:79], a[20:23], v[132:135], v[64:79]
  ds_read_b128 v[128:131], v104 offset:256
  s_add_u32 m0, s74, 21504
  s_add_u32 s61, s75, 10752
  buffer_load_dwordx4 v101, s[32:35], s61 offen lds
  v_mfma_f32_32x32x16_bf16 v[80:95], v[132:135], a[148:151], v[80:95]
  s_waitcnt lgkmcnt(2)
  v_mfma_f32_32x32x16_bf16 v[64:79], a[24:27], v[136:139], v[64:79]
  ds_read_b128 v[132:135], v105 offset:256
  s_add_u32 m0, s74, 22528
  s_add_u32 s61, s75, 12800
  buffer_load_dwordx4 v102, s[32:35], s61 offen lds
  v_mfma_f32_32x32x16_bf16 v[80:95], v[136:139], a[152:155], v[80:95]
  s_waitcnt lgkmcnt(2)
  v_mfma_f32_32x32x16_bf16 v[64:79], a[28:31], v[140:143], v[64:79]
  ds_read_b128 v[136:139], v106 offset:256
  s_add_u32 m0, s74, 23552
  s_add_u32 s61, s75, 14848
  buffer_load_dwordx4 v103, s[32:35], s61 offen lds
  v_mfma_f32_32x32x16_bf16 v[80:95], v[140:143], a[156:159], v[80:95]
  s_waitcnt lgkmcnt(2)
  v_mfma_f32_32x32x16_bf16 v[64:79], a[32:35], v[128:131], v[64:79]
  ds_read_b128 v[140:143], v107 offset:256
  s_add_u32 m0, s74, 24576
  s_add_u32 s61, s75, 16896
  buffer_load_dwordx4 v96, s[32:35], s61 offen lds
  v_mfma_f32_32x32x16_bf16 v[80:95], v[128:131], a[160:163], v[80:95]
  s_waitcnt lgkmcnt(2)
  v_mfma_f32_32x32x16_bf16 v[64:79], a[36:39], v[132:135], v[64:79]
  ds_read_b128 v[128:131], v108 offset:256
  s_add_u32 m0, s74, 25600
  s_add_u32 s61, s75, 18944
  buffer_load_dwordx4 v97, s[32:35], s61 offen lds
  v_mfma_f32_32x32x16_bf16 v[80:95], v[132:135], a[164:167], v[80:95]
  s_waitcnt lgkmcnt(2)
  v_mfma_f32_32x32x16_bf16 v[64:79], a[40:43], v[136:139], v[64:79]
  ds_read_b128 v[132:135], v109 offset:256
  s_add_u32 m0, s74, 26624
  s_add_u32 s61, s75, 20992
  buffer_load_dwordx4 v98, s[32:35], s61 offen lds
  v_mfma_f32_32x32x16_bf16 v[80:95], v[136:139], a[168:171], v[80:95]
  s_waitcnt lgkmcnt(2)
  v_mfma_f32_32x32x16_bf16 v[64:79], a[44:47], v[140:143], v[64:79]
  ds_read_b128 v[136:139], v110 offset:256
  s_add_u32 m0, s74, 27648
  s_add_u32 s61, s75, 23040
  buffer_load_dwordx4 v99, s[32:35], s61 offen lds
  v_mfma_f32_32x32x16_bf16 v[80:95], v[140:143], a[172:175], v[80:95]
  s_waitcnt lgkmcnt(2)
  v_mfma_f32_32x32x16_bf16 v[64:79], a[48:51], v[128:131], v[64:79]
  ds_read_b128 v[140:143], v111 offset:256
  s_add_u32 m0, s74, 28672
  s_add_u32 s61, s75, 25088
  buffer_load_dwordx4 v100, s[32:35], s61 offen lds
  v_mfma_f32_32x32x16_bf16 v[80:95], v[128:131], a[176:179], v[80:95]
  s_waitcnt lgkmcnt(2)
  v_mfma_f32_32x32x16_bf16 v[64:79], a[52:55], v[132:135], v[64:79]
  s_add_u32 m0, s74, 29696
  s_add_u32 s61, s75, 27136
  buffer_load_dwordx4 v101, s[32:35], s61 offen lds
  v_mfma_f32_32x32x16_bf16 v[80:95], v[132:135], a[180:183], v[80:95]
  s_waitcnt lgkmcnt(1)
  v_mfma_f32_32x32x16_bf16 v[64:79], a[56:59], v[136:139], v[64:79]
  s_add_u32 m0, s74, 30720
  s_add_u32 s61, s75, 29184
  buffer_load_dwordx4 v102, s[32:35], s61 offen lds
  v_mfma_f32_32x32x16_bf16 v[80:95], v[136:139], a[184:187], v[80:95]
  s_waitcnt lgkmcnt(0)
  v_mfma_f32_32x32x16_bf16 v[64:79], a[60:63], v[140:143], v[64:79]
  s_add_u32 m0, s74, 31744
  s_add_u32 s61, s75, 31232
  buffer_load_dwordx4 v103, s[32:35], s61 offen lds
  v_mfma_f32_32x32x16_bf16 v[80:95], v[140:143], a[188:191], v[80:95]
  s_waitcnt vmcnt(0)
  ds_read_b128 v[128:131], v104 offset:16384
  ds_read_b128 v[132:135], v105 offset:16384
  ds_read_b128 v[136:139], v106 offset:16384
  s_add_u32 s75, s70, 60
  s_min_u32 s75, s75, 63
  s_lshl_b32 s75, s75, 15
  s_waitcnt lgkmcnt(2)
  v_mfma_f32_32x32x16_bf16 v[64:79], a[64:67], v[128:131], v[64:79]
  ds_read_b128 v[140:143], v107 offset:16384
  s_add_u32 m0, s74, 0
  s_add_u32 s61, s75, 0
  buffer_load_dwordx4 v96, s[32:35], s61 offen lds
  v_mfma_f32_32x32x16_bf16 v[80:95], v[128:131], a[192:195], v[80:95]
  s_waitcnt lgkmcnt(2)
  v_mfma_f32_32x32x16_bf16 v[64:79], a[68:71], v[132:135], v[64:79]
  ds_read_b128 v[128:131], v108 offset:16384
  s_add_u32 m0, s74, 1024
  s_add_u32 s61, s75, 2048
  buffer_load_dwordx4 v97, s[32:35], s61 offen lds
  v_mfma_f32_32x32x16_bf16 v[80:95], v[132:135], a[196:199], v[80:95]
  s_waitcnt lgkmcnt(2)
  v_mfma_f32_32x32x16_bf16 v[64:79], a[72:75], v[136:139], v[64:79]
  ds_read_b128 v[132:135], v109 offset:16384
  s_add_u32 m0, s74, 2048
  s_add_u32 s61, s75, 4096
  buffer_load_dwordx4 v98, s[32:35], s61 offen lds
  v_mfma_f32_32x32x16_bf16 v[80:95], v[136:139], a[200:203], v[80:95]
  s_waitcnt lgkmcnt(2)
  v_mfma_f32_32x32x16_bf16 v[64:79], a[76:79], v[140:143], v[64:79]
  ds_read_b128 v[136:139], v110 offset:16384
  s_add_u32 m0, s74, 3072
  s_add_u32 s61, s75, 6144
  buffer_load_dwordx4 v99, s[32:35], s61 offen lds
  v_mfma_f32_32x32x16_bf16 v[80:95], v[140:143], a[204:207], v[80:95]
  s_waitcnt lgkmcnt(2)
  v_mfma_f32_32x32x16_bf16 v[64:79], a[80:83], v[128:131], v[64:79]
  ds_read_b128 v[140:143], v111 offset:16384
  s_add_u32 m0, s74, 4096
  s_add_u32 s61, s75, 8192
  buffer_load_dwordx4 v100, s[32:35], s61 offen lds
  v_mfma_f32_32x32x16_bf16 v[80:95], v[128:131], a[208:211], v[80:95]
  s_waitcnt lgkmcnt(2)
  v_mfma_f32_32x32x16_bf16 v[64:79], a[84:87], v[132:135], v[64:79]
  ds_read_b128 v[128:131], v104 offset:16640
  s_add_u32 m0, s74, 5120
  s_add_u32 s61, s75, 10240
  buffer_load_dwordx4 v101, s[32:35], s61 offen lds
  v_mfma_f32_32x32x16_bf16 v[80:95], v[132:135], a[212:215], v[80:95]
  s_waitcnt lgkmcnt(2)
  v_mfma_f32_32x32x16_bf16 v[64:79], a[88:91], v[136:139], v[64:79]
  ds_read_b128 v[132:135], v105 offset:16640
  s_add_u32 m0, s74, 6144
  s_add_u32 s61, s75, 12288
  buffer_load_dwordx4 v102, s[32:35], s61 offen lds
  v_mfma_f32_32x32x16_bf16 v[80:95], v[136:139], a[216:219], v[80:95]
  s_waitcnt lgkmcnt(2)
  v_mfma_f32_32x32x16_bf16 v[64:79], a[92:95], v[140:143], v[64:79]
  ds_read_b128 v[136:139], v106 offset:16640
  s_add_u32 m0, s74, 7168
  s_add_u32 s61, s75, 14336
  buffer_load_dwordx4 v103, s[32:35], s61 offen lds
  v_mfma_f32_32x32x16_bf16 v[80:95], v[140:143], a[220:223], v[80:95]
  s_waitcnt lgkmcnt(2)
  v_mfma_f32_32x32x16_bf16 v[64:79], a[96:99], v[128:131], v[64:79]
  ds_read_b128 v[140:143], v107 offset:16640
  s_add_u32 m0, s74, 8192
  s_add_u32 s61, s75, 16384
  buffer_load_dwordx4 v96, s[32:35], s61 offen lds
  v_mfma_f32_32x32x16_bf16 v[80:95], v[128:131], a[224:227], v[80:95]
  s_waitcnt lgkmcnt(2)
  v_mfma_f32_32x32x16_bf16 v[64:79], a[100:103], v[132:135], v[64:79]
  ds_read_b128 v[128:131], v108 offset:16640
  s_add_u32 m0, s74, 9216
  s_add_u32 s61, s75, 18432
  buffer_load_dwordx4 v97, s[32:35], s61 offen lds
  v_mfma_f32_32x32x16_bf16 v[80:95], v[132:135], a[228:231], v[80:95]
  s_waitcnt lgkmcnt(2)
  v_mfma_f32_32x32x16_bf16 v[64:79], a[104:107], v[136:139], v[64:79]
  ds_read_b128 v[132:135], v109 offset:16640
  s_add_u32 m0, s74, 10240
  s_add_u32 s61, s75, 20480
  buffer_load_dwordx4 v98, s[32:35], s61 offen lds
  v_mfma_f32_32x32x16_bf16 v[80:95], v[136:139], a[232:235], v[80:95]
  s_waitcnt lgkmcnt(2)
  v_mfma_f32_32x32x16_bf16 v[64:79], a[108:111], v[140:143], v[64:79]
  ds_read_b128 v[136:139], v110 offset:16640
  s_add_u32 m0, s74, 11264
  s_add_u32 s61, s75, 22528
  buffer_load_dwordx4 v99, s[32:35], s61 offen lds
  v_mfma_f32_32x32x16_bf16 v[80:95], v[140:143], a[236:239], v[80:95]
  s_waitcnt lgkmcnt(2)
  v_mfma_f32_32x32x16_bf16 v[64:79], a[112:115], v[128:131], v[64:79]
  ds_read_b128 v[140:143], v111 offset:16640
  s_add_u32 m0, s74, 12288
  s_add_u32 s61, s75, 24576
  buffer_load_dwordx4 v100, s[32:35], s61 offen lds
  v_mfma_f32_32x32x16_bf16 v[80:95], v[128:131], a[240:243], v[80:95]
  s_waitcnt lgkmcnt(2)
  v_mfma_f32_32x32x16_bf16 v[64:79], a[116:119], v[132:135], v[64:79]
  s_add_u32 m0, s74, 13312
  s_add_u32 s61, s75, 26624
  buffer_load_dwordx4 v101, s[32:35], s61 offen lds
  v_mfma_f32_32x32x16_bf16 v[80:95], v[132:135], a[244:247], v[80:95]
  s_waitcnt lgkmcnt(1)
  v_mfma_f32_32x32x16_bf16 v[64:79], a[120:123], v[136:139], v[64:79]
  s_add_u32 m0, s74, 14336
  s_add_u32 s61, s75, 28672
  buffer_load_dwordx4 v102, s[32:35], s61 offen lds
  v_mfma_f32_32x32x16_bf16 v[80:95], v[136:139], a[248:251], v[80:95]
  s_waitcnt lgkmcnt(0)
  v_mfma_f32_32x32x16_bf16 v[64:79], a[124:127], v[140:143], v[64:79]
  s_add_u32 m0, s74, 15360
  s_add_u32 s61, s75, 30720
  buffer_load_dwordx4 v103, s[32:35], s61 offen lds
  v_mfma_f32_32x32x16_bf16 v[80:95], v[140:143], a[252:255], v[80:95]
  s_nop 3
  v_mul_f32 v64, s79, v64
  v_mul_f32 v65, s79, v65
  v_mul_f32 v66, s79, v66
  v_mul_f32 v67, s79, v67
  v_mul_f32 v68, s79, v68
  v_mul_f32 v69, s79, v69
  v_mul_f32 v70, s79, v70
  v_mul_f32 v71, s79, v71
  v_cvt_pk_bf16_f32 v40, v64, v65
  v_cvt_pk_bf16_f32 v48, v72, v73
  v_cvt_pk_bf16_f32 v41, v66, v67
  v_cvt_pk_bf16_f32 v49, v74, v75
  v_cvt_pk_bf16_f32 v42, v68, v69
  v_cvt_pk_bf16_f32 v50, v76, v77
  v_cvt_pk_bf16_f32 v43, v70, v71
  v_cvt_pk_bf16_f32 v51, v78, v79
  v_cvt_pk_bf16_f32 v52, v80, v81
  v_cvt_pk_bf16_f32 v53, v82, v83
  v_cvt_pk_bf16_f32 v54, v84, v85
  v_cvt_pk_bf16_f32 v55, v86, v87
  v_cvt_pk_bf16_f32 v56, v88, v89
  v_cvt_pk_bf16_f32 v57, v90, v91
  v_cvt_pk_bf16_f32 v58, v92, v93
  v_cvt_pk_bf16_f32 v59, v94, v95
  v_cndmask_b32 v52, v52, v56, s[96:97]
  v_cndmask_b32 v53, v53, v57, s[96:97]
  v_cndmask_b32 v54, v54, v58, s[96:97]
  v_cndmask_b32 v55, v55, v59, s[96:97]
  s_lshl_b32 s61, s73, 10
  s_add_u32 s62, s61, 134217728
  buffer_store_dwordx4 v[48:51], v8, s[52:55], s62 offen sc1
  s_add_u32 s62, s61, 136314880
  buffer_store_dwordx4 v[52:55], v8, s[52:55], s62 offen sc1
  s_add_u32 s72, s72, 12
  s_min_u32 s73, s72, 63
  s_waitcnt vmcnt(2)
  ds_read_b128 v[128:131], v104 offset:0
  ds_read_b128 v[132:135], v105 offset:0
  ds_read_b128 v[136:139], v106 offset:0
  s_add_u32 s75, s70, 60
  s_min_u32 s75, s75, 63
  s_lshl_b32 s75, s75, 15
  s_waitcnt lgkmcnt(2)
  v_mfma_f32_32x32x16_bf16 v[64:79], a[0:3], v[128:131], 0
  ds_read_b128 v[140:143], v107 offset:0
  s_add_u32 m0, s74, 16384
  s_add_u32 s61, s75, 512
  buffer_load_dwordx4 v96, s[32:35], s61 offen lds
  v_mfma_f32_32x32x16_bf16 v[80:95], v[128:131], a[128:131], 0
  s_waitcnt lgkmcnt(2)
  v_mfma_f32_32x32x16_bf16 v[64:79], a[4:7], v[132:135], v[64:79]
  ds_read_b128 v[128:131], v108 offset:0
  s_add_u32 m0, s74, 17408
  s_add_u32 s61, s75, 2560
  buffer_load_dwordx4 v97, s[32:35], s61 offen lds
  v_mfma_f32_32x32x16_bf16 v[80:95], v[132:135], a[132:135], v[80:95]
  s_waitcnt lgkmcnt(2)
  v_mfma_f32_32x32x16_bf16 v[64:79], a[8:11], v[136:139], v[64:79]
  ds_read_b128 v[132:135], v109 offset:0
  s_add_u32 m0, s74, 18432
  s_add_u32 s61, s75, 4608
  buffer_load_dwordx4 v98, s[32:35], s61 offen lds
  v_mfma_f32_32x32x16_bf16 v[80:95], v[136:139], a[136:139], v[80:95]
  s_waitcnt lgkmcnt(2)
  v_mfma_f32_32x32x16_bf16 v[64:79], a[12:15], v[140:143], v[64:79]
  ds_read_b128 v[136:139], v110 offset:0
  s_add_u32 m0, s74, 19456
  s_add_u32 s61, s75, 6656
  buffer_load_dwordx4 v99, s[32:35], s61 offen lds
  v_mfma_f32_32x32x16_bf16 v[80:95], v[140:143], a[140:143], v[80:95]
  s_waitcnt lgkmcnt(2)
  v_mfma_f32_32x32x16_bf16 v[64:79], a[16:19], v[128:131], v[64:79]
  ds_read_b128 v[140:143], v111 offset:0
  s_add_u32 m0, s74, 20480
  s_add_u32 s61, s75, 8704
  buffer_load_dwordx4 v100, s[32:35], s61 offen lds
  v_mfma_f32_32x32x16_bf16 v[80:95], v[128:131], a[144:147], v[80:95]
  s_waitcnt lgkmcnt(2)
  v_mfma_f32_32x32x16_bf16 v[64:79], a[20:23], v[132:135], v[64:79]
  ds_read_b128 v[128:131], v104 offset:256
  s_add_u32 m0, s74, 21504
  s_add_u32 s61, s75, 10752
  buffer_load_dwordx4 v101, s[32:35], s61 offen lds
  v_mfma_f32_32x32x16_bf16 v[80:95], v[132:135], a[148:151], v[80:95]
  s_waitcnt lgkmcnt(2)
  v_mfma_f32_32x32x16_bf16 v[64:79], a[24:27], v[136:139], v[64:79]
  ds_read_b128 v[132:135], v105 offset:256
  s_add_u32 m0, s74, 22528
  s_add_u32 s61, s75, 12800
  buffer_load_dwordx4 v102, s[32:35], s61 offen lds
  v_mfma_f32_32x32x16_bf16 v[80:95], v[136:139], a[152:155], v[80:95]
  s_waitcnt lgkmcnt(2)
  v_mfma_f32_32x32x16_bf16 v[64:79], a[28:31], v[140:143], v[64:79]
  ds_read_b128 v[136:139], v106 offset:256
  s_add_u32 m0, s74, 23552
  s_add_u32 s61, s75, 14848
  buffer_load_dwordx4 v103, s[32:35], s61 offen lds
  v_mfma_f32_32x32x16_bf16 v[80:95], v[140:143], a[156:159], v[80:95]
  s_waitcnt lgkmcnt(2)
  v_mfma_f32_32x32x16_bf16 v[64:79], a[32:35], v[128:131], v[64:79]
  ds_read_b128 v[140:143], v107 offset:256
  s_add_u32 m0, s74, 24576
  s_add_u32 s61, s75, 16896
  buffer_load_dwordx4 v96, s[32:35], s61 offen lds
  v_mfma_f32_32x32x16_bf16 v[80:95], v[128:131], a[160:163], v[80:95]
  s_waitcnt lgkmcnt(2)
  v_mfma_f32_32x32x16_bf16 v[64:79], a[36:39], v[132:135], v[64:79]
  ds_read_b128 v[128:131], v108 offset:256
  s_add_u32 m0, s74, 25600
  s_add_u32 s61, s75, 18944
  buffer_load_dwordx4 v97, s[32:35], s61 offen lds
  v_mfma_f32_32x32x16_bf16 v[80:95], v[132:135], a[164:167], v[80:95]
  s_waitcnt lgkmcnt(2)
  v_mfma_f32_32x32x16_bf16 v[64:79], a[40:43], v[136:139], v[64:79]
  ds_read_b128 v[132:135], v109 offset:256
  s_add_u32 m0, s74, 26624
  s_add_u32 s61, s75, 20992
  buffer_load_dwordx4 v98, s[32:35], s61 offen lds
  v_mfma_f32_32x32x16_bf16 v[80:95], v[136:139], a[168:171], v[80:95]
  s_waitcnt lgkmcnt(2)
  v_mfma_f32_32x32x16_bf16 v[64:79], a[44:47], v[140:143], v[64:79]
  ds_read_b128 v[136:139], v110 offset:256
  s_add_u32 m0, s74, 27648
  s_add_u32 s61, s75, 23040
  buffer_load_dwordx4 v99, s[32:35], s61 offen lds
  v_mfma_f32_32x32x16_bf16 v[80:95], v[140:143], a[172:175], v[80:95]
  s_waitcnt lgkmcnt(2)
  v_mfma_f32_32x32x16_bf16 v[64:79], a[48:51], v[128:131], v[64:79]
  ds_read_b128 v[140:143], v111 offset:256
  s_add_u32 m0, s74, 28672
  s_add_u32 s61, s75, 25088
  buffer_load_dwordx4 v100, s[32:35], s61 offen lds
  v_mfma_f32_32x32x16_bf16 v[80:95], v[128:131], a[176:179], v[80:95]
  s_waitcnt lgkmcnt(2)
  v_mfma_f32_32x32x16_bf16 v[64:79], a[52:55], v[132:135], v[64:79]
  s_add_u32 m0, s74, 29696
  s_add_u32 s61, s75, 27136
  buffer_load_dwordx4 v101, s[32:35], s61 offen lds
  v_mfma_f32_32x32x16_bf16 v[80:95], v[132:135], a[180:183], v[80:95]
  s_waitcnt lgkmcnt(1)
  v_mfma_f32_32x32x16_bf16 v[64:79], a[56:59], v[136:139], v[64:79]
  s_add_u32 m0, s74, 30720
  s_add_u32 s61, s75, 29184
  buffer_load_dwordx4 v102, s[32:35], s61 offen lds
  v_mfma_f32_32x32x16_bf16 v[80:95], v[136:139], a[184:187], v[80:95]
  s_waitcnt lgkmcnt(0)
  v_mfma_f32_32x32x16_bf16 v[64:79], a[60:63], v[140:143], v[64:79]
  s_add_u32 m0, s74, 31744
  s_add_u32 s61, s75, 31232
  buffer_load_dwordx4 v103, s[32:35], s61 offen lds
  v_mfma_f32_32x32x16_bf16 v[80:95], v[140:143], a[188:191], v[80:95]
  s_waitcnt vmcnt(0)
  ds_read_b128 v[128:131], v104 offset:16384
  ds_read_b128 v[132:135], v105 offset:16384
  ds_read_b128 v[136:139], v106 offset:16384
  s_waitcnt lgkmcnt(2)
  v_mfma_f32_32x32x16_bf16 v[64:79], a[64:67], v[128:131], v[64:79]
  ds_read_b128 v[140:143], v107 offset:16384
  v_mfma_f32_32x32x16_bf16 v[80:95], v[128:131], a[192:195], v[80:95]
  s_waitcnt lgkmcnt(2)
  v_mfma_f32_32x32x16_bf16 v[64:79], a[68:71], v[132:135], v[64:79]
  ds_read_b128 v[128:131], v108 offset:16384
  v_mfma_f32_32x32x16_bf16 v[80:95], v[132:135], a[196:199], v[80:95]
  s_waitcnt lgkmcnt(2)
  v_mfma_f32_32x32x16_bf16 v[64:79], a[72:75], v[136:139], v[64:79]
  ds_read_b128 v[132:135], v109 offset:16384
  v_mfma_f32_32x32x16_bf16 v[80:95], v[136:139], a[200:203], v[80:95]
  s_waitcnt lgkmcnt(2)
  v_mfma_f32_32x32x16_bf16 v[64:79], a[76:79], v[140:143], v[64:79]
  ds_read_b128 v[136:139], v110 offset:16384
  v_mfma_f32_32x32x16_bf16 v[80:95], v[140:143], a[204:207], v[80:95]
  s_waitcnt lgkmcnt(2)
  v_mfma_f32_32x32x16_bf16 v[64:79], a[80:83], v[128:131], v[64:79]
  ds_read_b128 v[140:143], v111 offset:16384
  v_mfma_f32_32x32x16_bf16 v[80:95], v[128:131], a[208:211], v[80:95]
  s_waitcnt lgkmcnt(2)
  v_mfma_f32_32x32x16_bf16 v[64:79], a[84:87], v[132:135], v[64:79]
  ds_read_b128 v[128:131], v104 offset:16640
  v_mfma_f32_32x32x16_bf16 v[80:95], v[132:135], a[212:215], v[80:95]
  s_waitcnt lgkmcnt(2)
  v_mfma_f32_32x32x16_bf16 v[64:79], a[88:91], v[136:139], v[64:79]
  ds_read_b128 v[132:135], v105 offset:16640
  v_mfma_f32_32x32x16_bf16 v[80:95], v[136:139], a[216:219], v[80:95]
  s_waitcnt lgkmcnt(2)
  v_mfma_f32_32x32x16_bf16 v[64:79], a[92:95], v[140:143], v[64:79]
  ds_read_b128 v[136:139], v106 offset:16640
  v_mfma_f32_32x32x16_bf16 v[80:95], v[140:143], a[220:223], v[80:95]
  s_waitcnt lgkmcnt(2)
  v_mfma_f32_32x32x16_bf16 v[64:79], a[96:99], v[128:131], v[64:79]
  ds_read_b128 v[140:143], v107 offset:16640
  v_mfma_f32_32x32x16_bf16 v[80:95], v[128:131], a[224:227], v[80:95]
  s_waitcnt lgkmcnt(2)
  v_mfma_f32_32x32x16_bf16 v[64:79], a[100:103], v[132:135], v[64:79]
  ds_read_b128 v[128:131], v108 offset:16640
  v_mfma_f32_32x32x16_bf16 v[80:95], v[132:135], a[228:231], v[80:95]
  s_waitcnt lgkmcnt(2)
  v_mfma_f32_32x32x16_bf16 v[64:79], a[104:107], v[136:139], v[64:79]
  ds_read_b128 v[132:135], v109 offset:16640
  v_mfma_f32_32x32x16_bf16 v[80:95], v[136:139], a[232:235], v[80:95]
  s_waitcnt lgkmcnt(2)
  v_mfma_f32_32x32x16_bf16 v[64:79], a[108:111], v[140:143], v[64:79]
  ds_read_b128 v[136:139], v110 offset:16640
  v_mfma_f32_32x32x16_bf16 v[80:95], v[140:143], a[236:239], v[80:95]
  s_waitcnt lgkmcnt(2)
  v_mfma_f32_32x32x16_bf16 v[64:79], a[112:115], v[128:131], v[64:79]
  ds_read_b128 v[140:143], v111 offset:16640
  v_mfma_f32_32x32x16_bf16 v[80:95], v[128:131], a[240:243], v[80:95]
  s_waitcnt lgkmcnt(2)
  v_mfma_f32_32x32x16_bf16 v[64:79], a[116:119], v[132:135], v[64:79]
  v_mfma_f32_32x32x16_bf16 v[80:95], v[132:135], a[244:247], v[80:95]
  s_waitcnt lgkmcnt(1)
  v_mfma_f32_32x32x16_bf16 v[64:79], a[120:123], v[136:139], v[64:79]
  v_mfma_f32_32x32x16_bf16 v[80:95], v[136:139], a[248:251], v[80:95]
  s_waitcnt lgkmcnt(0)
  v_mfma_f32_32x32x16_bf16 v[64:79], a[124:127], v[140:143], v[64:79]
  v_mfma_f32_32x32x16_bf16 v[80:95], v[140:143], a[252:255], v[80:95]
  s_nop 3
  v_mul_f32 v64, s79, v64
  v_mul_f32 v65, s79, v65
  v_mul_f32 v66, s79, v66
  v_mul_f32 v67, s79, v67
  v_mul_f32 v68, s79, v68
  v_mul_f32 v69, s79, v69
  v_mul_f32 v70, s79, v70
  v_mul_f32 v71, s79, v71
  v_cvt_pk_bf16_f32 v44, v64, v65
  v_cvt_pk_bf16_f32 v48, v72, v73
  v_cvt_pk_bf16_f32 v45, v66, v67
  v_cvt_pk_bf16_f32 v49, v74, v75
  v_cvt_pk_bf16_f32 v46, v68, v69
  v_cvt_pk_bf16_f32 v50, v76, v77
  v_cvt_pk_bf16_f32 v47, v70, v71
  v_cvt_pk_bf16_f32 v51, v78, v79
  v_cvt_pk_bf16_f32 v52, v80, v81
  v_cvt_pk_bf16_f32 v53, v82, v83
  v_cvt_pk_bf16_f32 v54, v84, v85
  v_cvt_pk_bf16_f32 v55, v86, v87
  v_cvt_pk_bf16_f32 v56, v88, v89
  v_cvt_pk_bf16_f32 v57, v90, v91
  v_cvt_pk_bf16_f32 v58, v92, v93
  v_cvt_pk_bf16_f32 v59, v94, v95
  v_cndmask_b32 v52, v52, v56, s[96:97]
  v_cndmask_b32 v53, v53, v57, s[96:97]
  v_cndmask_b32 v54, v54, v58, s[96:97]
  v_cndmask_b32 v55, v55, v59, s[96:97]
  s_lshl_b32 s61, s73, 10
  s_add_u32 s62, s61, 134217728
  buffer_store_dwordx4 v[48:51], v8, s[52:55], s62 offen sc1
  s_add_u32 s62, s61, 136314880
  buffer_store_dwordx4 v[52:55], v8, s[52:55], s62 offen sc1
  s_add_u32 s72, s72, 12
L_wd_156:
  s_sub_u32 s56, s56, 1
  s_cbranch_scc1 L_timeout
  s_mov_b64 exec, 1
  buffer_load_dword v1, off, s[48:51], 0 offset:228 sc1
  s_mov_b64 exec, -1
  s_waitcnt vmcnt(0)
  v_readfirstlane_b32 s57, v1
  s_nop 0
  s_cmp_ge_u32 s57, 1
  s_cbranch_scc1 L_wd_157
  s_sleep 8
  s_branch L_wd_156
L_wd_157:
  s_barrier
  s_lshl_b32 s61, s6, 9
  s_add_u32 s61, s61, 32768
  s_lshl_b32 s62, s60, 7
  s_add_u32 s62, s62, s61
  v_mov_b32 v1, s62
  v_mov_b32 v2, 1
  s_mov_b64 exec, 1
  buffer_store_dword v2, v1, s[52:55], 0 offen sc1
  s_mov_b64 exec, -1
  ds_read_b64_tr_b16 a[128:129], v13 offset:0
  ds_read_b64_tr_b16 a[130:131], v13 offset:512
  ds_read_b64_tr_b16 a[132:133], v13 offset:1024
  ds_read_b64_tr_b16 a[134:135], v13 offset:1536
  ds_read_b64_tr_b16 a[136:137], v13 offset:2048
  ds_read_b64_tr_b16 a[138:139], v13 offset:2560
  ds_read_b64_tr_b16 a[140:141], v13 offset:3072
  ds_read_b64_tr_b16 a[142:143], v13 offset:3584
  s_waitcnt lgkmcnt(0)
  ds_read_b64_tr_b16 a[144:145], v13 offset:4096
  ds_read_b64_tr_b16 a[146:147], v13 offset:4608
  ds_read_b64_tr_b16 a[148:149], v13 offset:5120
  ds_read_b64_tr_b16 a[150:151], v13 offset:5632
  ds_read_b64_tr_b16 a[152:153], v13 offset:6144
  ds_read_b64_tr_b16 a[154:155], v13 offset:6656
  ds_read_b64_tr_b16 a[156:157], v13 offset:7168
  ds_read_b64_tr_b16 a[158:159], v13 offset:7680
  s_waitcnt lgkmcnt(0)
  ds_read_b64_tr_b16 a[160:161], v13 offset:8192
  ds_read_b64_tr_b16 a[162:163], v13 offset:8704
  ds_read_b64_tr_b16 a[164:165], v13 offset:9216
  ds_read_b64_tr_b16 a[166:167], v13 offset:9728
  ds_read_b64_tr_b16 a[168:169], v13 offset:10240
  ds_read_b64_tr_b16 a[170:171], v13 offset:10752
  ds_read_b64_tr_b16 a[172:173], v13 offset:11264
  ds_read_b64_tr_b16 a[174:175], v13 offset:11776
  s_waitcnt lgkmcnt(0)
  ds_read_b64_tr_b16 a[176:177], v13 offset:12288
  ds_read_b64_tr_b16 a[178:179], v13 offset:12800
  ds_read_b64_tr_b16 a[180:181], v13 offset:13312
  ds_read_b64_tr_b16 a[182:183], v13 offset:13824
  ds_read_b64_tr_b16 a[184:185], v13 offset:14336
  ds_read_b64_tr_b16 a[186:187], v13 offset:14848
  ds_read_b64_tr_b16 a[188:189], v13 offset:15360
  ds_read_b64_tr_b16 a[190:191], v13 offset:15872
  s_waitcnt lgkmcnt(0)
  ds_read_b64_tr_b16 a[192:193], v13 offset:16384
  ds_read_b64_tr_b16 a[194:195], v13 offset:16896
  ds_read_b64_tr_b16 a[196:197], v13 offset:17408
  ds_read_b64_tr_b16 a[198:199], v13 offset:17920
  ds_read_b64_tr_b16 a[200:201], v13 offset:18432
  ds_read_b64_tr_b16 a[202:203], v13 offset:18944
  ds_read_b64_tr_b16 a[204:205], v13 offset:19456
  ds_read_b64_tr_b16 a[206:207], v13 offset:19968
  s_waitcnt lgkmcnt(0)
  ds_read_b64_tr_b16 a[208:209], v13 offset:20480
  ds_read_b64_tr_b16 a[210:211], v13 offset:20992
  ds_read_b64_tr_b16 a[212:213], v13 offset:21504
  ds_read_b64_tr_b16 a[214:215], v13 offset:22016
  ds_read_b64_tr_b16 a[216:217], v13 offset:22528
  ds_read_b64_tr_b16 a[218:219], v13 offset:23040
  ds_read_b64_tr_b16 a[220:221], v13 offset:23552
  ds_read_b64_tr_b16 a[222:223], v13 offset:24064
  s_waitcnt lgkmcnt(0)
  ds_read_b64_tr_b16 a[224:225], v13 offset:24576
  ds_read_b64_tr_b16 a[226:227], v13 offset:25088
  ds_read_b64_tr_b16 a[228:229], v13 offset:25600
  ds_read_b64_tr_b16 a[230:231], v13 offset:26112
  ds_read_b64_tr_b16 a[232:233], v13 offset:26624
  ds_read_b64_tr_b16 a[234:235], v13 offset:27136
  ds_read_b64_tr_b16 a[236:237], v13 offset:27648
  ds_read_b64_tr_b16 a[238:239], v13 offset:28160
  s_waitcnt lgkmcnt(0)
  ds_read_b64_tr_b16 a[240:241], v13 offset:28672
  ds_read_b64_tr_b16 a[242:243], v13 offset:29184
  ds_read_b64_tr_b16 a[244:245], v13 offset:29696
  ds_read_b64_tr_b16 a[246:247], v13 offset:30208
  ds_read_b64_tr_b16 a[248:249], v13 offset:30720
  ds_read_b64_tr_b16 a[250:251], v13 offset:31232
  ds_read_b64_tr_b16 a[252:253], v13 offset:31744
  ds_read_b64_tr_b16 a[254:255], v13 offset:32256
  s_waitcnt lgkmcnt(0)
  v_min_u32 v1, 2, v0
  v_lshlrev_b32 v1, 7, v1
  v_add_u32 v1, s61, v1
L_b_w1:
  s_sub_u32 s56, s56, 1
  s_cbranch_scc1 L_timeout
  buffer_load_dword v2, v1, s[52:55], 0 offen sc1
  s_waitcnt vmcnt(0)
  v_cmp_ne_u32 vcc, 1, v2
  s_cbranch_vccz L_b_g1
  s_sleep 8
  s_branch L_b_w1
L_b_g1:
  s_lshl_b32 s63, s4, 14
  s_add_u32 m0, s63, 0
  s_add_u32 s61, s63, 134217728
  buffer_load_dwordx4 v8, s[52:55], s61 offen offset:0 sc1 lds
  buffer_load_dwordx4 v8, s[52:55], s61 offen offset:1024 sc1 lds
  buffer_load_dwordx4 v8, s[52:55], s61 offen offset:2048 sc1 lds
  buffer_load_dwordx4 v8, s[52:55], s61 offen offset:3072 sc1 lds
  s_add_u32 m0, s63, 4096
  s_add_u32 s61, s63, 134221824
  buffer_load_dwordx4 v8, s[52:55], s61 offen offset:0 sc1 lds
  buffer_load_dwordx4 v8, s[52:55], s61 offen offset:1024 sc1 lds
  buffer_load_dwordx4 v8, s[52:55], s61 offen offset:2048 sc1 lds
  buffer_load_dwordx4 v8, s[52:55], s61 offen offset:3072 sc1 lds
  s_add_u32 m0, s63, 8192
  s_add_u32 s61, s63, 134225920
  buffer_load_dwordx4 v8, s[52:55], s61 offen offset:0 sc1 lds
  buffer_load_dwordx4 v8, s[52:55], s61 offen offset:1024 sc1 lds
  buffer_load_dwordx4 v8, s[52:55], s61 offen offset:2048 sc1 lds
  buffer_load_dwordx4 v8, s[52:55], s61 offen offset:3072 sc1 lds
  s_add_u32 m0, s63, 12288
  s_add_u32 s61, s63, 134230016
  buffer_load_dwordx4 v8, s[52:55], s61 offen offset:0 sc1 lds
  buffer_load_dwordx4 v8, s[52:55], s61 offen offset:1024 sc1 lds
  buffer_load_dwordx4 v8, s[52:55], s61 offen offset:2048 sc1 lds
  buffer_load_dwordx4 v8, s[52:55], s61 offen offset:3072 sc1 lds
  s_add_u32 m0, s63, 65536
  s_add_u32 s61, s63, 136314880
  buffer_load_dwordx4 v8, s[52:55], s61 offen offset:0 sc1 lds
  buffer_load_dwordx4 v8, s[52:55], s61 offen offset:1024 sc1 lds
  buffer_load_dwordx4 v8, s[52:55], s61 offen offset:2048 sc1 lds
  buffer_load_dwordx4 v8, s[52:55], s61 offen offset:3072 sc1 lds
  s_add_u32 m0, s63, 69632
  s_add_u32 s61, s63, 136318976
  buffer_load_dwordx4 v8, s[52:55], s61 offen offset:0 sc1 lds
  buffer_load_dwordx4 v8, s[52:55], s61 offen offset:1024 sc1 lds
  buffer_load_dwordx4 v8, s[52:55], s61 offen offset:2048 sc1 lds
  buffer_load_dwordx4 v8, s[52:55], s61 offen offset:3072 sc1 lds
  s_add_u32 m0, s63, 73728
  s_add_u32 s61, s63, 136323072
  buffer_load_dwordx4 v8, s[52:55], s61 offen offset:0 sc1 lds
  buffer_load_dwordx4 v8, s[52:55], s61 offen offset:1024 sc1 lds
  buffer_load_dwordx4 v8, s[52:55], s61 offen offset:2048 sc1 lds
  buffer_load_dwordx4 v8, s[52:55], s61 offen offset:3072 sc1 lds
  s_add_u32 m0, s63, 77824
  s_add_u32 s61, s63, 136327168
  buffer_load_dwordx4 v8, s[52:55], s61 offen offset:0 sc1 lds
  buffer_load_dwordx4 v8, s[52:55], s61 offen offset:1024 sc1 lds
  buffer_load_dwordx4 v8, s[52:55], s61 offen offset:2048 sc1 lds
  buffer_load_dwordx4 v8, s[52:55], s61 offen offset:3072 sc1 lds
  v_mov_b32 v48, 0xff61b1e6
  v_mov_b32 v49, 0xff61b1e6
  v_mov_b32 v50, 0xff61b1e6
  v_mov_b32 v51, 0xff61b1e6
  v_mov_b32 v52, 0xff61b1e6
  v_mov_b32 v53, 0xff61b1e6
  v_accvgpr_write_b32 a0, 0
  v_accvgpr_write_b32 a1, 0
  v_accvgpr_write_b32 a2, 0
  v_accvgpr_write_b32 a3, 0
  v_accvgpr_write_b32 a4, 0
  v_accvgpr_write_b32 a5, 0
  v_accvgpr_write_b32 a6, 0
  v_accvgpr_write_b32 a7, 0
  v_accvgpr_write_b32 a8, 0
  v_accvgpr_write_b32 a9, 0
  v_accvgpr_write_b32 a10, 0
  v_accvgpr_write_b32 a11, 0
  v_accvgpr_write_b32 a12, 0
  v_accvgpr_write_b32 a13, 0
  v_accvgpr_write_b32 a14, 0
  v_accvgpr_write_b32 a15, 0
  v_accvgpr_write_b32 a16, 0
  v_accvgpr_write_b32 a17, 0
  v_accvgpr_write_b32 a18, 0
  v_accvgpr_write_b32 a19, 0
  v_accvgpr_write_b32 a20, 0
  v_accvgpr_write_b32 a21, 0
  v_accvgpr_write_b32 a22, 0
  v_accvgpr_write_b32 a23, 0
  v_accvgpr_write_b32 a24, 0
  v_accvgpr_write_b32 a25, 0
  v_accvgpr_write_b32 a26, 0
  v_accvgpr_write_b32 a27, 0
  v_accvgpr_write_b32 a28, 0
  v_accvgpr_write_b32 a29, 0
  v_accvgpr_write_b32 a30, 0
  v_accvgpr_write_b32 a31, 0
  v_accvgpr_write_b32 a32, 0
  v_accvgpr_write_b32 a33, 0
  v_accvgpr_write_b32 a34, 0
  v_accvgpr_write_b32 a35, 0
  v_accvgpr_write_b32 a36, 0
  v_accvgpr_write_b32 a37, 0
  v_accvgpr_write_b32 a38, 0
  v_accvgpr_write_b32 a39, 0
  v_accvgpr_write_b32 a40, 0
  v_accvgpr_write_b32 a41, 0
  v_accvgpr_write_b32 a42, 0
  v_accvgpr_write_b32 a43, 0
  v_accvgpr_write_b32 a44, 0
  v_accvgpr_write_b32 a45, 0
  v_accvgpr_write_b32 a46, 0
  v_accvgpr_write_b32 a47, 0
  v_accvgpr_write_b32 a48, 0
  v_accvgpr_write_b32 a49, 0
  v_accvgpr_write_b32 a50, 0
  v_accvgpr_write_b32 a51, 0
  v_accvgpr_write_b32 a52, 0
  v_accvgpr_write_b32 a53, 0
  v_accvgpr_write_b32 a54, 0
  v_accvgpr_write_b32 a55, 0
  v_accvgpr_write_b32 a56, 0
  v_accvgpr_write_b32 a57, 0
  v_accvgpr_write_b32 a58, 0
  v_accvgpr_write_b32 a59, 0
  v_accvgpr_write_b32 a60, 0
  v_accvgpr_write_b32 a61, 0
  v_accvgpr_write_b32 a62, 0
  v_accvgpr_write_b32 a63, 0
  v_accvgpr_write_b32 a64, 0
  v_accvgpr_write_b32 a65, 0
  v_accvgpr_write_b32 a66, 0
  v_accvgpr_write_b32 a67, 0
  v_accvgpr_write_b32 a68, 0
  v_accvgpr_write_b32 a69, 0
  v_accvgpr_write_b32 a70, 0
  v_accvgpr_write_b32 a71, 0
  v_accvgpr_write_b32 a72, 0
  v_accvgpr_write_b32 a73, 0
  v_accvgpr_write_b32 a74, 0
  v_accvgpr_write_b32 a75, 0
  v_accvgpr_write_b32 a76, 0
  v_accvgpr_write_b32 a77, 0
  v_accvgpr_write_b32 a78, 0
  v_accvgpr_write_b32 a79, 0
  v_accvgpr_write_b32 a80, 0
  v_accvgpr_write_b32 a81, 0
  v_accvgpr_write_b32 a82, 0
  v_accvgpr_write_b32 a83, 0
  v_accvgpr_write_b32 a84, 0
  v_accvgpr_write_b32 a85, 0
  v_accvgpr_write_b32 a86, 0
  v_accvgpr_write_b32 a87, 0
  v_accvgpr_write_b32 a88, 0
  v_accvgpr_write_b32 a89, 0
  v_accvgpr_write_b32 a90, 0
  v_accvgpr_write_b32 a91, 0
  v_accvgpr_write_b32 a92, 0
  v_accvgpr_write_b32 a93, 0
  v_accvgpr_write_b32 a94, 0
  v_accvgpr_write_b32 a95, 0
  s_waitcnt vmcnt(0)
  s_barrier
  v_mov_b32 v15, v4
  ds_read_b128 v[56:59], v15
  s_mov_b32 s71, 0
L_b_p1:
  ds_read_b128 v[60:63], v15 offset:1024
  s_waitcnt lgkmcnt(1)
  v_mfma_f32_32x32x16_bf16 v[64:79], v[56:59], v[24:27], 0
  v_mfma_f32_32x32x16_bf16 v[80:95], v[56:59], v[28:31], 0
  v_mfma_f32_32x32x16_bf16 v[96:111], v[56:59], v[32:35], 0
  v_max3_f32 v48, v48, v64, v65
  v_max3_f32 v48, v48, v66, v67
  v_max3_f32 v48, v48, v68, v69
  v_max3_f32 v48, v48, v70, v71
  v_max3_f32 v48, v48, v72, v73
  v_max3_f32 v48, v48, v74, v75
  v_max3_f32 v48, v48, v76, v77
  v_max3_f32 v48, v48, v78, v79
  v_mfma_f32_32x32x16_bf16 v[64:79], v[56:59], v[36:39], 0
  v_max3_f32 v49, v49, v80, v81
  v_max3_f32 v49, v49, v82, v83
  v_max3_f32 v49, v49, v84, v85
  v_max3_f32 v49, v49, v86, v87
  v_max3_f32 v49, v49, v88, v89
  v_max3_f32 v49, v49, v90, v91
  v_max3_f32 v49, v49, v92, v93
  v_max3_f32 v49, v49, v94, v95
  v_mfma_f32_32x32x16_bf16 v[80:95], v[56:59], v[40:43], 0
  v_max3_f32 v50, v50, v96, v97
  v_max3_f32 v50, v50, v98, v99
  v_max3_f32 v50, v50, v100, v101
  v_max3_f32 v50, v50, v102, v103
  v_max3_f32 v50, v50, v104, v105
  v_max3_f32 v50, v50, v106, v107
  v_max3_f32 v50, v50, v108, v109
  v_max3_f32 v50, v50, v110, v111
  v_mfma_f32_32x32x16_bf16 v[96:111], v[56:59], v[44:47], 0
  v_max3_f32 v51, v51, v64, v65
  v_max3_f32 v51, v51, v66, v67
  v_max3_f32 v51, v51, v68, v69
  v_max3_f32 v51, v51, v70, v71
  v_max3_f32 v51, v51, v72, v73
  v_max3_f32 v51, v51, v74, v75
  v_max3_f32 v51, v51, v76, v77
  v_max3_f32 v51, v51, v78, v79
  s_waitcnt lgkmcnt(0)
  v_mfma_f32_32x32x16_bf16 v[64:79], v[60:63], v[24:27], 0
  ds_read_b128 v[56:59], v15 offset:2048
  v_max3_f32 v52, v52, v80, v81
  v_max3_f32 v52, v52, v82, v83
  v_max3_f32 v52, v52, v84, v85
  v_max3_f32 v52, v52, v86, v87
  v_max3_f32 v52, v52, v88, v89
  v_max3_f32 v52, v52, v90, v91
  v_max3_f32 v52, v52, v92, v93
  v_max3_f32 v52, v52, v94, v95
  v_mfma_f32_32x32x16_bf16 v[80:95], v[60:63], v[28:31], 0
  v_max3_f32 v53, v53, v96, v97
  v_max3_f32 v53, v53, v98, v99
  v_max3_f32 v53, v53, v100, v101
  v_max3_f32 v53, v53, v102, v103
  v_max3_f32 v53, v53, v104, v105
  v_max3_f32 v53, v53, v106, v107
  v_max3_f32 v53, v53, v108, v109
  v_max3_f32 v53, v53, v110, v111
  v_mfma_f32_32x32x16_bf16 v[96:111], v[60:63], v[32:35], 0
  v_max3_f32 v48, v48, v64, v65
  v_max3_f32 v48, v48, v66, v67
  v_max3_f32 v48, v48, v68, v69
  v_max3_f32 v48, v48, v70, v71
  v_max3_f32 v48, v48, v72, v73
  v_max3_f32 v48, v48, v74, v75
  v_max3_f32 v48, v48, v76, v77
  v_max3_f32 v48, v48, v78, v79
  v_mfma_f32_32x32x16_bf16 v[64:79], v[60:63], v[36:39], 0
  v_max3_f32 v49, v49, v80, v81
  v_max3_f32 v49, v49, v82, v83
  v_max3_f32 v49, v49, v84, v85
  v_max3_f32 v49, v49, v86, v87
  v_max3_f32 v49, v49, v88, v89
  v_max3_f32 v49, v49, v90, v91
  v_max3_f32 v49, v49, v92, v93
  v_max3_f32 v49, v49, v94, v95
  v_mfma_f32_32x32x16_bf16 v[80:95], v[60:63], v[40:43], 0
  v_max3_f32 v50, v50, v96, v97
  v_max3_f32 v50, v50, v98, v99
  v_max3_f32 v50, v50, v100, v101
  v_max3_f32 v50, v50, v102, v103
  v_max3_f32 v50, v50, v104, v105
  v_max3_f32 v50, v50, v106, v107
  v_max3_f32 v50, v50, v108, v109
  v_max3_f32 v50, v50, v110, v111
  v_mfma_f32_32x32x16_bf16 v[96:111], v[60:63], v[44:47], 0
  v_max3_f32 v51, v51, v64, v65
  v_max3_f32 v51, v51, v66, v67
  v_max3_f32 v51, v51, v68, v69
  v_max3_f32 v51, v51, v70, v71
  v_max3_f32 v51, v51, v72, v73
  v_max3_f32 v51, v51, v74, v75
  v_max3_f32 v51, v51, v76, v77
  v_max3_f32 v51, v51, v78, v79
  v_max3_f32 v52, v52, v80, v81
  v_max3_f32 v52, v52, v82, v83
  v_max3_f32 v52, v52, v84, v85
  v_max3_f32 v52, v52, v86, v87
  v_max3_f32 v52, v52, v88, v89
  v_max3_f32 v52, v52, v90, v91
  v_max3_f32 v52, v52, v92, v93
  v_max3_f32 v52, v52, v94, v95
  v_max3_f32 v53, v53, v96, v97
  v_max3_f32 v53, v53, v98, v99
  v_max3_f32 v53, v53, v100, v101
  v_max3_f32 v53, v53, v102, v103
  v_max3_f32 v53, v53, v104, v105
  v_max3_f32 v53, v53, v106, v107
  v_max3_f32 v53, v53, v108, v109
  v_max3_f32 v53, v53, v110, v111
  v_add_u32 v15, 2048, v15
  s_add_u32 s71, s71, 2
  s_cmp_lt_u32 s71, 64
  s_cbranch_scc1 L_b_p1
  v_mov_b32 v1, v48
  s_nop 1
  v_permlane32_swap_b32 v48, v1
  v_max_f32 v1, v1, v48
  v_sub_f32 v160, 0, v1
  v_sub_f32 v161, 0, v1
  v_sub_f32 v162, 0, v1
  v_sub_f32 v163, 0, v1
  v_sub_f32 v164, 0, v1
  v_sub_f32 v165, 0, v1
  v_sub_f32 v166, 0, v1
  v_sub_f32 v167, 0, v1
  v_sub_f32 v168, 0, v1
  v_sub_f32 v169, 0, v1
  v_sub_f32 v170, 0, v1
  v_sub_f32 v171, 0, v1
  v_sub_f32 v172, 0, v1
  v_sub_f32 v173, 0, v1
  v_sub_f32 v174, 0, v1
  v_sub_f32 v175, 0, v1
  v_mov_b32 v1, v49
  s_nop 1
  v_permlane32_swap_b32 v49, v1
  v_max_f32 v1, v1, v49
  v_sub_f32 v176, 0, v1
  v_sub_f32 v177, 0, v1
  v_sub_f32 v178, 0, v1
  v_sub_f32 v179, 0, v1
  v_sub_f32 v180, 0, v1
  v_sub_f32 v181, 0, v1
  v_sub_f32 v182, 0, v1
  v_sub_f32 v183, 0, v1
  v_sub_f32 v184, 0, v1
  v_sub_f32 v185, 0, v1
  v_sub_f32 v186, 0, v1
  v_sub_f32 v187, 0, v1
  v_sub_f32 v188, 0, v1
  v_sub_f32 v189, 0, v1
  v_sub_f32 v190, 0, v1
  v_sub_f32 v191, 0, v1
  v_mov_b32 v1, v50
  s_nop 1
  v_permlane32_swap_b32 v50, v1
  v_max_f32 v1, v1, v50
  v_sub_f32 v192, 0, v1
  v_sub_f32 v193, 0, v1
  v_sub_f32 v194, 0, v1
  v_sub_f32 v195, 0, v1
  v_sub_f32 v196, 0, v1
  v_sub_f32 v197, 0, v1
  v_sub_f32 v198, 0, v1
  v_sub_f32 v199, 0, v1
  v_sub_f32 v200, 0, v1
  v_sub_f32 v201, 0, v1
  v_sub_f32 v202, 0, v1
  v_sub_f32 v203, 0, v1
  v_sub_f32 v204, 0, v1
  v_sub_f32 v205, 0, v1
  v_sub_f32 v206, 0, v1
  v_sub_f32 v207, 0, v1
  v_mov_b32 v1, v51
  s_nop 1
  v_permlane32_swap_b32 v51, v1
  v_max_f32 v1, v1, v51
  v_sub_f32 v208, 0, v1
  v_sub_f32 v209, 0, v1
  v_sub_f32 v210, 0, v1
  v_sub_f32 v211, 0, v1
  v_sub_f32 v212, 0, v1
  v_sub_f32 v213, 0, v1
  v_sub_f32 v214, 0, v1
  v_sub_f32 v215, 0, v1
  v_sub_f32 v216, 0, v1
  v_sub_f32 v217, 0, v1
  v_sub_f32 v218, 0, v1
  v_sub_f32 v219, 0, v1
  v_sub_f32 v220, 0, v1
  v_sub_f32 v221, 0, v1
  v_sub_f32 v222, 0, v1
  v_sub_f32 v223, 0, v1
  v_mov_b32 v1, v52
  s_nop 1
  v_permlane32_swap_b32 v52, v1
  v_max_f32 v1, v1, v52
  v_sub_f32 v224, 0, v1
  v_sub_f32 v225, 0, v1
  v_sub_f32 v226, 0, v1
  v_sub_f32 v227, 0, v1
  v_sub_f32 v228, 0, v1
  v_sub_f32 v229, 0, v1
  v_sub_f32 v230, 0, v1
  v_sub_f32 v231, 0, v1
  v_sub_f32 v232, 0, v1
  v_sub_f32 v233, 0, v1
  v_sub_f32 v234, 0, v1
  v_sub_f32 v235, 0, v1
  v_sub_f32 v236, 0, v1
  v_sub_f32 v237, 0, v1
  v_sub_f32 v238, 0, v1
  v_sub_f32 v239, 0, v1
  v_mov_b32 v1, v53
  s_nop 1
  v_permlane32_swap_b32 v53, v1
  v_max_f32 v1, v1, v53
  v_sub_f32 v240, 0, v1
  v_sub_f32 v241, 0, v1
  v_sub_f32 v242, 0, v1
  v_sub_f32 v243, 0, v1
  v_sub_f32 v244, 0, v1
  v_sub_f32 v245, 0, v1
  v_sub_f32 v246, 0, v1
  v_sub_f32 v247, 0, v1
  v_sub_f32 v248, 0, v1
  v_sub_f32 v249, 0, v1
  v_sub_f32 v250, 0, v1
  v_sub_f32 v251, 0, v1
  v_sub_f32 v252, 0, v1
  v_sub_f32 v253, 0, v1
  v_sub_f32 v254, 0, v1
  v_sub_f32 v255, 0, v1
  s_waitcnt lgkmcnt(0)
  v_mov_b32 v15, v4
  v_mov_b32 v16, v9
  ds_read_b128 v[56:59], v15 offset:0
  ds_read_b128 v[112:115], v16 offset:0
  ds_read_b128 v[116:119], v16 offset:256
  s_mov_b32 s71, 0
L_b_p2:
  s_waitcnt lgkmcnt(0)
  ds_read_b128 v[60:63], v15 offset:1024
  ds_read_b128 v[120:123], v16 offset:1024
  ds_read_b128 v[124:127], v16 offset:1280
  v_mfma_f32_32x32x16_bf16 v[64:79], v[56:59], v[24:27], v[160:175]
  v_cndmask_b32 v112, v112, v14, s[96:97]
  v_cndmask_b32 v113, v113, v14, s[96:97]
  v_cndmask_b32 v114, v114, v14, s[96:97]
  v_cndmask_b32 v115, v115, v14, s[96:97]
  v_cndmask_b32 v116, v116, v14, s[96:97]
  v_cndmask_b32 v117, v117, v14, s[96:97]
  v_cndmask_b32 v118, v118, v14, s[96:97]
  v_cndmask_b32 v119, v119, v14, s[96:97]
  v_mfma_f32_32x32x16_bf16 v[80:95], v[56:59], v[28:31], v[176:191]
  s_nop 2
  v_exp_f32 v64, v64
  v_exp_f32 v65, v65
  v_exp_f32 v66, v66
  v_exp_f32 v67, v67
  v_exp_f32 v68, v68
  v_exp_f32 v69, v69
  v_exp_f32 v70, v70
  v_exp_f32 v71, v71
  v_cvt_pk_bf16_f32 v128, v64, v65
  v_cvt_pk_bf16_f32 v129, v66, v67
  v_cvt_pk_bf16_f32 v130, v68, v69
  v_cvt_pk_bf16_f32 v131, v70, v71
  v_exp_f32 v72, v72
  v_exp_f32 v73, v73
  v_exp_f32 v74, v74
  v_exp_f32 v75, v75
  v_exp_f32 v76, v76
  v_exp_f32 v77, v77
  v_exp_f32 v78, v78
  v_exp_f32 v79, v79
  v_cvt_pk_bf16_f32 v132, v72, v73
  v_cvt_pk_bf16_f32 v133, v74, v75
  v_cvt_pk_bf16_f32 v134, v76, v77
  v_cvt_pk_bf16_f32 v135, v78, v79
  v_mfma_f32_32x32x16_bf16 a[0:15], v[112:115], v[128:131], a[0:15]
  v_mfma_f32_32x32x16_bf16 v[64:79], v[56:59], v[32:35], v[192:207]
  v_exp_f32 v80, v80
  v_exp_f32 v81, v81
  v_exp_f32 v82, v82
  v_exp_f32 v83, v83
  v_exp_f32 v84, v84
  v_exp_f32 v85, v85
  v_exp_f32 v86, v86
  v_exp_f32 v87, v87
  v_cvt_pk_bf16_f32 v136, v80, v81
  v_cvt_pk_bf16_f32 v137, v82, v83
  v_cvt_pk_bf16_f32 v138, v84, v85
  v_cvt_pk_bf16_f32 v139, v86, v87
  v_mfma_f32_32x32x16_bf16 a[0:15], v[116:119], v[132:135], a[0:15]
  v_exp_f32 v88, v88
  v_exp_f32 v89, v89
  v_exp_f32 v90, v90
  v_exp_f32 v91, v91
  v_exp_f32 v92, v92
  v_exp_f32 v93, v93
  v_exp_f32 v94, v94
  v_exp_f32 v95, v95
  v_cvt_pk_bf16_f32 v140, v88, v89
  v_cvt_pk_bf16_f32 v141, v90, v91
  v_cvt_pk_bf16_f32 v142, v92, v93
  v_cvt_pk_bf16_f32 v143, v94, v95
  v_mfma_f32_32x32x16_bf16 a[16:31], v[112:115], v[136:139], a[16:31]
  v_mfma_f32_32x32x16_bf16 v[80:95], v[56:59], v[36:39], v[208:223]
  v_exp_f32 v64, v64
  v_exp_f32 v65, v65
  v_exp_f32 v66, v66
  v_exp_f32 v67, v67
  v_exp_f32 v68, v68
  v_exp_f32 v69, v69
  v_exp_f32 v70, v70
  v_exp_f32 v71, v71
  v_cvt_pk_bf16_f32 v128, v64, v65
  v_cvt_pk_bf16_f32 v129, v66, v67
  v_cvt_pk_bf16_f32 v130, v68, v69
  v_cvt_pk_bf16_f32 v131, v70, v71
  v_mfma_f32_32x32x16_bf16 a[16:31], v[116:119], v[140:143], a[16:31]
  v_exp_f32 v72, v72
  v_exp_f32 v73, v73
  v_exp_f32 v74, v74
  v_exp_f32 v75, v75
  v_exp_f32 v76, v76
  v_exp_f32 v77, v77
  v_exp_f32 v78, v78
  v_exp_f32 v79, v79
  v_cvt_pk_bf16_f32 v132, v72, v73
  v_cvt_pk_bf16_f32 v133, v74, v75
  v_cvt_pk_bf16_f32 v134, v76, v77
  v_cvt_pk_bf16_f32 v135, v78, v79
  v_mfma_f32_32x32x16_bf16 a[32:47], v[112:115], v[128:131], a[32:47]
  v_mfma_f32_32x32x16_bf16 v[64:79], v[56:59], v[40:43], v[224:239]
  v_exp_f32 v80, v80
  v_exp_f32 v81, v81
  v_exp_f32 v82, v82
  v_exp_f32 v83, v83
  v_exp_f32 v84, v84
  v_exp_f32 v85, v85
  v_exp_f32 v86, v86
  v_exp_f32 v87, v87
  v_cvt_pk_bf16_f32 v136, v80, v81
  v_cvt_pk_bf16_f32 v137, v82, v83
  v_cvt_pk_bf16_f32 v138, v84, v85
  v_cvt_pk_bf16_f32 v139, v86, v87
  v_mfma_f32_32x32x16_bf16 a[32:47], v[116:119], v[132:135], a[32:47]
  v_exp_f32 v88, v88
  v_exp_f32 v89, v89
  v_exp_f32 v90, v90
  v_exp_f32 v91, v91
  v_exp_f32 v92, v92
  v_exp_f32 v93, v93
  v_exp_f32 v94, v94
  v_exp_f32 v95, v95
  v_cvt_pk_bf16_f32 v140, v88, v89
  v_cvt_pk_bf16_f32 v141, v90, v91
  v_cvt_pk_bf16_f32 v142, v92, v93
  v_cvt_pk_bf16_f32 v143, v94, v95
  v_mfma_f32_32x32x16_bf16 a[48:63], v[112:115], v[136:139], a[48:63]
  v_mfma_f32_32x32x16_bf16 v[80:95], v[56:59], v[44:47], v[240:255]
  v_exp_f32 v64, v64
  v_exp_f32 v65, v65
  v_exp_f32 v66, v66
  v_exp_f32 v67, v67
  v_exp_f32 v68, v68
  v_exp_f32 v69, v69
  v_exp_f32 v70, v70
  v_exp_f32 v71, v71
  v_cvt_pk_bf16_f32 v128, v64, v65
  v_cvt_pk_bf16_f32 v129, v66, v67
  v_cvt_pk_bf16_f32 v130, v68, v69
  v_cvt_pk_bf16_f32 v131, v70, v71
  v_mfma_f32_32x32x16_bf16 a[48:63], v[116:119], v[140:143], a[48:63]
  v_exp_f32 v72, v72
  v_exp_f32 v73, v73
  v_exp_f32 v74, v74
  v_exp_f32 v75, v75
  v_exp_f32 v76, v76
  v_exp_f32 v77, v77
  v_exp_f32 v78, v78
  v_exp_f32 v79, v79
  v_cvt_pk_bf16_f32 v132, v72, v73
  v_cvt_pk_bf16_f32 v133, v74, v75
  v_cvt_pk_bf16_f32 v134, v76, v77
  v_cvt_pk_bf16_f32 v135, v78, v79
  v_mfma_f32_32x32x16_bf16 a[64:79], v[112:115], v[128:131], a[64:79]
  s_waitcnt lgkmcnt(0)
  v_cndmask_b32 v120, v120, v14, s[96:97]
  v_cndmask_b32 v121, v121, v14, s[96:97]
  v_cndmask_b32 v122, v122, v14, s[96:97]
  v_cndmask_b32 v123, v123, v14, s[96:97]
  v_cndmask_b32 v124, v124, v14, s[96:97]
  v_cndmask_b32 v125, v125, v14, s[96:97]
  v_cndmask_b32 v126, v126, v14, s[96:97]
  v_cndmask_b32 v127, v127, v14, s[96:97]
  v_mfma_f32_32x32x16_bf16 v[64:79], v[60:63], v[24:27], v[160:175]
  v_exp_f32 v80, v80
  v_exp_f32 v81, v81
  v_exp_f32 v82, v82
  v_exp_f32 v83, v83
  v_exp_f32 v84, v84
  v_exp_f32 v85, v85
  v_exp_f32 v86, v86
  v_exp_f32 v87, v87
  v_cvt_pk_bf16_f32 v136, v80, v81
  v_cvt_pk_bf16_f32 v137, v82, v83
  v_cvt_pk_bf16_f32 v138, v84, v85
  v_cvt_pk_bf16_f32 v139, v86, v87
  v_mfma_f32_32x32x16_bf16 a[64:79], v[116:119], v[132:135], a[64:79]
  v_exp_f32 v88, v88
  v_exp_f32 v89, v89
  v_exp_f32 v90, v90
  v_exp_f32 v91, v91
  v_exp_f32 v92, v92
  v_exp_f32 v93, v93
  v_exp_f32 v94, v94
  v_exp_f32 v95, v95
  v_cvt_pk_bf16_f32 v140, v88, v89
  v_cvt_pk_bf16_f32 v141, v90, v91
  v_cvt_pk_bf16_f32 v142, v92, v93
  v_cvt_pk_bf16_f32 v143, v94, v95
  v_mfma_f32_32x32x16_bf16 a[80:95], v[112:115], v[136:139], a[80:95]
  v_mfma_f32_32x32x16_bf16 v[80:95], v[60:63], v[28:31], v[176:191]
  v_exp_f32 v64, v64
  v_exp_f32 v65, v65
  v_exp_f32 v66, v66
  v_exp_f32 v67, v67
  v_exp_f32 v68, v68
  v_exp_f32 v69, v69
  v_exp_f32 v70, v70
  v_exp_f32 v71, v71
  v_cvt_pk_bf16_f32 v128, v64, v65
  v_cvt_pk_bf16_f32 v129, v66, v67
  v_cvt_pk_bf16_f32 v130, v68, v69
  v_cvt_pk_bf16_f32 v131, v70, v71
  v_mfma_f32_32x32x16_bf16 a[80:95], v[116:119], v[140:143], a[80:95]
  v_exp_f32 v72, v72
  v_exp_f32 v73, v73
  v_exp_f32 v74, v74
  v_exp_f32 v75, v75
  v_exp_f32 v76, v76
  v_exp_f32 v77, v77
  v_exp_f32 v78, v78
  v_exp_f32 v79, v79
  v_cvt_pk_bf16_f32 v132, v72, v73
  v_cvt_pk_bf16_f32 v133, v74, v75
  v_cvt_pk_bf16_f32 v134, v76, v77
  v_cvt_pk_bf16_f32 v135, v78, v79
  v_mfma_f32_32x32x16_bf16 a[0:15], v[120:123], v[128:131], a[0:15]
  ds_read_b128 v[56:59], v15 offset:2048
  ds_read_b128 v[112:115], v16 offset:2048
  ds_read_b128 v[116:119], v16 offset:2304
  v_mfma_f32_32x32x16_bf16 v[64:79], v[60:63], v[32:35], v[192:207]
  v_exp_f32 v80, v80
  v_exp_f32 v81, v81
  v_exp_f32 v82, v82
  v_exp_f32 v83, v83
  v_exp_f32 v84, v84
  v_exp_f32 v85, v85
  v_exp_f32 v86, v86
  v_exp_f32 v87, v87
  v_cvt_pk_bf16_f32 v136, v80, v81
  v_cvt_pk_bf16_f32 v137, v82, v83
  v_cvt_pk_bf16_f32 v138, v84, v85
  v_cvt_pk_bf16_f32 v139, v86, v87
  v_mfma_f32_32x32x16_bf16 a[0:15], v[124:127], v[132:135], a[0:15]
  v_exp_f32 v88, v88
  v_exp_f32 v89, v89
  v_exp_f32 v90, v90
  v_exp_f32 v91, v91
  v_exp_f32 v92, v92
  v_exp_f32 v93, v93
  v_exp_f32 v94, v94
  v_exp_f32 v95, v95
  v_cvt_pk_bf16_f32 v140, v88, v89
  v_cvt_pk_bf16_f32 v141, v90, v91
  v_cvt_pk_bf16_f32 v142, v92, v93
  v_cvt_pk_bf16_f32 v143, v94, v95
  v_mfma_f32_32x32x16_bf16 a[16:31], v[120:123], v[136:139], a[16:31]
  v_mfma_f32_32x32x16_bf16 v[80:95], v[60:63], v[36:39], v[208:223]
  v_exp_f32 v64, v64
  v_exp_f32 v65, v65
  v_exp_f32 v66, v66
  v_exp_f32 v67, v67
  v_exp_f32 v68, v68
  v_exp_f32 v69, v69
  v_exp_f32 v70, v70
  v_exp_f32 v71, v71
  v_cvt_pk_bf16_f32 v128, v64, v65
  v_cvt_pk_bf16_f32 v129, v66, v67
  v_cvt_pk_bf16_f32 v130, v68, v69
  v_cvt_pk_bf16_f32 v131, v70, v71
  v_mfma_f32_32x32x16_bf16 a[16:31], v[124:127], v[140:143], a[16:31]
  v_exp_f32 v72, v72
  v_exp_f32 v73, v73
  v_exp_f32 v74, v74
  v_exp_f32 v75, v75
  v_exp_f32 v76, v76
  v_exp_f32 v77, v77
  v_exp_f32 v78, v78
  v_exp_f32 v79, v79
  v_cvt_pk_bf16_f32 v132, v72, v73
  v_cvt_pk_bf16_f32 v133, v74, v75
  v_cvt_pk_bf16_f32 v134, v76, v77
  v_cvt_pk_bf16_f32 v135, v78, v79
  v_mfma_f32_32x32x16_bf16 a[32:47], v[120:123], v[128:131], a[32:47]
  v_mfma_f32_32x32x16_bf16 v[64:79], v[60:63], v[40:43], v[224:239]
  v_exp_f32 v80, v80
  v_exp_f32 v81, v81
  v_exp_f32 v82, v82
  v_exp_f32 v83, v83
  v_exp_f32 v84, v84
  v_exp_f32 v85, v85
  v_exp_f32 v86, v86
  v_exp_f32 v87, v87
  v_cvt_pk_bf16_f32 v136, v80, v81
  v_cvt_pk_bf16_f32 v137, v82, v83
  v_cvt_pk_bf16_f32 v138, v84, v85
  v_cvt_pk_bf16_f32 v139, v86, v87
  v_mfma_f32_32x32x16_bf16 a[32:47], v[124:127], v[132:135], a[32:47]
  v_exp_f32 v88, v88
  v_exp_f32 v89, v89
  v_exp_f32 v90, v90
  v_exp_f32 v91, v91
  v_exp_f32 v92, v92
  v_exp_f32 v93, v93
  v_exp_f32 v94, v94
  v_exp_f32 v95, v95
  v_cvt_pk_bf16_f32 v140, v88, v89
  v_cvt_pk_bf16_f32 v141, v90, v91
  v_cvt_pk_bf16_f32 v142, v92, v93
  v_cvt_pk_bf16_f32 v143, v94, v95
  v_mfma_f32_32x32x16_bf16 a[48:63], v[120:123], v[136:139], a[48:63]
  v_mfma_f32_32x32x16_bf16 v[80:95], v[60:63], v[44:47], v[240:255]
  v_exp_f32 v64, v64
  v_exp_f32 v65, v65
  v_exp_f32 v66, v66
  v_exp_f32 v67, v67
  v_exp_f32 v68, v68
  v_exp_f32 v69, v69
  v_exp_f32 v70, v70
  v_exp_f32 v71, v71
  v_cvt_pk_bf16_f32 v128, v64, v65
  v_cvt_pk_bf16_f32 v129, v66, v67
  v_cvt_pk_bf16_f32 v130, v68, v69
  v_cvt_pk_bf16_f32 v131, v70, v71
  v_mfma_f32_32x32x16_bf16 a[48:63], v[124:127], v[140:143], a[48:63]
  v_exp_f32 v72, v72
  v_exp_f32 v73, v73
  v_exp_f32 v74, v74
  v_exp_f32 v75, v75
  v_exp_f32 v76, v76
  v_exp_f32 v77, v77
  v_exp_f32 v78, v78
  v_exp_f32 v79, v79
  v_cvt_pk_bf16_f32 v132, v72, v73
  v_cvt_pk_bf16_f32 v133, v74, v75
  v_cvt_pk_bf16_f32 v134, v76, v77
  v_cvt_pk_bf16_f32 v135, v78, v79
  v_mfma_f32_32x32x16_bf16 a[64:79], v[120:123], v[128:131], a[64:79]
  v_exp_f32 v80, v80
  v_exp_f32 v81, v81
  v_exp_f32 v82, v82
  v_exp_f32 v83, v83
  v_exp_f32 v84, v84
  v_exp_f32 v85, v85
  v_exp_f32 v86, v86
  v_exp_f32 v87, v87
  v_cvt_pk_bf16_f32 v136, v80, v81
  v_cvt_pk_bf16_f32 v137, v82, v83
  v_cvt_pk_bf16_f32 v138, v84, v85
  v_cvt_pk_bf16_f32 v139, v86, v87
  v_mfma_f32_32x32x16_bf16 a[64:79], v[124:127], v[132:135], a[64:79]
  v_exp_f32 v88, v88
  v_exp_f32 v89, v89
  v_exp_f32 v90, v90
  v_exp_f32 v91, v91
  v_exp_f32 v92, v92
  v_exp_f32 v93, v93
  v_exp_f32 v94, v94
  v_exp_f32 v95, v95
  v_cvt_pk_bf16_f32 v140, v88, v89
  v_cvt_pk_bf16_f32 v141, v90, v91
  v_cvt_pk_bf16_f32 v142, v92, v93
  v_cvt_pk_bf16_f32 v143, v94, v95
  v_mfma_f32_32x32x16_bf16 a[80:95], v[120:123], v[136:139], a[80:95]
  s_nop 0
  v_mfma_f32_32x32x16_bf16 a[80:95], v[124:127], v[140:143], a[80:95]
  v_add_u32 v15, 2048, v15
  v_add_u32 v16, 2048, v16
  s_add_u32 s71, s71, 2
  s_cmp_lt_u32 s71, 64
  s_cbranch_scc1 L_b_p2
  s_mov_b32 s72, s70
  v_accvgpr_read_b32 v64, a0
  v_accvgpr_read_b32 v65, a1
  v_accvgpr_read_b32 v66, a2
  v_accvgpr_read_b32 v67, a3
  v_accvgpr_read_b32 v68, a4
  v_accvgpr_read_b32 v69, a5
  v_accvgpr_read_b32 v70, a6
  v_accvgpr_read_b32 v71, a7
  v_accvgpr_read_b32 v72, a8
  v_rcp_f32 v72, v72
  s_nop 0
  v_mul_f32 v64, v64, v72
  v_mul_f32 v65, v65, v72
  v_mul_f32 v66, v66, v72
  v_mul_f32 v67, v67, v72
  v_mul_f32 v68, v68, v72
  v_mul_f32 v69, v69, v72
  v_mul_f32 v70, v70, v72
  v_mul_f32 v71, v71, v72
  v_cvt_pk_bf16_f32 v76, v64, v65
  v_cvt_pk_bf16_f32 v77, v66, v67
  v_cvt_pk_bf16_f32 v78, v68, v69
  v_cvt_pk_bf16_f32 v79, v70, v71
  s_min_u32 s73, s72, 63
  s_lshl_b32 s61, s73, 15
  s_add_u32 s61, s61, 138412032
  buffer_store_dwordx4 v[76:79], v11, s[52:55], s61 offen sc1
  s_add_u32 s72, s72, 12
  v_accvgpr_read_b32 v80, a16
  v_accvgpr_read_b32 v81, a17
  v_accvgpr_read_b32 v82, a18
  v_accvgpr_read_b32 v83, a19
  v_accvgpr_read_b32 v84, a20
  v_accvgpr_read_b32 v85, a21
  v_accvgpr_read_b32 v86, a22
  v_accvgpr_read_b32 v87, a23
  v_accvgpr_read_b32 v88, a24
  v_rcp_f32 v88, v88
  s_nop 0
  v_mul_f32 v80, v80, v88
  v_mul_f32 v81, v81, v88
  v_mul_f32 v82, v82, v88
  v_mul_f32 v83, v83, v88
  v_mul_f32 v84, v84, v88
  v_mul_f32 v85, v85, v88
  v_mul_f32 v86, v86, v88
  v_mul_f32 v87, v87, v88
  v_cvt_pk_bf16_f32 v92, v80, v81
  v_cvt_pk_bf16_f32 v93, v82, v83
  v_cvt_pk_bf16_f32 v94, v84, v85
  v_cvt_pk_bf16_f32 v95, v86, v87
  s_min_u32 s73, s72, 63
  s_lshl_b32 s61, s73, 15
  s_add_u32 s61, s61, 138412032
  buffer_store_dwordx4 v[92:95], v11, s[52:55], s61 offen sc1
  s_add_u32 s72, s72, 12
  v_accvgpr_read_b32 v64, a32
  v_accvgpr_read_b32 v65, a33
  v_accvgpr_read_b32 v66, a34
  v_accvgpr_read_b32 v67, a35
  v_accvgpr_read_b32 v68, a36
  v_accvgpr_read_b32 v69, a37
  v_accvgpr_read_b32 v70, a38
  v_accvgpr_read_b32 v71, a39
  v_accvgpr_read_b32 v72, a40
  v_rcp_f32 v72, v72
  s_nop 0
  v_mul_f32 v64, v64, v72
  v_mul_f32 v65, v65, v72
  v_mul_f32 v66, v66, v72
  v_mul_f32 v67, v67, v72
  v_mul_f32 v68, v68, v72
  v_mul_f32 v69, v69, v72
  v_mul_f32 v70, v70, v72
  v_mul_f32 v71, v71, v72
  v_cvt_pk_bf16_f32 v76, v64, v65
  v_cvt_pk_bf16_f32 v77, v66, v67
  v_cvt_pk_bf16_f32 v78, v68, v69
  v_cvt_pk_bf16_f32 v79, v70, v71
  s_min_u32 s73, s72, 63
  s_lshl_b32 s61, s73, 15
  s_add_u32 s61, s61, 138412032
  buffer_store_dwordx4 v[76:79], v11, s[52:55], s61 offen sc1
  s_add_u32 s72, s72, 12
  v_accvgpr_read_b32 v80, a48
  v_accvgpr_read_b32 v81, a49
  v_accvgpr_read_b32 v82, a50
  v_accvgpr_read_b32 v83, a51
  v_accvgpr_read_b32 v84, a52
  v_accvgpr_read_b32 v85, a53
  v_accvgpr_read_b32 v86, a54
  v_accvgpr_read_b32 v87, a55
  v_accvgpr_read_b32 v88, a56
  v_rcp_f32 v88, v88
  s_nop 0
  v_mul_f32 v80, v80, v88
  v_mul_f32 v81, v81, v88
  v_mul_f32 v82, v82, v88
  v_mul_f32 v83, v83, v88
  v_mul_f32 v84, v84, v88
  v_mul_f32 v85, v85, v88
  v_mul_f32 v86, v86, v88
  v_mul_f32 v87, v87, v88
  v_cvt_pk_bf16_f32 v92, v80, v81
  v_cvt_pk_bf16_f32 v93, v82, v83
  v_cvt_pk_bf16_f32 v94, v84, v85
  v_cvt_pk_bf16_f32 v95, v86, v87
  s_min_u32 s73, s72, 63
  s_lshl_b32 s61, s73, 15
  s_add_u32 s61, s61, 138412032
  buffer_store_dwordx4 v[92:95], v11, s[52:55], s61 offen sc1
  s_add_u32 s72, s72, 12
  v_accvgpr_read_b32 v64, a64
  v_accvgpr_read_b32 v65, a65
  v_accvgpr_read_b32 v66, a66
  v_accvgpr_read_b32 v67, a67
  v_accvgpr_read_b32 v68, a68
  v_accvgpr_read_b32 v69, a69
  v_accvgpr_read_b32 v70, a70
  v_accvgpr_read_b32 v71, a71
  v_accvgpr_read_b32 v72, a72
  v_rcp_f32 v72, v72
  s_nop 0
  v_mul_f32 v64, v64, v72
  v_mul_f32 v65, v65, v72
  v_mul_f32 v66, v66, v72
  v_mul_f32 v67, v67, v72
  v_mul_f32 v68, v68, v72
  v_mul_f32 v69, v69, v72
  v_mul_f32 v70, v70, v72
  v_mul_f32 v71, v71, v72
  v_cvt_pk_bf16_f32 v76, v64, v65
  v_cvt_pk_bf16_f32 v77, v66, v67
  v_cvt_pk_bf16_f32 v78, v68, v69
  v_cvt_pk_bf16_f32 v79, v70, v71
  s_min_u32 s73, s72, 63
  s_lshl_b32 s61, s73, 15
  s_add_u32 s61, s61, 138412032
  buffer_store_dwordx4 v[76:79], v11, s[52:55], s61 offen sc1
  s_add_u32 s72, s72, 12
  v_accvgpr_read_b32 v80, a80
  v_accvgpr_read_b32 v81, a81
  v_accvgpr_read_b32 v82, a82
  v_accvgpr_read_b32 v83, a83
  v_accvgpr_read_b32 v84, a84
  v_accvgpr_read_b32 v85, a85
  v_accvgpr_read_b32 v86, a86
  v_accvgpr_read_b32 v87, a87
  v_accvgpr_read_b32 v88, a88
  v_rcp_f32 v88, v88
  s_nop 0
  v_mul_f32 v80, v80, v88
  v_mul_f32 v81, v81, v88
  v_mul_f32 v82, v82, v88
  v_mul_f32 v83, v83, v88
  v_mul_f32 v84, v84, v88
  v_mul_f32 v85, v85, v88
  v_mul_f32 v86, v86, v88
  v_mul_f32 v87, v87, v88
  v_cvt_pk_bf16_f32 v92, v80, v81
  v_cvt_pk_bf16_f32 v93, v82, v83
  v_cvt_pk_bf16_f32 v94, v84, v85
  v_cvt_pk_bf16_f32 v95, v86, v87
  s_min_u32 s73, s72, 63
  s_lshl_b32 s61, s73, 15
  s_add_u32 s61, s61, 138412032
  buffer_store_dwordx4 v[92:95], v11, s[52:55], s61 offen sc1
  s_add_u32 s72, s72, 12
  s_waitcnt vmcnt(0) lgkmcnt(0)
  s_barrier
  s_lshl_b32 s61, s60, 12
  s_add_u32 s61, s61, 49152
  s_lshl_b32 s62, s6, 7
  s_add_u32 s62, s62, s61
  v_mov_b32 v1, s62
  v_mov_b32 v2, 1
  s_mov_b64 exec, 1
  buffer_store_dword v2, v1, s[52:55], 0 offen sc1
  s_mov_b64 exec, -1
  v_and_b32 v1, 31, v0
  v_lshlrev_b32 v1, 7, v1
  v_add_u32 v1, s61, v1
L_b_w2:
  s_sub_u32 s56, s56, 1
  s_cbranch_scc1 L_timeout
  buffer_load_dword v2, v1, s[52:55], 0 offen sc1
  s_waitcnt vmcnt(0)
  v_cmp_ne_u32 vcc, 1, v2
  s_cbranch_vccz L_b_g2
  s_sleep 8
  s_branch L_b_w2
L_b_g2:
  s_lshr_b32 s72, s6, 4
  s_mul_i32 s72, s72, 36
  s_add_u32 s72, s72, s70
  s_mov_b32 s71, 0
L_b_3:
  s_cmp_ge_u32 s72, 64
  s_cbranch_scc1 L_exit
  s_lshl_b32 s61, s72, 15
  s_add_u32 s61, s61, 138412032
  buffer_load_dwordx4 v[128:131], v4, s[52:55], s61 offen offset:0 sc1
  buffer_load_dwordx4 v[132:135], v4, s[52:55], s61 offen offset:1024 sc1
  buffer_load_dwordx4 v[136:139], v4, s[52:55], s61 offen offset:2048 sc1
  buffer_load_dwordx4 v[140:143], v4, s[52:55], s61 offen offset:3072 sc1
  s_add_u32 s61, s61, 4096
  buffer_load_dwordx4 v[144:147], v4, s[52:55], s61 offen offset:0 sc1
  buffer_load_dwordx4 v[148:151], v4, s[52:55], s61 offen offset:1024 sc1
  buffer_load_dwordx4 v[152:155], v4, s[52:55], s61 offen offset:2048 sc1
  buffer_load_dwordx4 v[156:159], v4, s[52:55], s61 offen offset:3072 sc1
  s_add_u32 s61, s61, 4096
  buffer_load_dwordx4 v[160:163], v4, s[52:55], s61 offen offset:0 sc1
  buffer_load_dwordx4 v[164:167], v4, s[52:55], s61 offen offset:1024 sc1
  buffer_load_dwordx4 v[168:171], v4, s[52:55], s61 offen offset:2048 sc1
  buffer_load_dwordx4 v[172:175], v4, s[52:55], s61 offen offset:3072 sc1
  s_add_u32 s61, s61, 4096
  buffer_load_dwordx4 v[176:179], v4, s[52:55], s61 offen offset:0 sc1
  buffer_load_dwordx4 v[180:183], v4, s[52:55], s61 offen offset:1024 sc1
  buffer_load_dwordx4 v[184:187], v4, s[52:55], s61 offen offset:2048 sc1
  buffer_load_dwordx4 v[188:191], v4, s[52:55], s61 offen offset:3072 sc1
  s_add_u32 s61, s61, 4096
  buffer_load_dwordx4 v[192:195], v4, s[52:55], s61 offen offset:0 sc1
  buffer_load_dwordx4 v[196:199], v4, s[52:55], s61 offen offset:1024 sc1
  buffer_load_dwordx4 v[200:203], v4, s[52:55], s61 offen offset:2048 sc1
  buffer_load_dwordx4 v[204:207], v4, s[52:55], s61 offen offset:3072 sc1
  s_add_u32 s61, s61, 4096
  buffer_load_dwordx4 v[208:211], v4, s[52:55], s61 offen offset:0 sc1
  buffer_load_dwordx4 v[212:215], v4, s[52:55], s61 offen offset:1024 sc1
  buffer_load_dwordx4 v[216:219], v4, s[52:55], s61 offen offset:2048 sc1
  buffer_load_dwordx4 v[220:223], v4, s[52:55], s61 offen offset:3072 sc1
  s_add_u32 s61, s61, 4096
  buffer_load_dwordx4 v[224:227], v4, s[52:55], s61 offen offset:0 sc1
  buffer_load_dwordx4 v[228:231], v4, s[52:55], s61 offen offset:1024 sc1
  buffer_load_dwordx4 v[232:235], v4, s[52:55], s61 offen offset:2048 sc1
  buffer_load_dwordx4 v[236:239], v4, s[52:55], s61 offen offset:3072 sc1
  s_add_u32 s61, s61, 4096
  buffer_load_dwordx4 v[240:243], v4, s[52:55], s61 offen offset:0 sc1
  buffer_load_dwordx4 v[244:247], v4, s[52:55], s61 offen offset:1024 sc1
  buffer_load_dwordx4 v[248:251], v4, s[52:55], s61 offen offset:2048 sc1
  buffer_load_dwordx4 v[252:255], v4, s[52:55], s61 offen offset:3072 sc1
  s_add_u32 s61, s61, 4096
  s_waitcnt vmcnt(31)
  v_mfma_f32_32x32x16_bf16 v[64:79], a[128:131], v[128:131], 0
  s_waitcnt vmcnt(30)
  v_mfma_f32_32x32x16_bf16 v[64:79], a[132:135], v[132:135], v[64:79]
  s_waitcnt vmcnt(29)
  v_mfma_f32_32x32x16_bf16 v[64:79], a[136:139], v[136:139], v[64:79]
  s_waitcnt vmcnt(28)
  v_mfma_f32_32x32x16_bf16 v[64:79], a[140:143], v[140:143], v[64:79]
  s_waitcnt vmcnt(27)
  v_mfma_f32_32x32x16_bf16 v[64:79], a[144:147], v[144:147], v[64:79]
  s_waitcnt vmcnt(26)
  v_mfma_f32_32x32x16_bf16 v[64:79], a[148:151], v[148:151], v[64:79]
  s_waitcnt vmcnt(25)
  v_mfma_f32_32x32x16_bf16 v[64:79], a[152:155], v[152:155], v[64:79]
  s_waitcnt vmcnt(24)
  v_mfma_f32_32x32x16_bf16 v[64:79], a[156:159], v[156:159], v[64:79]
  s_waitcnt vmcnt(23)
  v_mfma_f32_32x32x16_bf16 v[64:79], a[160:163], v[160:163], v[64:79]
  s_waitcnt vmcnt(22)
  v_mfma_f32_32x32x16_bf16 v[64:79], a[164:167], v[164:167], v[64:79]
  s_waitcnt vmcnt(21)
  v_mfma_f32_32x32x16_bf16 v[64:79], a[168:171], v[168:171], v[64:79]
  s_waitcnt vmcnt(20)
  v_mfma_f32_32x32x16_bf16 v[64:79], a[172:175], v[172:175], v[64:79]
  s_waitcnt vmcnt(19)
  v_mfma_f32_32x32x16_bf16 v[64:79], a[176:179], v[176:179], v[64:79]
  s_waitcnt vmcnt(18)
  v_mfma_f32_32x32x16_bf16 v[64:79], a[180:183], v[180:183], v[64:79]
  s_waitcnt vmcnt(17)
  v_mfma_f32_32x32x16_bf16 v[64:79], a[184:187], v[184:187], v[64:79]
  s_waitcnt vmcnt(16)
  v_mfma_f32_32x32x16_bf16 v[64:79], a[188:191], v[188:191], v[64:79]
  s_waitcnt vmcnt(15)
  v_mfma_f32_32x32x16_bf16 v[64:79], a[192:195], v[192:195], v[64:79]
  s_waitcnt vmcnt(14)
  v_mfma_f32_32x32x16_bf16 v[64:79], a[196:199], v[196:199], v[64:79]
  s_waitcnt vmcnt(13)
  v_mfma_f32_32x32x16_bf16 v[64:79], a[200:203], v[200:203], v[64:79]
  s_waitcnt vmcnt(12)
  v_mfma_f32_32x32x16_bf16 v[64:79], a[204:207], v[204:207], v[64:79]
  s_waitcnt vmcnt(11)
  v_mfma_f32_32x32x16_bf16 v[64:79], a[208:211], v[208:211], v[64:79]
  s_waitcnt vmcnt(10)
  v_mfma_f32_32x32x16_bf16 v[64:79], a[212:215], v[212:215], v[64:79]
  s_waitcnt vmcnt(9)
  v_mfma_f32_32x32x16_bf16 v[64:79], a[216:219], v[216:219], v[64:79]
  s_waitcnt vmcnt(8)
  v_mfma_f32_32x32x16_bf16 v[64:79], a[220:223], v[220:223], v[64:79]
  s_waitcnt vmcnt(7)
  v_mfma_f32_32x32x16_bf16 v[64:79], a[224:227], v[224:227], v[64:79]
  s_waitcnt vmcnt(6)
  v_mfma_f32_32x32x16_bf16 v[64:79], a[228:231], v[228:231], v[64:79]
  s_waitcnt vmcnt(5)
  v_mfma_f32_32x32x16_bf16 v[64:79], a[232:235], v[232:235], v[64:79]
  s_waitcnt vmcnt(4)
  v_mfma_f32_32x32x16_bf16 v[64:79], a[236:239], v[236:239], v[64:79]
  s_waitcnt vmcnt(3)
  v_mfma_f32_32x32x16_bf16 v[64:79], a[240:243], v[240:243], v[64:79]
  s_waitcnt vmcnt(2)
  v_mfma_f32_32x32x16_bf16 v[64:79], a[244:247], v[244:247], v[64:79]
  s_waitcnt vmcnt(1)
  v_mfma_f32_32x32x16_bf16 v[64:79], a[248:251], v[248:251], v[64:79]
  s_waitcnt vmcnt(0)
  v_mfma_f32_32x32x16_bf16 v[64:79], a[252:255], v[252:255], v[64:79]
  s_nop 11
  v_cvt_pk_bf16_f32 v80, v64, v65
  v_cvt_pk_bf16_f32 v81, v66, v67
  v_cvt_pk_bf16_f32 v82, v68, v69
  v_cvt_pk_bf16_f32 v83, v70, v71
  v_cvt_pk_bf16_f32 v84, v72, v73
  v_cvt_pk_bf16_f32 v85, v74, v75
  v_cvt_pk_bf16_f32 v86, v76, v77
  v_cvt_pk_bf16_f32 v87, v78, v79
  s_lshl_b32 s61, s72, 16
  buffer_store_dwordx4 v[80:83], v12, s[44:47], s61 offen
  buffer_store_dwordx4 v[84:87], v12, s[44:47], s61 offen offset:16
  s_add_u32 s72, s72, 12
  s_add_u32 s71, s71, 1
  s_cmp_lt_u32 s71, 3
  s_cbranch_scc1 L_b_3
  s_endpgm
L_timeout:
  s_mov_b64 exec, 1
  v_mov_b32 v2, 232
  v_mov_b32 v3, s5
  v_add_u32 v3, 0x100, v3
  buffer_store_dword v3, v2, s[48:51], 0 offen sc1
L_exit:
  s_endpgm
.section .rodata,"a"
.p2align 6
.amdhsa_kernel concat_heads__memory_aug_recurrent_mem_tr__mha_block__prompt_kernel
  .amdhsa_next_free_vgpr 512
  .amdhsa_next_free_sgpr 102
  .amdhsa_accum_offset 256
  .amdhsa_group_segment_fixed_size 0
  .amdhsa_kernarg_size 104
  .amdhsa_user_sgpr_count 2
  .amdhsa_user_sgpr_kernarg_segment_ptr 1
  .amdhsa_system_sgpr_workgroup_id_x 1
.end_amdhsa_kernel
```
